```python
import torch

def _softmax(x, axis=-1):
    return torch.softmax(x, dim=axis)
def _gelu(x):
    return torch.nn.functional.gelu(x, approximate="tanh")
def _silu(x):
    return torch.nn.functional.silu(x)
def _sigmoid(x):
    return torch.sigmoid(x)
def _layernorm(x, axis=-1, eps=1e-5):
    m = x.mean(dim=axis, keepdim=True)
    v = x.var(dim=axis, keepdim=True, unbiased=False)
    return (x - m) / torch.sqrt(v + eps)
def _scatter_add(tgt, idx, src, axis=0):
    return tgt.clone().index_add_(axis, idx, src)
def _segment_sum(src, seg, n):
    out = torch.zeros((n,) + src.shape[1:], dtype=src.dtype)
    return out.index_add_(0, seg, src)
def _pad(x, pw):
    flat = tuple(v for pair in reversed(pw) for v in pair)
    return torch.nn.functional.pad(x, flat)

kernel_name = 'interleave_layers__ssm_conv_s4__linear_attn_block__prompt'

def setup_inputs():

    _w = (lambda a: (lambda t: t.to(torch.bfloat16) if t.is_floating_point() else t)(torch.as_tensor(a)))
    def _A_setup():
        B, L, D, N = 1, 2048, 512, 128
        A_re = -(lambda _x: torch.exp(torch.as_tensor(_x)))((lambda *s: torch.randn(*s, dtype=torch.bfloat16) * 1.6)(D, N))
        A_im = torch.pi * (lambda *s: torch.randn(*s, dtype=torch.bfloat16) * 0.05)(D, N)
        B_re = (lambda *s: torch.randn(*s, dtype=torch.bfloat16) * 0.05)(D, N)
        B_im = (lambda *s: torch.randn(*s, dtype=torch.bfloat16) * 0.05)(D, N)
        C_re = (lambda *s: torch.randn(*s, dtype=torch.bfloat16) * 0.05)(D, N)
        C_im = (lambda *s: torch.randn(*s, dtype=torch.bfloat16) * 0.05)(D, N)
        log_dt = (lambda *s: torch.randn(*s, dtype=torch.bfloat16) * 0.05)(D) * 0.5 - 4.0
        Dskip = (lambda *s: torch.randn(*s, dtype=torch.bfloat16) * 0.05)(D)
        return {
            "u": _w((lambda *s: torch.randn(*s, dtype=torch.bfloat16) * 0.05)(B, L, D)),
            "A_re": _w(A_re),
            "A_im": _w(A_im),
            "B_re": _w(B_re),
            "B_im": _w(B_im),
            "C_re": _w(C_re),
            "C_im": _w(C_im),
            "log_dt": _w(log_dt),
            "Dskip": _w(Dskip),
        }
    _A_in = _A_setup()

    def _B_setup():
        B, S, D = 1, 2048, 512
        return {
            "x": _w((lambda *s: torch.randn(*s, dtype=torch.bfloat16) * 0.05)(B, S, D)),
            "wqkv": _w((lambda *s: torch.randn(*s, dtype=torch.bfloat16) * 0.1)(D, 3 * D)),
            "wo": _w((lambda *s: torch.randn(*s, dtype=torch.bfloat16) * 0.05)(D, D)),
        }
    _B_in = _B_setup()

    return {
        "A_u": _A_in["u"],
        "A_A_re": _A_in["A_re"],
        "A_A_im": _A_in["A_im"],
        "A_B_re": _A_in["B_re"],
        "A_B_im": _A_in["B_im"],
        "A_C_re": _A_in["C_re"],
        "A_C_im": _A_in["C_im"],
        "A_log_dt": _A_in["log_dt"],
        "A_Dskip": _A_in["Dskip"],
        "B_x": _B_in["x"],
        "B_wqkv": _B_in["wqkv"],
        "B_wo": _B_in["wo"],
    }

def reference(A_u, A_A_re, A_A_im, A_B_re, A_B_im, A_C_re, A_C_im, A_log_dt, A_Dskip, B_x, B_wqkv, B_wo):
    def _A_ref(u, A_re, A_im, B_re, B_im, C_re, C_im, log_dt, Dskip):
        Bsz, L, D = u.shape
        dt = torch.exp(log_dt)[:, None]
        A = A_re + 1j * A_im
        Bc = B_re + 1j * B_im
        Cc = C_re + 1j * C_im
        logdA = dt * A
        dB = dt * Bc
        l = (lambda x, dt: x.to(dt))(torch.arange(L), A_re.dtype)
        P = torch.exp(logdA[:, :, None] * l[None, None, :])
        K = torch.einsum("dn,dnl,dn->dl", Cc, P, dB).real
        L2 = 2 * L
        Kp = _pad(K, ((0, 0), (0, L)))
        up = (lambda x, *d: x.permute(*d))(u, 0, 2, 1)
        up = _pad(up, ((0, 0), (0, 0), (0, L)))
        Kf = (lambda x, axes=(-2,-1): torch.fft.rfft2(x.float(), dim=axes))(Kp[:, None, :], axes=(-2, -1))
        Uf = (lambda x, axes=(-2,-1): torch.fft.rfft2(x.float(), dim=axes))(up[:, :, None, :], axes=(-2, -1))
        Yf = Uf * Kf[None, :, :, :]
        y = (lambda x, s, axes=(-2,-1): torch.fft.irfft2(x, s=s, dim=axes).to(torch.bfloat16))(Yf, (1, L2), axes=(-2, -1))[:, :, 0, :L]
        y = (lambda x, *d: x.permute(*d))(y, 0, 2, 1) + u * Dskip[None, None, :]
        return y

    def _B_ref(x, wqkv, wo):
        B, S, D = x.shape
        H = 32; Dh = D // H
        qkv = (lambda x, *d: x.permute(*d))((x @ wqkv).reshape(B, S, 3, H, Dh), 2, 0, 3, 1, 4)
        q, k, v = qkv[0], qkv[1], qkv[2]
        phi = lambda t: torch.where(t > 0, t + 1, torch.exp(t)) + 1e-6
        pq, pk = phi(q), phi(k)
        kv = torch.einsum("bhsd,bhse->bhde", pk, v)
        z = torch.einsum("bhsd->bhd", pk)
        num = torch.einsum("bhqd,bhde->bhqe", pq, kv)
        den = torch.einsum("bhqd,bhd->bhq", pq, z)[..., None] + 1e-6
        o = num / den
        return (lambda x, *d: x.permute(*d))(o, 0, 2, 1, 3).reshape(B, S, D) @ wo

    x = A_u
    x = x + _A_ref(_layernorm(x, axis=-1), A_A_re, A_A_im, A_B_re, A_B_im, A_C_re, A_C_im, A_log_dt, A_Dskip)
    x = x + _B_ref(_layernorm(x, axis=-1), B_wqkv, B_wo)
    x = x + _A_ref(_layernorm(x, axis=-1), A_A_re, A_A_im, A_B_re, A_B_im, A_C_re, A_C_im, A_log_dt, A_Dskip)
    x = x + _B_ref(_layernorm(x, axis=-1), B_wqkv, B_wo)
    return x
```

```asm
; @launch grid=(256,1,1) block=(256,1,1) lds=163840
.amdgcn_target "amdgcn-amd-amdhsa--gfx950"
.text
.globl interleave_layers__ssm_conv_s4__linear_attn_block__prompt_kernel
.p2align 12
.p2align 8
.type interleave_layers__ssm_conv_s4__linear_attn_block__prompt_kernel,@function
interleave_layers__ssm_conv_s4__linear_attn_block__prompt_kernel:
    s_cmp_ge_u32 s2, 256
    s_cbranch_scc1 L_end
    s_load_dwordx16 s[4:19], s[0:1], 0
    s_load_dwordx16 s[20:35], s[0:1], 56
    s_getpc_b64 s[76:77]
L_pc:
    s_lshr_b32 s69, s2, 3
    s_lshl_b32 s68, s69, 11
    v_lshl_add_u32 v1, v0, 3, s68
    v_min_u32_e32 v1, L_last-L_pc-4, v1
    global_load_dword v59, v1, s[76:77]
    s_and_b32 s68, s2, 7
    s_lshl_b32 s57, s68, 5
    s_add_u32 s57, s57, s69
    s_lshl_b32 s68, s57, 9
    v_lshl_add_u32 v60, v0, 1, s68
    v_lshrrev_b32_e32 v61, 8, v60
    v_lshlrev_b32_e32 v61, 1, v61
    v_mov_b64_e32 v[64:65], 0
    v_mov_b64_e32 v[66:67], 0
    v_mov_b64_e32 v[68:69], 0
    v_mov_b64_e32 v[70:71], 0
    v_lshrrev_b32_e32 v1, 6, v0
    v_and_b32_e32 v53, 15, v0
    v_readfirstlane_b32 s56, v1
    v_bfe_u32 v56, v0, 4, 1
    s_lshr_b32 s58, s57, 3
    s_and_b32 s59, s69, 7
    s_lshr_b32 s60, s59, 1
    s_and_b32 s68, s59, 1
    s_lshl_b32 s68, s68, 5
    s_add_u32 s67, s58, s68
    s_lshl_b32 s67, s67, 5
    s_lshl2_add_u32 s70, s60, s56
    s_lshl4_add_u32 s64, s67, s70
    s_lshl_b32 s64, s64, 6
    v_and_b32_e32 v5, 32, v0
    v_lshl_add_u32 v5, v53, 10, v5
    v_lshlrev_b32_e32 v2, 14, v56
    v_add3_u32 v2, v2, v5, s64
    v_mov_b32_e32 v62, 0
    s_waitcnt lgkmcnt(0)
    global_load_short_d16_hi v70, v61, s[18:19]
    global_load_short_d16_hi v64, v60, s[6:7]
    global_load_short_d16_hi v65, v60, s[8:9]
    global_load_short_d16_hi v66, v60, s[10:11]
    global_load_short_d16_hi v67, v60, s[12:13]
    global_load_short_d16_hi v68, v60, s[14:15]
    global_load_short_d16_hi v69, v60, s[16:17]
    global_load_dwordx4 v[72:75], v2, s[4:5]
    global_load_dwordx4 v[76:79], v2, s[4:5] offset:16
    global_load_short_d16_hi v71, v61, s[22:23]
    global_load_dword v62, v62, s[34:35]
    s_mov_b32 s36, s34
    s_and_b32 s37, s35, 0xffff
    s_mov_b32 s38, 0x1300000
    s_mov_b32 s39, 0x20000
    s_mov_b32 s48, s26
    s_and_b32 s49, s27, 0xffff
    s_mov_b32 s50, 0x180000
    s_mov_b32 s51, 0x20000
    s_mov_b32 s40, s30
    s_and_b32 s41, s31, 0xffff
    v_and_or_b32 v5, v0, 16, v5
    v_and_b32_e32 v52, 63, v0
    v_bfe_u32 v55, v0, 5, 1
    v_and_b32_e32 v57, 3, v0
    v_lshlrev_b32_e32 v6, 4, v52
    v_bfe_u32 v58, v0, 2, 2
    v_bfe_u32 v54, v0, 4, 2
    s_lshr_b32 s65, s56, 1
    s_and_b32 s66, s56, 1
    s_lshl_b32 s75, s56, 10
    s_mul_i32 s68, s70, 133120
    s_lshl2_add_u32 s72, s67, s68
    s_add_u32 s72, s72, 0x300000
    s_lshl_b32 s68, s60, 13
    s_lshl2_add_u32 s73, s67, s68
    s_add_u32 s73, s73, 0x8000
    s_cmp_eq_u32 s56, 0
    s_cselect_b32 s73, s73, 0x40000000
    v_lshlrev_b32_e32 v1, 2, v53
    v_lshl_add_u32 v1, v56, 6, v1
    v_mul_u32_u24_e32 v7, 66560, v55
    v_add_u32_e32 v7, v7, v1
    v_lshl_add_u32 v8, v55, 30, v1
    s_lshl2_add_u32 s68, s56, 0x1f800
    v_add_u32_e32 v9, s68, v6
    v_and_b32_e32 v1, 0x1f0, v6
    v_add_u32_e32 v10, 0x1f800, v1
    s_mov_b32 s55, 0x20000
    s_add_u32 s71, s75, 0x21000
    s_bitcmp1_b32 s57, 0
    s_cbranch_scc1 arm_1
    s_mov_b32 s52, s28
    s_and_b32 s53, s29, 0xffff
    s_mov_b32 s54, 0x80000
    s_bfe_u32 s68, s57, 0x20001
    s_lshl2_add_u32 s68, s68, s56
    s_lshr_b32 s69, s57, 3
    s_lshl_b32 s76, s68, 5
    s_add_u32 s76, s76, s69
    s_lshl_b32 s76, s76, 10
    s_add_u32 s76, s76, 0x80000
    s_mul_i32 s69, s69, 256
    s_add_u32 s68, s68, s69
    s_lshl_b32 s68, s68, 6
    v_lshrrev_b32_e64 v1, 2, v52
    v_lshl_add_u32 v1, v1, 10, s68
    v_lshl_add_u32 v80, v57, 4, v1
    v_lshl_add_u32 v1, v55, 3, v58
    v_lshl_add_u32 v1, v1, 6, s71
    v_lshl_add_u32 v1, v56, 4, v1
    v_and_b32_e32 v2, 1, v0
    v_lshl_add_u32 v1, v2, 5, v1
    v_and_b32_e32 v2, 2, v0
    v_lshl_add_u32 v63, v2, 2, v1
    v_add_u32_e32 v84, 0x100, v63
    s_branch join_2
arm_1:
    s_mov_b32 s52, s26
    s_and_b32 s53, s27, 0xffff
    s_mov_b32 s54, 0x180000
    s_bfe_u32 s68, s57, 0x30001
    s_lshl2_add_u32 s68, s68, s56
    s_lshr_b32 s69, s57, 4
    s_lshl_b32 s76, s68, 4
    s_add_u32 s76, s76, s69
    s_lshl_b32 s76, s76, 10
    s_add_u32 s76, s76, 0x100000
    s_mul_i32 s69, s69, 3072
    s_add_u32 s68, s68, s69
    s_lshl_b32 s68, s68, 5
    v_lshrrev_b32_e32 v1, 1, v52
    v_mul_u32_u24_e32 v1, 0xc00, v1
    v_and_b32_e64 v2, 16, v6
    v_add3_u32 v80, v1, v2, s68
    v_lshl_add_u32 v63, v52, 3, s71
    v_add_u32_e32 v84, 0x200, v63
join_2:
    s_mov_b32 s4, 0x3f803f80
    s_add_u32 s7, s72, 0x0
    s_add_u32 s8, s72, 0x2080
    s_add_u32 s9, s72, 0x4100
    s_add_u32 s10, s72, 0x6180
    s_add_u32 s11, s72, 0x8200
    s_add_u32 s12, s72, 0xa280
    s_add_u32 s13, s72, 0xc300
    s_add_u32 s14, s72, 0xe380
    s_lshl_b32 s68, s56, 14
    s_sub_u32 s15, 0x1c000, s68
    v_add_u32_e32 v85, s15, v6
    v_xor_b32_e32 v86, 0x40, v85
    v_xor_b32_e32 v87, 0x80, v85
    v_xor_b32_e32 v88, 0xc0, v85
    v_lshl_add_u32 v4, v55, 2, v58
    v_lshl_add_u32 v4, v4, 4, s15
    v_mul_u32_u24_e32 v1, 0x880, v56
    v_xor_b32_e32 v4, v4, v1
    v_and_b32_e32 v1, 1, v0
    v_bfe_u32 v2, v0, 1, 1
    v_mul_u32_u24_e32 v3, 0x440, v1
    v_xor_b32_e64 v3, v3, v4
    v_lshl_add_u32 v89, v2, 3, v3
    v_xor_b32_e32 v90, 0x80, v89
    v_mul_u32_u24_e32 v3, 0x440, v2
    v_xor_b32_e32 v3, v3, v4
    v_lshl_add_u32 v91, v1, 3, v3
    v_xor_b32_e32 v92, 0x80, v91
    v_lshrrev_b32_e32 v1, 3, v0
    v_mul_u32_u24_e32 v1, 0xc00, v1
    v_and_b32_e32 v4, 0x70, v6
    v_lshlrev_b32_e32 v3, 5, v54
    v_xor_b32_e32 v4, v4, v3
    s_lshl_b32 s68, s59, 7
    v_add3_u32 v46, v1, v4, s68
    s_mov_b32 s15, 0x0
    s_mov_b32 s16, 0x18000
    s_mov_b32 s17, 0x30000
    s_mov_b32 s18, 0x48000
    s_mov_b32 s19, 0x60000
    s_mov_b32 s20, 0x78000
    s_mov_b32 s21, 0x90000
    s_mov_b32 s22, 0xa8000
    s_mul_i32 s68, s56, 2240
    v_and_b32_e32 v1, 31, v0
    v_lshl_add_u32 v1, v1, 1, v55
    v_lshlrev_b32_e32 v1, 4, v1
    s_add_u32 s69, s68, 0x10430
    v_sub_u32_e32 v93, s69, v1
    s_mul_i32 s70, s65, 5120
    s_add_u32 s69, s70, 0x124fc
    v_lshlrev_b32_e32 v1, 2, v52
    v_sub_u32_e32 v95, s69, v1
    v_add_u32_e32 v1, 4, v0
    v_and_b32_e32 v1, 63, v1
    v_cmp_gt_u32_e32 vcc, 8, v1
    v_and_b32_e64 v2, 4, v1
    v_lshl_add_u32 v1, v2, 5, v1
    s_add_u32 s69, s68, 0x10000
    v_lshl_add_u32 v1, v1, 4, s69
    s_lshl_b32 s69, s66, 8
    s_add_u32 s69, s69, s70
    s_add_u32 s69, s69, 0x12500
    v_lshl_add_u32 v2, v53, 4, s69
    v_cndmask_b32_e32 v94, v2, v1, vcc
    v_cmp_ne_u32_e64 s[24:25], 0, v56
    s_cmp_lg_u32 s66, 0
    s_cselect_b64 s[26:27], -1, 0
    s_cselect_b64 s[28:29], 1, 0
    s_mov_b32 s30, 0
    s_brev_b32 s31, 1
    s_waitcnt vmcnt(11)
    s_mov_b64 exec, 0
    s_cmp_eq_u32 s56, 0
    s_cbranch_scc1 W1_0
    s_cmp_eq_u32 s56, 1
    s_cbranch_scc1 W1_ret
    s_cmp_eq_u32 s56, 2
    s_cbranch_scc1 W1_ret
    s_branch W1_ret
W1_ret:
    s_mov_b64 exec, -1
    s_mov_b32 s5, 0xffff0000
    s_mov_b32 s6, 0x3727c5ac
    v_mov_b64_e32 v[22:23], -1
    v_mov_b64_e32 v[24:25], -1
    v_lshlrev_b32_e32 v13, 4, v0
    s_cmp_eq_u32 s66, 0
    s_cselect_b32 s68, 0x1ff, 0
    s_cselect_b32 s68, s68, 0xfe00
    s_add_u32 s70, s66, 1
    s_cmp_eq_u32 s65, 0
    s_cselect_b32 s68, s68, s70
    v_lshlrev_b32_e32 v1, s65, v53
    v_lshlrev_b32_e64 v1, v1, s68
    v_lshlrev_b32_e32 v2, 3, v54
    v_lshrrev_b32_e32 v1, v2, v1
    v_bfe_u32 v96, v1, 0, 2
    v_mul_u32_u24_e32 v96, 0x8001, v96
    v_and_b32_e32 v96, 0x10001, v96
    v_mul_u32_u24_e32 v96, 0x3f80, v96
    v_bfe_u32 v97, v1, 2, 2
    v_mul_u32_u24_e32 v97, 0x8001, v97
    v_and_b32_e32 v97, 0x10001, v97
    v_mul_u32_u24_e32 v97, 0x3f80, v97
    v_bfe_u32 v98, v1, 4, 2
    v_mul_u32_u24_e32 v98, 0x8001, v98
    v_and_b32_e32 v98, 0x10001, v98
    v_mul_u32_u24_e32 v98, 0x3f80, v98
    v_bfe_u32 v99, v1, 6, 2
    v_mul_u32_u24_e32 v99, 0x8001, v99
    v_and_b32_e32 v99, 0x10001, v99
    v_mul_u32_u24_e32 v99, 0x3f80, v99
    s_lshl1_add_u32 s68, s57, s65
    s_lshl_b32 s68, s68, 6
    s_mul_i32 s70, s66, 263168
    s_add_u32 s68, s68, s70
    s_add_u32 s74, s68, 0xc00000
    v_bfe_u32 v2, v0, 2, 3
    v_lshl_add_u32 v2, v55, 4, v2
    v_mul_u32_u24_e32 v2, 32896, v2
    v_lshl_add_u32 v11, v57, 4, v2
    v_bfe_u32 v1, v0, 3, 2
    v_xor_b32_e32 v1, s56, v1
    v_lshl_add_u32 v1, v1, 2, v57
    v_lshrrev_b32_e32 v2, 2, v52
    v_lshl_add_u32 v1, v2, 4, v1
    s_lshl_b32 s68, s65, 14
    v_lshl_add_u32 v48, v1, 3, s68
    v_xor_b32_e32 v49, 0x4000, v48
    v_and_b32_e32 v3, 1, v0
    v_mul_u32_u24_e32 v1, 561, v3
    v_lshrrev_b32_e32 v2, 1, v53
    v_add_u32_e32 v1, v1, v2
    v_lshlrev_b32_e32 v4, 2, v54
    v_sub_u32_e64 v1, v4, v1
    s_mul_i32 s68, s65, 4480
    s_add_u32 s68, s68, 0x108e0
    v_lshl_add_u32 v14, v1, 2, s68
    s_waitcnt vmcnt(10)
    v_mul_f32_e32 v70, 0x3fb8aa3b, v70
    v_exp_f32_e32 v70, v70
    s_nop 0
    v_cvt_pk_bf16_f32 v70, 0, v70
    s_waitcnt vmcnt(9)
    v_mul_f32_e32 v100, v70, v64
    s_waitcnt vmcnt(8)
    v_mul_f32_e32 v101, v70, v65
    s_waitcnt vmcnt(7)
    v_mul_f32_e32 v102, v70, v66
    s_waitcnt vmcnt(6)
    v_mul_f32_e32 v103, v70, v67
    s_waitcnt vmcnt(4)
    v_pk_mul_f32 v[104:105], v[68:69], v[102:103] op_sel:[0,0] op_sel_hi:[1,0]
    v_pk_fma_f32 v[106:107], v[68:69], v[102:103], v[104:105] op_sel:[1,1,0] op_sel_hi:[0,1,1] neg_lo:[1,0,0]
    v_mul_f32_e32 v1, 0x3fb8aa3b, v100
    v_mul_f32_e32 v2, 0x3e22f983, v101
    v_exp_f32_e32 v1, v1
    v_fract_f32_e32 v2, v2
    v_cos_f32_e32 v108, v2
    v_sin_f32_e32 v109, v2
    v_mul_f32_e32 v108, v1, v108
    v_mul_f32_e32 v109, v1, v109
    v_mul_f32_e32 v1, 0x41b8aa3b, v100
    v_mul_f32_e32 v2, 0xc022f983, v101
    v_exp_f32_e32 v1, v1
    v_fract_f32_e32 v2, v2
    v_cos_f32_e32 v110, v2
    v_sin_f32_e32 v111, v2
    v_mul_f32_e32 v110, v1, v110
    v_mul_f32_e32 v111, v1, v111
    v_mul_f32_e32 v1, 0x4438aa3b, v100
    v_mul_f32_e32 v2, 0x42a2f983, v101
    v_exp_f32_e32 v1, v1
    v_fract_f32_e32 v2, v2
    v_cos_f32_e32 v112, v2
    v_sin_f32_e32 v113, v2
    v_mul_f32_e32 v112, v1, v112
    v_mul_f32_e32 v113, v1, v113
    s_waitcnt vmcnt(3)
    buffer_store_dword v72, v7, s[36:39], s7 offen sc1
    v_dot2_f32_bf16 v1, v72, s4, 0
    v_dot2_f32_bf16 v2, v72, v72, 0
    buffer_store_dword v73, v7, s[36:39], s8 offen sc1
    v_dot2_f32_bf16 v1, v73, s4, v1
    v_dot2_f32_bf16 v2, v73, v73, v2
    buffer_store_dword v74, v7, s[36:39], s9 offen sc1
    v_dot2_f32_bf16 v1, v74, s4, v1
    v_dot2_f32_bf16 v2, v74, v74, v2
    buffer_store_dword v75, v7, s[36:39], s10 offen sc1
    v_dot2_f32_bf16 v1, v75, s4, v1
    v_dot2_f32_bf16 v2, v75, v75, v2
    s_waitcnt vmcnt(6)
    buffer_store_dword v76, v7, s[36:39], s11 offen sc1
    v_dot2_f32_bf16 v1, v76, s4, v1
    v_dot2_f32_bf16 v2, v76, v76, v2
    buffer_store_dword v77, v7, s[36:39], s12 offen sc1
    v_dot2_f32_bf16 v1, v77, s4, v1
    v_dot2_f32_bf16 v2, v77, v77, v2
    buffer_store_dword v78, v7, s[36:39], s13 offen sc1
    v_dot2_f32_bf16 v1, v78, s4, v1
    v_dot2_f32_bf16 v2, v78, v78, v2
    buffer_store_dword v79, v7, s[36:39], s14 offen sc1
    v_dot2_f32_bf16 v1, v79, s4, v1
    v_dot2_f32_bf16 v2, v79, v79, v2
    v_lshrrev_b32_e32 v3, 7, v0
    v_lshlrev_b32_e32 v3, 10, v3
    v_lshl_add_u32 v3, v0, 4, v3
    v_permlane32_swap_b32 v1, v2
    v_add_f32_e64 v1, v1, v2
    ds_write_b32 v9, v1 offset:2048
    s_mul_i32 s68, s57, 6144
    buffer_load_dword v59, v3, s[48:51], s68 offen offset:1024
    buffer_load_dwordx4 v[80:83], v80, s[52:55], 0 offen
    s_waitcnt vmcnt(10)
    v_readfirstlane_b32 s61, v62
    v_readfirstlane_b32 s62, v71
    s_mov_b32 s63, 0x20000
    s_add_u32 s61, s61, 1
    v_pk_mul_f32 v[104:105], v[106:107], v[108:109] op_sel:[0,0] op_sel_hi:[1,0]
    v_pk_fma_f32 v[72:73], v[106:107], v[108:109], v[104:105] op_sel:[1,1,0] op_sel_hi:[0,1,1] neg_lo:[1,0,0]
    v_cvt_pk_bf16_f32 v116, v106, v72
    v_cvt_pk_bf16_f32 v120, v107, v73
    v_pk_mul_f32 v[104:105], v[72:73], v[108:109] op_sel:[0,0] op_sel_hi:[1,0]
    v_pk_fma_f32 v[60:61], v[72:73], v[108:109], v[104:105] op_sel:[1,1,0] op_sel_hi:[0,1,1] neg_lo:[1,0,0]
    v_pk_mul_f32 v[104:105], v[60:61], v[108:109] op_sel:[0,0] op_sel_hi:[1,0]
    v_pk_fma_f32 v[72:73], v[60:61], v[108:109], v[104:105] op_sel:[1,1,0] op_sel_hi:[0,1,1] neg_lo:[1,0,0]
    v_cvt_pk_bf16_f32 v117, v60, v72
    v_cvt_pk_bf16_f32 v121, v61, v73
    v_pk_mul_f32 v[104:105], v[72:73], v[108:109] op_sel:[0,0] op_sel_hi:[1,0]
    v_pk_fma_f32 v[74:75], v[72:73], v[108:109], v[104:105] op_sel:[1,1,0] op_sel_hi:[0,1,1] neg_lo:[1,0,0]
    v_pk_mul_f32 v[104:105], v[74:75], v[108:109] op_sel:[0,0] op_sel_hi:[1,0]
    v_pk_fma_f32 v[72:73], v[74:75], v[108:109], v[104:105] op_sel:[1,1,0] op_sel_hi:[0,1,1] neg_lo:[1,0,0]
    v_cvt_pk_bf16_f32 v118, v74, v72
    v_cvt_pk_bf16_f32 v122, v75, v73
    v_pk_mul_f32 v[104:105], v[72:73], v[108:109] op_sel:[0,0] op_sel_hi:[1,0]
    v_pk_fma_f32 v[60:61], v[72:73], v[108:109], v[104:105] op_sel:[1,1,0] op_sel_hi:[0,1,1] neg_lo:[1,0,0]
    v_pk_mul_f32 v[104:105], v[60:61], v[108:109] op_sel:[0,0] op_sel_hi:[1,0]
    v_pk_fma_f32 v[72:73], v[60:61], v[108:109], v[104:105] op_sel:[1,1,0] op_sel_hi:[0,1,1] neg_lo:[1,0,0]
    v_cvt_pk_bf16_f32 v119, v60, v72
    v_cvt_pk_bf16_f32 v123, v61, v73
    s_waitcnt lgkmcnt(0)
    s_barrier
    s_cmp_lg_u32 s56, 0
    s_cbranch_scc1 nw_3
    ds_read_b128 v[124:127], v10 offset:2048
    ds_read_b128 v[128:131], v10 offset:2560
    s_add_u32 s71, s73, 0x0
    s_waitcnt lgkmcnt(1)
    v_pk_add_f32 v[124:125], v[124:125], v[126:127]
    s_waitcnt lgkmcnt(0)
    v_pk_add_f32 v[128:129], v[128:129], v[130:131]
    v_add_f32_e32 v124, v124, v125
    v_add_f32_e64 v128, v128, v129
    v_mul_f32_e32 v124, 0x3b800000, v124
    v_mul_f32_e32 v128, 0x3b000000, v128
    v_fma_f32 v128, -v124, v124, v128
    v_max_f32_e32 v128, 0, v128
    v_sqrt_f32_e32 v128, v128
    s_nop 0
    v_cvt_pk_bf16_f32 v124, v124, v128
    buffer_store_dword v124, v8, s[36:39], s71 offen sc1
nw_3:
    ds_write_b128 v85, v[116:119]
    ds_write_b128 v85, v[120:123] offset:4096
    v_pk_mul_f32 v[104:105], v[72:73], v[108:109] op_sel:[0,0] op_sel_hi:[1,0]
    v_pk_fma_f32 v[76:77], v[72:73], v[108:109], v[104:105] op_sel:[1,1,0] op_sel_hi:[0,1,1] neg_lo:[1,0,0]
    v_pk_mul_f32 v[104:105], v[76:77], v[108:109] op_sel:[0,0] op_sel_hi:[1,0]
    v_pk_fma_f32 v[72:73], v[76:77], v[108:109], v[104:105] op_sel:[1,1,0] op_sel_hi:[0,1,1] neg_lo:[1,0,0]
    v_cvt_pk_bf16_f32 v116, v76, v72
    v_cvt_pk_bf16_f32 v120, v77, v73
    v_pk_mul_f32 v[104:105], v[72:73], v[108:109] op_sel:[0,0] op_sel_hi:[1,0]
    v_pk_fma_f32 v[60:61], v[72:73], v[108:109], v[104:105] op_sel:[1,1,0] op_sel_hi:[0,1,1] neg_lo:[1,0,0]
    v_pk_mul_f32 v[104:105], v[60:61], v[108:109] op_sel:[0,0] op_sel_hi:[1,0]
    v_pk_fma_f32 v[72:73], v[60:61], v[108:109], v[104:105] op_sel:[1,1,0] op_sel_hi:[0,1,1] neg_lo:[1,0,0]
    v_cvt_pk_bf16_f32 v117, v60, v72
    v_cvt_pk_bf16_f32 v121, v61, v73
    v_pk_mul_f32 v[104:105], v[72:73], v[108:109] op_sel:[0,0] op_sel_hi:[1,0]
    v_pk_fma_f32 v[78:79], v[72:73], v[108:109], v[104:105] op_sel:[1,1,0] op_sel_hi:[0,1,1] neg_lo:[1,0,0]
    v_pk_mul_f32 v[104:105], v[78:79], v[108:109] op_sel:[0,0] op_sel_hi:[1,0]
    v_pk_fma_f32 v[72:73], v[78:79], v[108:109], v[104:105] op_sel:[1,1,0] op_sel_hi:[0,1,1] neg_lo:[1,0,0]
    v_cvt_pk_bf16_f32 v118, v78, v72
    v_cvt_pk_bf16_f32 v122, v79, v73
    v_pk_mul_f32 v[104:105], v[72:73], v[108:109] op_sel:[0,0] op_sel_hi:[1,0]
    v_pk_fma_f32 v[60:61], v[72:73], v[108:109], v[104:105] op_sel:[1,1,0] op_sel_hi:[0,1,1] neg_lo:[1,0,0]
    v_pk_mul_f32 v[104:105], v[60:61], v[108:109] op_sel:[0,0] op_sel_hi:[1,0]
    v_pk_fma_f32 v[72:73], v[60:61], v[108:109], v[104:105] op_sel:[1,1,0] op_sel_hi:[0,1,1] neg_lo:[1,0,0]
    v_cvt_pk_bf16_f32 v119, v60, v72
    v_cvt_pk_bf16_f32 v123, v61, v73
    ds_write_b128 v86, v[116:119] offset:1024
    ds_write_b128 v86, v[120:123] offset:5120
    v_pk_mul_f32 v[104:105], v[72:73], v[108:109] op_sel:[0,0] op_sel_hi:[1,0]
    v_pk_fma_f32 v[100:101], v[72:73], v[108:109], v[104:105] op_sel:[1,1,0] op_sel_hi:[0,1,1] neg_lo:[1,0,0]
    v_pk_mul_f32 v[104:105], v[106:107], v[112:113] op_sel:[0,0] op_sel_hi:[1,0]
    v_pk_fma_f32 v[102:103], v[106:107], v[112:113], v[104:105] op_sel:[1,1,0] op_sel_hi:[0,1,1] neg_lo:[1,0,0]
    v_pk_mul_f32 v[104:105], v[74:75], v[112:113] op_sel:[0,0] op_sel_hi:[1,0]
    v_pk_fma_f32 v[114:115], v[74:75], v[112:113], v[104:105] op_sel:[1,1,0] op_sel_hi:[0,1,1] neg_lo:[1,0,0]
    v_pk_mul_f32 v[104:105], v[76:77], v[112:113] op_sel:[0,0] op_sel_hi:[1,0]
    v_pk_fma_f32 v[124:125], v[76:77], v[112:113], v[104:105] op_sel:[1,1,0] op_sel_hi:[0,1,1] neg_lo:[1,0,0]
    v_pk_mul_f32 v[104:105], v[78:79], v[112:113] op_sel:[0,0] op_sel_hi:[1,0]
    v_pk_fma_f32 v[126:127], v[78:79], v[112:113], v[104:105] op_sel:[1,1,0] op_sel_hi:[0,1,1] neg_lo:[1,0,0]
    v_pk_mul_f32 v[104:105], v[100:101], v[112:113] op_sel:[0,0] op_sel_hi:[1,0]
    v_pk_fma_f32 v[128:129], v[100:101], v[112:113], v[104:105] op_sel:[1,1,0] op_sel_hi:[0,1,1] neg_lo:[1,0,0]
    v_pk_mul_f32 v[104:105], v[124:125], v[112:113] op_sel:[0,0] op_sel_hi:[1,0]
    v_pk_fma_f32 v[130:131], v[124:125], v[112:113], v[104:105] op_sel:[1,1,0] op_sel_hi:[0,1,1] neg_lo:[1,0,0]
    v_pk_mul_f32 v[104:105], v[128:129], v[112:113] op_sel:[0,0] op_sel_hi:[1,0]
    v_pk_fma_f32 v[132:133], v[128:129], v[112:113], v[104:105] op_sel:[1,1,0] op_sel_hi:[0,1,1] neg_lo:[1,0,0]
    v_cvt_pk_bf16_f32 v116, v76, v102
    v_cvt_pk_bf16_f32 v120, v77, v103
    v_cvt_pk_bf16_f32 v117, v114, v124
    v_cvt_pk_bf16_f32 v121, v115, v125
    v_cvt_pk_bf16_f32 v118, v130, v132
    v_cvt_pk_bf16_f32 v122, v131, v133
    ds_write_b128 v87, v[116:119] offset:2048
    ds_write_b128 v87, v[120:123] offset:6144
    v_pk_mul_f32 v[104:105], v[130:131], v[112:113] op_sel:[0,0] op_sel_hi:[1,0]
    v_pk_fma_f32 v[130:131], v[130:131], v[112:113], v[104:105] op_sel:[1,1,0] op_sel_hi:[0,1,1] neg_lo:[1,0,0]
    v_pk_mul_f32 v[104:105], v[132:133], v[112:113] op_sel:[0,0] op_sel_hi:[1,0]
    v_pk_fma_f32 v[132:133], v[132:133], v[112:113], v[104:105] op_sel:[1,1,0] op_sel_hi:[0,1,1] neg_lo:[1,0,0]
    v_cvt_pk_bf16_f32 v116, v100, v124
    v_cvt_pk_bf16_f32 v120, v101, v125
    v_cvt_pk_bf16_f32 v117, v126, v128
    v_cvt_pk_bf16_f32 v121, v127, v129
    v_cvt_pk_bf16_f32 v118, v130, v132
    v_cvt_pk_bf16_f32 v122, v131, v133
    ds_write_b128 v88, v[116:119] offset:3072
    ds_write_b128 v88, v[120:123] offset:7168
    v_mov_b32_e32 v60, 1.0
    v_mov_b32_e64 v61, 0
    v_cvt_pk_bf16_f32 v116, v60, v110
    v_cvt_pk_bf16_f32 v120, v61, v111
    v_pk_mul_f32 v[104:105], v[110:111], v[110:111] op_sel:[0,0] op_sel_hi:[1,0]
    v_pk_fma_f32 v[60:61], v[110:111], v[110:111], v[104:105] op_sel:[1,1,0] op_sel_hi:[0,1,1] neg_lo:[1,0,0]
    v_pk_mul_f32 v[104:105], v[60:61], v[110:111] op_sel:[0,0] op_sel_hi:[1,0]
    v_pk_fma_f32 v[72:73], v[60:61], v[110:111], v[104:105] op_sel:[1,1,0] op_sel_hi:[0,1,1] neg_lo:[1,0,0]
    v_cvt_pk_bf16_f32 v117, v60, v72
    v_cvt_pk_bf16_f32 v121, v61, v73
    v_pk_mul_f32 v[104:105], v[72:73], v[110:111] op_sel:[0,0] op_sel_hi:[1,0]
    v_pk_fma_f32 v[60:61], v[72:73], v[110:111], v[104:105] op_sel:[1,1,0] op_sel_hi:[0,1,1] neg_lo:[1,0,0]
    v_pk_mul_f32 v[104:105], v[60:61], v[110:111] op_sel:[0,0] op_sel_hi:[1,0]
    v_pk_fma_f32 v[72:73], v[60:61], v[110:111], v[104:105] op_sel:[1,1,0] op_sel_hi:[0,1,1] neg_lo:[1,0,0]
    v_cvt_pk_bf16_f32 v118, v60, v72
    v_cvt_pk_bf16_f32 v122, v61, v73
    v_pk_mul_f32 v[104:105], v[72:73], v[110:111] op_sel:[0,0] op_sel_hi:[1,0]
    v_pk_fma_f32 v[60:61], v[72:73], v[110:111], v[104:105] op_sel:[1,1,0] op_sel_hi:[0,1,1] neg_lo:[1,0,0]
    v_pk_mul_f32 v[104:105], v[60:61], v[110:111] op_sel:[0,0] op_sel_hi:[1,0]
    v_pk_fma_f32 v[72:73], v[60:61], v[110:111], v[104:105] op_sel:[1,1,0] op_sel_hi:[0,1,1] neg_lo:[1,0,0]
    v_cvt_pk_bf16_f32 v119, v60, v72
    v_cvt_pk_bf16_f32 v123, v61, v73
    ds_write_b128 v85, v[116:119] offset:8192
    ds_write_b128 v85, v[120:123] offset:12288
    v_pk_mul_f32 v[104:105], v[72:73], v[110:111] op_sel:[0,0] op_sel_hi:[1,0]
    v_pk_fma_f32 v[60:61], v[72:73], v[110:111], v[104:105] op_sel:[1,1,0] op_sel_hi:[0,1,1] neg_lo:[1,0,0]
    v_pk_mul_f32 v[104:105], v[60:61], v[110:111] op_sel:[0,0] op_sel_hi:[1,0]
    v_pk_fma_f32 v[72:73], v[60:61], v[110:111], v[104:105] op_sel:[1,1,0] op_sel_hi:[0,1,1] neg_lo:[1,0,0]
    v_cvt_pk_bf16_f32 v116, v60, v72
    v_cvt_pk_bf16_f32 v120, v61, v73
    v_pk_mul_f32 v[104:105], v[72:73], v[110:111] op_sel:[0,0] op_sel_hi:[1,0]
    v_pk_fma_f32 v[60:61], v[72:73], v[110:111], v[104:105] op_sel:[1,1,0] op_sel_hi:[0,1,1] neg_lo:[1,0,0]
    v_pk_mul_f32 v[104:105], v[60:61], v[110:111] op_sel:[0,0] op_sel_hi:[1,0]
    v_pk_fma_f32 v[72:73], v[60:61], v[110:111], v[104:105] op_sel:[1,1,0] op_sel_hi:[0,1,1] neg_lo:[1,0,0]
    v_cvt_pk_bf16_f32 v117, v60, v72
    v_cvt_pk_bf16_f32 v121, v61, v73
    v_add_u32_e32 v47, 0xc0400, v46
    s_add_u32 m0, s75, 0x8000
    s_nop 0
    buffer_load_dwordx4 v47, s[48:51], s15 offen lds
    v_pk_mul_f32 v[104:105], v[72:73], v[110:111] op_sel:[0,0] op_sel_hi:[1,0]
    v_pk_fma_f32 v[60:61], v[72:73], v[110:111], v[104:105] op_sel:[1,1,0] op_sel_hi:[0,1,1] neg_lo:[1,0,0]
    v_pk_mul_f32 v[104:105], v[60:61], v[110:111] op_sel:[0,0] op_sel_hi:[1,0]
    v_pk_fma_f32 v[72:73], v[60:61], v[110:111], v[104:105] op_sel:[1,1,0] op_sel_hi:[0,1,1] neg_lo:[1,0,0]
W1_0:
    s_cbranch_execz W1_ret
    v_cvt_pk_bf16_f32 v118, v60, v72
    v_cvt_pk_bf16_f32 v122, v61, v73
    v_pk_mul_f32 v[104:105], v[72:73], v[110:111] op_sel:[0,0] op_sel_hi:[1,0]
    v_pk_fma_f32 v[60:61], v[72:73], v[110:111], v[104:105] op_sel:[1,1,0] op_sel_hi:[0,1,1] neg_lo:[1,0,0]
    v_pk_mul_f32 v[104:105], v[60:61], v[110:111] op_sel:[0,0] op_sel_hi:[1,0]
    v_pk_fma_f32 v[72:73], v[60:61], v[110:111], v[104:105] op_sel:[1,1,0] op_sel_hi:[0,1,1] neg_lo:[1,0,0]
    v_cvt_pk_bf16_f32 v119, v60, v72
    v_cvt_pk_bf16_f32 v123, v61, v73
    ds_write_b128 v86, v[116:119] offset:9216
    ds_write_b128 v86, v[120:123] offset:13312
    s_add_u32 m0, s75, 0x9000
    s_nop 0
    buffer_load_dwordx4 v47, s[48:51], s16 offen lds
    v_pk_mul_f32 v[104:105], v[72:73], v[110:111] op_sel:[0,0] op_sel_hi:[1,0]
    v_pk_fma_f32 v[60:61], v[72:73], v[110:111], v[104:105] op_sel:[1,1,0] op_sel_hi:[0,1,1] neg_lo:[1,0,0]
    v_pk_mul_f32 v[104:105], v[60:61], v[110:111] op_sel:[0,0] op_sel_hi:[1,0]
    v_pk_fma_f32 v[72:73], v[60:61], v[110:111], v[104:105] op_sel:[1,1,0] op_sel_hi:[0,1,1] neg_lo:[1,0,0]
    v_cvt_pk_bf16_f32 v116, v60, v72
    v_cvt_pk_bf16_f32 v120, v61, v73
    v_pk_mul_f32 v[104:105], v[72:73], v[110:111] op_sel:[0,0] op_sel_hi:[1,0]
    v_pk_fma_f32 v[60:61], v[72:73], v[110:111], v[104:105] op_sel:[1,1,0] op_sel_hi:[0,1,1] neg_lo:[1,0,0]
    v_pk_mul_f32 v[104:105], v[60:61], v[110:111] op_sel:[0,0] op_sel_hi:[1,0]
    v_pk_fma_f32 v[72:73], v[60:61], v[110:111], v[104:105] op_sel:[1,1,0] op_sel_hi:[0,1,1] neg_lo:[1,0,0]
    v_cvt_pk_bf16_f32 v117, v60, v72
    v_cvt_pk_bf16_f32 v121, v61, v73
    s_add_u32 m0, s75, 0xa000
    s_nop 0
    buffer_load_dwordx4 v47, s[48:51], s17 offen lds
    v_pk_mul_f32 v[104:105], v[72:73], v[110:111] op_sel:[0,0] op_sel_hi:[1,0]
    v_pk_fma_f32 v[60:61], v[72:73], v[110:111], v[104:105] op_sel:[1,1,0] op_sel_hi:[0,1,1] neg_lo:[1,0,0]
    v_pk_mul_f32 v[104:105], v[60:61], v[110:111] op_sel:[0,0] op_sel_hi:[1,0]
    v_pk_fma_f32 v[72:73], v[60:61], v[110:111], v[104:105] op_sel:[1,1,0] op_sel_hi:[0,1,1] neg_lo:[1,0,0]
    v_cvt_pk_bf16_f32 v118, v60, v72
    v_cvt_pk_bf16_f32 v122, v61, v73
    v_pk_mul_f32 v[104:105], v[72:73], v[110:111] op_sel:[0,0] op_sel_hi:[1,0]
    v_pk_fma_f32 v[60:61], v[72:73], v[110:111], v[104:105] op_sel:[1,1,0] op_sel_hi:[0,1,1] neg_lo:[1,0,0]
    v_pk_mul_f32 v[104:105], v[60:61], v[110:111] op_sel:[0,0] op_sel_hi:[1,0]
    v_pk_fma_f32 v[72:73], v[60:61], v[110:111], v[104:105] op_sel:[1,1,0] op_sel_hi:[0,1,1] neg_lo:[1,0,0]
    v_cvt_pk_bf16_f32 v119, v60, v72
    v_cvt_pk_bf16_f32 v123, v61, v73
    ds_write_b128 v87, v[116:119] offset:10240
    ds_write_b128 v87, v[120:123] offset:14336
    s_add_u32 m0, s75, 0xb000
    s_nop 0
    buffer_load_dwordx4 v47, s[48:51], s18 offen lds
    v_pk_mul_f32 v[104:105], v[72:73], v[110:111] op_sel:[0,0] op_sel_hi:[1,0]
    v_pk_fma_f32 v[60:61], v[72:73], v[110:111], v[104:105] op_sel:[1,1,0] op_sel_hi:[0,1,1] neg_lo:[1,0,0]
    v_pk_mul_f32 v[104:105], v[60:61], v[110:111] op_sel:[0,0] op_sel_hi:[1,0]
    v_pk_fma_f32 v[72:73], v[60:61], v[110:111], v[104:105] op_sel:[1,1,0] op_sel_hi:[0,1,1] neg_lo:[1,0,0]
    v_cvt_pk_bf16_f32 v116, v60, v72
    v_cvt_pk_bf16_f32 v120, v61, v73
    v_pk_mul_f32 v[104:105], v[72:73], v[110:111] op_sel:[0,0] op_sel_hi:[1,0]
    v_pk_fma_f32 v[60:61], v[72:73], v[110:111], v[104:105] op_sel:[1,1,0] op_sel_hi:[0,1,1] neg_lo:[1,0,0]
    v_pk_mul_f32 v[104:105], v[60:61], v[110:111] op_sel:[0,0] op_sel_hi:[1,0]
    v_pk_fma_f32 v[72:73], v[60:61], v[110:111], v[104:105] op_sel:[1,1,0] op_sel_hi:[0,1,1] neg_lo:[1,0,0]
    v_cvt_pk_bf16_f32 v117, v60, v72
    v_cvt_pk_bf16_f32 v121, v61, v73
    s_add_u32 m0, s75, 0xc000
    s_nop 0
    buffer_load_dwordx4 v47, s[48:51], s19 offen lds
    v_pk_mul_f32 v[104:105], v[72:73], v[110:111] op_sel:[0,0] op_sel_hi:[1,0]
    v_pk_fma_f32 v[60:61], v[72:73], v[110:111], v[104:105] op_sel:[1,1,0] op_sel_hi:[0,1,1] neg_lo:[1,0,0]
    v_pk_mul_f32 v[104:105], v[60:61], v[110:111] op_sel:[0,0] op_sel_hi:[1,0]
    v_pk_fma_f32 v[72:73], v[60:61], v[110:111], v[104:105] op_sel:[1,1,0] op_sel_hi:[0,1,1] neg_lo:[1,0,0]
    v_cvt_pk_bf16_f32 v118, v60, v72
    v_cvt_pk_bf16_f32 v122, v61, v73
    v_pk_mul_f32 v[104:105], v[72:73], v[110:111] op_sel:[0,0] op_sel_hi:[1,0]
    v_pk_fma_f32 v[60:61], v[72:73], v[110:111], v[104:105] op_sel:[1,1,0] op_sel_hi:[0,1,1] neg_lo:[1,0,0]
    v_pk_mul_f32 v[104:105], v[60:61], v[110:111] op_sel:[0,0] op_sel_hi:[1,0]
    v_pk_fma_f32 v[72:73], v[60:61], v[110:111], v[104:105] op_sel:[1,1,0] op_sel_hi:[0,1,1] neg_lo:[1,0,0]
    v_cvt_pk_bf16_f32 v119, v60, v72
    v_cvt_pk_bf16_f32 v123, v61, v73
    ds_write_b128 v88, v[116:119] offset:11264
    ds_write_b128 v88, v[120:123] offset:15360
    s_add_u32 m0, s75, 0xd000
    s_nop 0
    buffer_load_dwordx4 v47, s[48:51], s20 offen lds
    ds_read_b64_tr_b16 v[116:117], v89
    ds_read_b64_tr_b16 v[118:119], v89 offset:4096
    ds_read_b64_tr_b16 v[128:129], v91 offset:8192
    ds_read_b64_tr_b16 v[130:131], v91 offset:12288
    ds_read_b64_tr_b16 v[120:121], v90
    ds_read_b64_tr_b16 v[122:123], v90 offset:4096
    ds_read_b64_tr_b16 v[132:133], v92 offset:8192
    ds_read_b64_tr_b16 v[134:135], v92 offset:12288
    s_lshl_b32 s68, s2, 5
    s_add_u32 s68, s68, 0x1000
    v_min_u32_e32 v2, 1, v0
    v_mov_b32_e32 v1, s61
    v_lshlrev_b32_e32 v2, 30, v2
    v_mov_b32_e32 v3, 0
    v_writelane_b32 v3, s62, 0
    s_waitcnt vmcnt(6) lgkmcnt(8)
    s_barrier
    buffer_store_dword v1, v2, s[36:39], s68 offen sc1
    ds_read_b64_tr_b16 v[124:125], v89 offset:256
    ds_read_b64_tr_b16 v[126:127], v89 offset:4352
    ds_read_b64_tr_b16 v[136:137], v91 offset:8448
    ds_read_b64_tr_b16 v[138:139], v91 offset:12544
    s_waitcnt lgkmcnt(8)
    v_mfma_f32_32x32x16_bf16 v[64:79], v[116:119], v[128:131], 0
    ds_read_b64_tr_b16 v[116:117], v90 offset:256
    ds_read_b64_tr_b16 v[118:119], v90 offset:4352
    ds_read_b64_tr_b16 v[128:129], v92 offset:8448
    ds_read_b64_tr_b16 v[130:131], v92 offset:12544
    s_waitcnt lgkmcnt(8)
    v_mfma_f32_32x32x16_bf16 v[64:79], v[120:123], v[132:135], v[64:79]
    s_add_u32 m0, s75, 0xe000
    s_nop 0
    buffer_load_dwordx4 v47, s[48:51], s21 offen lds
    ds_read_b64_tr_b16 v[120:121], v89 offset:512
    ds_read_b64_tr_b16 v[122:123], v89 offset:4608
    ds_read_b64_tr_b16 v[132:133], v91 offset:8704
    ds_read_b64_tr_b16 v[134:135], v91 offset:12800
    s_waitcnt lgkmcnt(8)
    v_mfma_f32_32x32x16_bf16 v[64:79], v[124:127], v[136:139], v[64:79]
    ds_read_b64_tr_b16 v[124:125], v90 offset:512
    ds_read_b64_tr_b16 v[126:127], v90 offset:4608
    ds_read_b64_tr_b16 v[136:137], v92 offset:8704
    ds_read_b64_tr_b16 v[138:139], v92 offset:12800
    s_waitcnt lgkmcnt(8)
    v_mfma_f32_32x32x16_bf16 v[64:79], v[116:119], v[128:131], v[64:79]
    ds_read_b64_tr_b16 v[116:117], v89 offset:768
    ds_read_b64_tr_b16 v[118:119], v89 offset:4864
    ds_read_b64_tr_b16 v[128:129], v91 offset:8960
    ds_read_b64_tr_b16 v[130:131], v91 offset:13056
    s_waitcnt lgkmcnt(8)
    v_mfma_f32_32x32x16_bf16 v[64:79], v[120:123], v[132:135], v[64:79]
    s_add_u32 m0, s75, 0xf000
    s_nop 0
    buffer_load_dwordx4 v47, s[48:51], s22 offen lds
    ds_read_b64_tr_b16 v[120:121], v90 offset:768
    ds_read_b64_tr_b16 v[122:123], v90 offset:4864
    ds_read_b64_tr_b16 v[132:133], v92 offset:8960
    ds_read_b64_tr_b16 v[134:135], v92 offset:13056
    s_waitcnt lgkmcnt(8)
    v_mfma_f32_32x32x16_bf16 v[64:79], v[124:127], v[136:139], v[64:79]
    v_xor_b32_e32 v89, 0x4000, v89
    v_xor_b32_e32 v90, 0x4000, v90
    v_xor_b32_e32 v91, 0x4000, v91
    v_xor_b32_e32 v92, 0x4000, v92
    ds_read_b64_tr_b16 v[124:125], v89
    ds_read_b64_tr_b16 v[126:127], v89 offset:4096
    ds_read_b64_tr_b16 v[136:137], v91 offset:8192
    ds_read_b64_tr_b16 v[138:139], v91 offset:12288
    s_waitcnt lgkmcnt(8)
    v_mfma_f32_32x32x16_bf16 v[64:79], v[116:119], v[128:131], v[64:79]
    ds_read_b64_tr_b16 v[116:117], v90
    ds_read_b64_tr_b16 v[118:119], v90 offset:4096
    ds_read_b64_tr_b16 v[128:129], v92 offset:8192
    ds_read_b64_tr_b16 v[130:131], v92 offset:12288
    s_waitcnt lgkmcnt(8)
    v_mfma_f32_32x32x16_bf16 v[64:79], v[120:123], v[132:135], v[64:79]
    v_add_u32_e32 v47, 0x400, v46
    s_add_u32 m0, s75, 0x0
    s_nop 0
    buffer_load_dwordx4 v47, s[48:51], s15 offen lds
    ds_read_b64_tr_b16 v[120:121], v89 offset:256
    ds_read_b64_tr_b16 v[122:123], v89 offset:4352
    ds_read_b64_tr_b16 v[132:133], v91 offset:8448
    ds_read_b64_tr_b16 v[134:135], v91 offset:12544
    s_waitcnt lgkmcnt(8)
    v_mfma_f32_32x32x16_bf16 v[100:115], v[124:127], v[136:139], 0
    ds_read_b64_tr_b16 v[124:125], v90 offset:256
    ds_read_b64_tr_b16 v[126:127], v90 offset:4352
    ds_read_b64_tr_b16 v[136:137], v92 offset:8448
    ds_read_b64_tr_b16 v[138:139], v92 offset:12544
    s_waitcnt lgkmcnt(8)
    v_mfma_f32_32x32x16_bf16 v[100:115], v[116:119], v[128:131], v[100:115]
    ds_read_b64_tr_b16 v[116:117], v89 offset:512
    ds_read_b64_tr_b16 v[118:119], v89 offset:4608
    ds_read_b64_tr_b16 v[128:129], v91 offset:8704
    ds_read_b64_tr_b16 v[130:131], v91 offset:12800
    s_waitcnt lgkmcnt(8)
    v_mfma_f32_32x32x16_bf16 v[100:115], v[120:123], v[132:135], v[100:115]
    s_add_u32 m0, s75, 0x1000
    s_nop 0
    buffer_load_dwordx4 v47, s[48:51], s16 offen lds
    ds_read_b64_tr_b16 v[120:121], v90 offset:512
    ds_read_b64_tr_b16 v[122:123], v90 offset:4608
    ds_read_b64_tr_b16 v[132:133], v92 offset:8704
    ds_read_b64_tr_b16 v[134:135], v92 offset:12800
    s_waitcnt lgkmcnt(8)
    v_mfma_f32_32x32x16_bf16 v[100:115], v[124:127], v[136:139], v[100:115]
    ds_read_b64_tr_b16 v[124:125], v89 offset:768
    ds_read_b64_tr_b16 v[126:127], v89 offset:4864
    ds_read_b64_tr_b16 v[136:137], v91 offset:8960
    ds_read_b64_tr_b16 v[138:139], v91 offset:13056
    s_waitcnt lgkmcnt(8)
    v_mfma_f32_32x32x16_bf16 v[100:115], v[116:119], v[128:131], v[100:115]
    ds_read_b64_tr_b16 v[116:117], v90 offset:768
    ds_read_b64_tr_b16 v[118:119], v90 offset:4864
    ds_read_b64_tr_b16 v[128:129], v92 offset:8960
    ds_read_b64_tr_b16 v[130:131], v92 offset:13056
    s_waitcnt lgkmcnt(8)
    v_mfma_f32_32x32x16_bf16 v[100:115], v[120:123], v[132:135], v[100:115]
    s_add_u32 m0, s75, 0x2000
    s_nop 0
    buffer_load_dwordx4 v47, s[48:51], s17 offen lds
    s_waitcnt lgkmcnt(4)
    v_mfma_f32_32x32x16_bf16 v[100:115], v[124:127], v[136:139], v[100:115]
    s_waitcnt lgkmcnt(0)
    v_mfma_f32_32x32x16_bf16 v[100:115], v[116:119], v[128:131], v[100:115]
    s_barrier
    v_lshrrev_b32_e32 v4, 4, v0
    v_mul_u32_u24_e32 v4, 0xc00, v4
    s_lshr_b32 s70, s2, 3
    s_mul_i32 s70, s70, 49152
    buffer_load_dword v59, v4, s[48:51], s70 offen offset:2432
    s_add_u32 s68, s75, 0x21000
    v_add_u32_e32 v1, s68, v6
    ds_write_b128 v1, v[80:83]
    ds_read_b64_tr_b16 v[80:81], v63
    ds_read_b64_tr_b16 v[82:83], v84
    s_add_u32 m0, s75, 0x3000
    s_nop 0
    buffer_load_dwordx4 v47, s[48:51], s18 offen lds
    v_pk_add_f32 v[76:77], v[76:77], v[112:113]
    v_pk_add_f32 v[74:75], v[74:75], v[110:111]
    v_pk_add_f32 v[72:73], v[72:73], v[108:109]
    v_pk_add_f32 v[70:71], v[70:71], v[106:107]
    v_pk_add_f32 v[68:69], v[68:69], v[104:105]
    v_pk_add_f32 v[66:67], v[66:67], v[102:103]
    v_pk_add_f32 v[64:65], v[64:65], v[100:101]
    v_cvt_pk_bf16_f32 v112, v77, v76
    ds_write_b32 v95, v112
    v_cndmask_b32_e64 v113, v74, v75, s[26:27]
    v_cndmask_b32_e64 v114, v73, v74, s[26:27]
    v_cvt_pk_bf16_f32 v100, v75, v75
    v_cvt_pk_bf16_f32 v101, v113, v74
    v_cvt_pk_bf16_f32 v102, v74, v114
    v_cvt_pk_bf16_f32 v103, v73, v73
    ds_write_b128 v93, v[100:103]
    s_add_u32 m0, s75, 0x4000
    s_nop 0
    buffer_load_dwordx4 v47, s[48:51], s19 offen lds
    v_add_f32_e64 v64, v64, v3
    v_cndmask_b32_e64 v113, 0, v75, s[30:31]
    v_cndmask_b32_e64 v114, 0, v64, s[28:29]
    v_cndmask_b32_e64 v115, v113, 0, s[26:27]
    v_cvt_pk_bf16_f32 v104, v114, 0
    v_cvt_pk_bf16_f32 v105, 0, v115
    v_cvt_pk_bf16_f32 v106, v113, v113
    v_cvt_pk_bf16_f32 v107, v113, v113
    ds_write_b128 v94, v[104:107]
    s_add_u32 m0, s75, 0x5000
    s_nop 0
    buffer_load_dwordx4 v47, s[48:51], s20 offen lds
    v_cndmask_b32_e64 v65, v65, v64, s[24:25]
    v_cndmask_b32_e64 v67, v67, v68, s[24:25]
    v_cndmask_b32_e64 v69, v69, v68, s[24:25]
    v_cndmask_b32_e64 v71, v71, v72, s[24:25]
    v_cndmask_b32_e64 v64, v64, v65, s[26:27]
    v_cndmask_b32_e64 v65, v65, v66, s[26:27]
    v_cndmask_b32_e64 v66, v66, v67, s[26:27]
    v_cndmask_b32_e64 v67, v67, v68, s[26:27]
    v_cndmask_b32_e64 v68, v68, v69, s[26:27]
    v_cndmask_b32_e64 v69, v69, v70, s[26:27]
    v_cndmask_b32_e64 v70, v70, v71, s[26:27]
    v_cndmask_b32_e64 v71, v71, v72, s[26:27]
    v_cvt_pk_bf16_f32 v108, v71, v70
    v_cvt_pk_bf16_f32 v109, v69, v68
    v_cvt_pk_bf16_f32 v110, v67, v66
    v_cvt_pk_bf16_f32 v111, v65, v64
    ds_write_b128 v93, v[108:111] offset:1024
    v_add_u32_e32 v1, 0x1ac00, v13
    ds_write_b128 v1, v[96:99]
    s_add_u32 m0, s75, 0x6000
    s_nop 0
    buffer_load_dwordx4 v47, s[48:51], s21 offen lds
    s_add_u32 m0, s75, 0x7000
    s_nop 0
    buffer_load_dwordx4 v47, s[48:51], s22 offen lds
    v_lshlrev_b32_e32 v61, 5, v0
    s_mov_b32 s69, 4096
    buffer_load_dword v60, v61, s[36:39], s69 offen sc1
    s_add_u32 s71, s74, 0x0
    buffer_store_dwordx4 v[22:25], v11, s[36:39], s71 offen sc1
    s_add_u32 s71, s74, 0x101000
    buffer_store_dwordx4 v[22:25], v11, s[36:39], s71 offen sc1
    s_waitcnt lgkmcnt(5)
    buffer_store_dwordx4 v[80:83], v6, s[36:39], s76 offen sc1
    s_mov_b32 s24, 0x8000
    s_mov_b32 s25, 0xa000
    s_mov_b32 s26, 0xc000
    s_mov_b32 s27, 0xe000
    s_mov_b32 s29, 0x9000
    s_mov_b32 s30, 0xb000
    s_mov_b32 s31, 0xd000
    s_mov_b32 s52, 0xf000
    s_mul_i32 s68, s57, 8320
    s_add_u32 s28, s68, 0x300000
    s_add_u32 s53, s68, 0x301000
    v_and_b32_e32 v3, 1, v0
    v_lshrrev_b32_e32 v2, 1, v53
    v_mul_u32_u24_e32 v2, 32896, v2
    v_lshl_add_u32 v2, v3, 5, v2
    v_lshl_add_u32 v12, v54, 3, v2
    s_mul_i32 s70, s65, 5120
    s_add_u32 s71, s70, 0x12520
    v_lshl_add_u32 v1, v53, 1, v54
    v_lshl_add_u32 v15, v1, 4, s71
    v_lshlrev_b32_e32 v4, 2, v54
    v_sub_u32_e32 v1, v4, v53
    s_add_u32 s71, s70, 0x1243c
    v_lshl_add_u32 v18, v1, 2, s71
    v_lshl_add_u32 v1, v53, 2, v54
    v_lshlrev_b32_e32 v20, 4, v1
    s_mov_b32 s68, 0x12700
    v_lshl_add_u32 v16, v0, 3, s68
    s_lshl_b32 s68, s65, 13
    s_add_u32 s68, s68, 0x14c00
    v_add_u32_e64 v17, s68, v6
    v_cmp_eq_u32_e64 s[32:33], v58, v54
    v_add_u32_e32 v50, 0x20000, v48
    v_add_u32_e32 v51, 0x20000, v49
    s_lshl_b32 s70, s56, 11
    v_add_u32_e32 v30, s70, v6
    v_and_b32_e32 v3, 16, v0
    v_lshlrev_b32_e32 v3, 1, v3
    v_xor_b32_e32 v29, v3, v30
    s_waitcnt lgkmcnt(0)
    s_barrier
    s_lshl_b32 s68, s66, 8
    s_sub_u32 s68, 0x100, s68
    v_add_u32_e64 v1, s68, v14
    v_add_u32_e32 v2, 0x400, v1
    ds_read2_b32 v[52:53], v2 offset0:192 offset1:193
    ds_read2_b32 v[54:55], v2 offset0:194 offset1:195
    ds_read2_b32 v[104:105], v2 offset0:64 offset1:65
    ds_read2_b32 v[106:107], v2 offset0:66 offset1:67
    ds_read2_b32 v[108:109], v1 offset0:192 offset1:193
    ds_read2_b32 v[110:111], v1 offset0:194 offset1:195
    ds_read2_b32 v[112:113], v1 offset0:64 offset1:65
    ds_read2_b32 v[114:115], v1 offset0:66 offset1:67
    ds_read2_b32 v[116:117], v2 offset0:176 offset1:177
    ds_read2_b32 v[118:119], v2 offset0:178 offset1:179
    ds_read2_b32 v[120:121], v2 offset0:48 offset1:49
    ds_read2_b32 v[122:123], v2 offset0:50 offset1:51
    ds_read2_b32 v[124:125], v1 offset0:176 offset1:177
    ds_read2_b32 v[126:127], v1 offset0:178 offset1:179
    ds_read2_b32 v[128:129], v1 offset0:48 offset1:49
    ds_read2_b32 v[130:131], v1 offset0:50 offset1:51
    ds_read2_b32 v[132:133], v2 offset0:160 offset1:161
    ds_read2_b32 v[134:135], v2 offset0:162 offset1:163
    ds_read2_b32 v[136:137], v2 offset0:32 offset1:33
    ds_read2_b32 v[138:139], v2 offset0:34 offset1:35
    ds_read2_b32 v[140:141], v1 offset0:160 offset1:161
    ds_read2_b32 v[142:143], v1 offset0:162 offset1:163
    ds_read2_b32 v[144:145], v1 offset0:32 offset1:33
    ds_read2_b32 v[146:147], v1 offset0:34 offset1:35
    ds_read2_b32 v[148:149], v2 offset0:144 offset1:145
    ds_read2_b32 v[150:151], v2 offset0:146 offset1:147
    ds_read2_b32 v[152:153], v2 offset0:16 offset1:17
    ds_read2_b32 v[154:155], v2 offset0:18 offset1:19
    ds_read2_b32 v[156:157], v1 offset0:144 offset1:145
    ds_read2_b32 v[158:159], v1 offset0:146 offset1:147
    ds_read2_b32 v[160:161], v1 offset0:16 offset1:17
    ds_read2_b32 v[162:163], v1 offset0:18 offset1:19
    v_add_u32_e32 v56, 0x1ac00, v6
    ds_read_b128 v[164:167], v56 offset:2048
    s_lshl_b32 s68, s65, 10
    v_add_u32_e32 v57, s68, v56
    v_add_u32_e32 v3, 0x18c00, v13
    v_add_u32_e32 v4, 0x18c00, v20
    s_mul_i32 s68, s58, 32896
    s_add_u32 s82, s68, 0xc00000
    s_add_u32 s83, s68, 0xc02000
    s_add_u32 s84, s68, 0xc04000
    s_add_u32 s85, s68, 0xc06000
    s_add_u32 s86, s68, 0xd01000
    s_add_u32 s87, s68, 0xd03000
    s_add_u32 s88, s68, 0xd05000
    s_add_u32 s89, s68, 0xd07000
    s_lshl_b32 s90, s56, 11
    s_branch chk_5
retry_4:
    s_cmp_eq_u32 s63, 0
    s_cbranch_scc1 ok_6
    s_sub_u32 s63, s63, 1
    s_mov_b64 exec, vcc
    buffer_load_dword v60, v61, s[36:39], s69 offen sc1
    s_mov_b64 exec, -1
    s_waitcnt vmcnt(0)
chk_5:
    s_waitcnt vmcnt(3)
    v_cmp_ne_u32_e32 vcc, s61, v60
    s_cbranch_vccnz retry_4
ok_6:
    s_barrier
    buffer_load_dwordx4 v[64:67], v13, s[36:39], s24 offen sc1
    buffer_load_dwordx4 v[68:71], v13, s[36:39], s25 offen sc1
    buffer_load_dwordx4 v[72:75], v13, s[36:39], s26 offen sc1
    buffer_load_dwordx4 v[76:79], v13, s[36:39], s27 offen sc1
    buffer_load_dwordx4 v[96:99], v13, s[36:39], s28 offen sc1
    ds_read_b64_tr_b16 a[32:33], v48 offset:32768
    ds_read_b64_tr_b16 a[34:35], v48 offset:34816
    ds_read_b64_tr_b16 a[36:37], v48 offset:36864
    ds_read_b64_tr_b16 a[38:39], v48 offset:38912
    ds_read_b64_tr_b16 a[40:41], v48 offset:40960
    ds_read_b64_tr_b16 a[42:43], v48 offset:43008
    ds_read_b64_tr_b16 a[44:45], v48 offset:45056
    ds_read_b64_tr_b16 a[46:47], v48 offset:47104
    ds_read_b64_tr_b16 a[48:49], v49 offset:32768
    ds_read_b64_tr_b16 a[50:51], v49 offset:34816
    ds_read_b64_tr_b16 a[52:53], v49 offset:36864
    ds_read_b64_tr_b16 a[54:55], v49 offset:38912
    ds_read_b64_tr_b16 a[56:57], v49 offset:40960
    ds_read_b64_tr_b16 a[58:59], v49 offset:43008
    ds_read_b64_tr_b16 a[60:61], v49 offset:45056
    ds_read_b64_tr_b16 a[62:63], v49 offset:47104
    ds_read_b64_tr_b16 a[0:1], v48
    ds_read_b64_tr_b16 a[2:3], v48 offset:2048
    ds_read_b64_tr_b16 a[4:5], v48 offset:4096
    ds_read_b64_tr_b16 a[6:7], v48 offset:6144
    ds_read_b64_tr_b16 a[8:9], v48 offset:8192
    ds_read_b64_tr_b16 a[10:11], v48 offset:10240
    ds_read_b64_tr_b16 a[12:13], v48 offset:12288
    ds_read_b64_tr_b16 a[14:15], v48 offset:14336
    ds_read_b64_tr_b16 a[16:17], v49
    ds_read_b64_tr_b16 a[18:19], v49 offset:2048
    ds_read_b64_tr_b16 a[20:21], v49 offset:4096
    ds_read_b64_tr_b16 a[22:23], v49 offset:6144
    ds_read_b64_tr_b16 a[24:25], v49 offset:8192
    ds_read_b64_tr_b16 a[26:27], v49 offset:10240
    ds_read_b64_tr_b16 a[28:29], v49 offset:12288
    ds_read_b64_tr_b16 a[30:31], v49 offset:14336
    s_mov_b64 exec, 0
    s_cmp_eq_u32 s56, 0
    s_cbranch_scc1 W2_0
    s_cmp_eq_u32 s56, 1
    s_cbranch_scc1 W2_1
    s_cmp_eq_u32 s56, 2
    s_cbranch_scc1 W2_2
    s_branch W2_3
W2_ret:
    s_mov_b64 exec, -1
    v_add_u32_e32 v47, 0x800, v46
    s_add_u32 m0, s75, 0x20000
    s_nop 0
    buffer_load_dwordx4 v47, s[48:51], s15 offen lds
    s_add_u32 m0, s75, 0x21000
    s_nop 0
    buffer_load_dwordx4 v47, s[48:51], s16 offen lds
    s_add_u32 m0, s75, 0x22000
    s_nop 0
    buffer_load_dwordx4 v47, s[48:51], s17 offen lds
    s_add_u32 m0, s75, 0x23000
    s_nop 0
    buffer_load_dwordx4 v47, s[48:51], s18 offen lds
    s_cmp_lg_u32 s66, 0
    s_cbranch_scc1 arm_7
    s_add_u32 s91, s74, 0x0
    s_add_u32 s92, s74, 0xc0c00
    s_add_u32 s93, s74, 0x101000
    s_add_u32 s94, s74, 0x1c1c00
    s_waitcnt vmcnt(8) lgkmcnt(15)
    v_mfma_f32_16x16x32_bf16 v[168:171], v[164:167], v[64:67], 0
    s_waitcnt vmcnt(7)
    v_mfma_f32_16x16x32_bf16 v[168:171], v[164:167], v[68:71], v[168:171]
    s_waitcnt vmcnt(6)
    v_mfma_f32_16x16x32_bf16 v[168:171], v[164:167], v[72:75], v[168:171]
    s_waitcnt vmcnt(5)
    v_mfma_f32_16x16x32_bf16 v[168:171], v[164:167], v[76:79], v[168:171]
    s_waitcnt vmcnt(4)
    v_lshlrev_b32_e32 v172, 16, v96
    v_lshlrev_b32_e64 v173, 16, v97
    v_dot2_f32_bf16 v60, v64, v64, s6
    v_dot2_f32_bf16 v61, v65, v65, s6
    v_dot2_f32_bf16 v62, v66, v66, s6
    v_dot2_f32_bf16 v63, v67, v67, s6
    v_dot2_f32_bf16 v60, v68, v68, v60
    v_dot2_f32_bf16 v61, v69, v69, v61
    v_dot2_f32_bf16 v62, v70, v70, v62
    v_dot2_f32_bf16 v63, v71, v71, v63
    v_dot2_f32_bf16 v60, v72, v72, v60
    v_dot2_f32_bf16 v61, v73, v73, v61
    v_dot2_f32_bf16 v62, v74, v74, v62
    v_dot2_f32_bf16 v63, v75, v75, v63
    v_dot2_f32_bf16 v60, v76, v76, v60
    v_dot2_f32_bf16 v61, v77, v77, v61
    v_dot2_f32_bf16 v62, v78, v78, v62
    v_dot2_f32_bf16 v63, v79, v79, v63
    ds_write_b128 v3, v[96:99]
    v_pk_mul_f32 v[168:169], v[168:169], 0.5 op_sel_hi:[1,0]
    v_pk_mul_f32 v[170:171], v[170:171], 0.5 op_sel_hi:[1,0]
    v_lshlrev_b32_e32 v174, 16, v98
    v_pk_fma_f32 v[60:61], v[168:169], v[168:169], v[60:61] neg_lo:[1,0,0] neg_hi:[1,0,0]
    v_pk_fma_f32 v[62:63], v[170:171], v[170:171], v[62:63] neg_lo:[1,0,0] neg_hi:[1,0,0]
    v_rsq_f32_e32 v60, v60
    v_rsq_f32_e32 v61, v61
    v_rsq_f32_e32 v62, v62
    v_rsq_f32_e32 v63, v63
    v_lshlrev_b32_e32 v175, 16, v99
    v_and_b32_e32 v176, s5, v96
    v_and_b32_e32 v177, s5, v97
    v_and_b32_e32 v178, s5, v98
    v_and_b32_e32 v179, s5, v99
    v_pk_mul_f32 v[168:169], v[168:169], v[60:61] neg_lo:[1,0] neg_hi:[1,0]
    v_pk_mul_f32 v[170:171], v[170:171], v[62:63] neg_lo:[1,0] neg_hi:[1,0]
    v_pk_fma_f32 v[172:173], v[172:173], v[60:61], v[168:169]
    v_pk_fma_f32 v[174:175], v[174:175], v[62:63], v[170:171]
    v_pk_fma_f32 v[176:177], v[176:177], v[60:61], v[168:169]
    v_pk_fma_f32 v[178:179], v[178:179], v[62:63], v[170:171]
    v_cvt_pk_bf16_f32 v96, v172, v173
    v_cvt_pk_bf16_f32 v97, v174, v175
    v_cvt_pk_bf16_f32 v98, v176, v177
    v_cvt_pk_bf16_f32 v99, v178, v179
    ds_write2st64_b64 v16, v[96:97], v[98:99] offset0:0 offset1:10
    buffer_load_dwordx4 v[80:83], v13, s[36:39], s29 offen sc1
    buffer_load_dwordx4 v[84:87], v13, s[36:39], s30 offen sc1
    buffer_load_dwordx4 v[88:91], v13, s[36:39], s31 offen sc1
    buffer_load_dwordx4 v[92:95], v13, s[36:39], s52 offen sc1
    buffer_load_dwordx4 v[100:103], v13, s[36:39], s53 offen sc1
    s_add_u32 m0, s75, 0x24000
    s_nop 0
    buffer_load_dwordx4 v47, s[48:51], s19 offen lds
    s_lshl_b32 s68, s2, 5
    s_add_u32 s68, s68, 0x3000
    v_min_u32_e32 v2, 1, v0
    v_mov_b32_e32 v1, s61
    v_lshlrev_b32_e32 v2, 30, v2
    s_waitcnt lgkmcnt(0)
    s_barrier
    buffer_store_dword v1, v2, s[36:39], s68 offen sc1
    ds_read_b128 v[76:79], v15 offset:448
    ds_read_b128 v[96:99], v15 offset:960
    ds_read_b128 v[168:171], v15 offset:1472
    ds_read_b128 v[172:175], v15 offset:384
    s_waitcnt lgkmcnt(3)
    v_mfma_f32_16x16x32_bf16 v[64:67], v[104:107], v[76:79], 0
    ds_read_b128 v[176:179], v15 offset:896
    s_add_u32 m0, s75, 0x25000
    v_mfma_f32_16x16x32_bf16 v[68:71], v[108:111], v[76:79], 0
    ds_read_b128 v[180:183], v15 offset:1408
    s_waitcnt lgkmcnt(4)
    v_mfma_f32_16x16x32_bf16 v[64:67], v[52:55], v[96:99], v[64:67]
    ds_read_b128 v[184:187], v15 offset:320
    buffer_load_dwordx4 v47, s[48:51], s20 offen lds
    v_mfma_f32_16x16x32_bf16 v[68:71], v[104:107], v[96:99], v[68:71]
    ds_read_b128 v[192:195], v15 offset:832
    s_waitcnt lgkmcnt(5)
    v_mfma_f32_16x16x32_bf16 v[68:71], v[52:55], v[168:171], v[68:71]
    s_add_u32 m0, s75, 0x26000
    s_waitcnt lgkmcnt(4)
    v_mfma_f32_16x16x32_bf16 v[64:67], v[120:123], v[172:175], v[64:67]
    ds_read_b128 v[196:199], v15 offset:1344
    v_mfma_f32_16x16x32_bf16 v[68:71], v[124:127], v[172:175], v[68:71]
    buffer_load_dwordx4 v47, s[48:51], s21 offen lds
    s_waitcnt lgkmcnt(4)
    v_mfma_f32_16x16x32_bf16 v[64:67], v[116:119], v[176:179], v[64:67]
    ds_read_b128 v[200:203], v15 offset:256
    v_mfma_f32_16x16x32_bf16 v[68:71], v[120:123], v[176:179], v[68:71]
    s_add_u32 m0, s75, 0x27000
    s_waitcnt lgkmcnt(3)
    v_mfma_f32_16x16x32_bf16 v[68:71], v[116:119], v[180:183], v[68:71]
    ds_read_b128 v[204:207], v15 offset:768
    v_mfma_f32_16x16x32_bf16 v[64:67], v[136:139], v[184:187], v[64:67]
    buffer_load_dwordx4 v47, s[48:51], s22 offen lds
    v_add_u32_e32 v47, 0xc0800, v46
    v_mfma_f32_16x16x32_bf16 v[68:71], v[140:143], v[184:187], v[68:71]
    ds_read_b128 v[208:211], v15 offset:1280
    s_waitcnt lgkmcnt(3)
    v_mfma_f32_16x16x32_bf16 v[64:67], v[132:135], v[192:195], v[64:67]
    ds_read_b128 v[212:215], v15 offset:1792
    v_mfma_f32_16x16x32_bf16 v[68:71], v[136:139], v[192:195], v[68:71]
    ds_read_b128 v[76:79], v15 offset:320
    v_mfma_f32_16x16x32_bf16 v[68:71], v[132:135], v[196:199], v[68:71]
    ds_read_b128 v[96:99], v15 offset:832
    s_waitcnt lgkmcnt(5)
    v_mfma_f32_16x16x32_bf16 v[64:67], v[152:155], v[200:203], v[64:67]
    ds_read_b128 v[168:171], v15 offset:1344
    v_mfma_f32_16x16x32_bf16 v[68:71], v[156:159], v[200:203], v[68:71]
    s_add_u32 m0, s75, 0x8000
    s_waitcnt lgkmcnt(5)
    v_mfma_f32_16x16x32_bf16 v[64:67], v[148:151], v[204:207], v[64:67]
W2_0:
    s_cbranch_execz W2_4
    buffer_load_dwordx4 v47, s[48:51], s15 offen lds
    ds_read_b128 v[172:175], v15 offset:1856
    v_mfma_f32_16x16x32_bf16 v[68:71], v[152:155], v[204:207], v[68:71]
    ds_read_b128 v[176:179], v15 offset:384
    s_waitcnt lgkmcnt(5)
    v_mfma_f32_16x16x32_bf16 v[68:71], v[148:151], v[208:211], v[68:71]
    ds_read_b128 v[180:183], v15 offset:896
    v_mfma_f32_16x16x32_bf16 v[60:63], v[148:151], v[200:203], 0
    ds_read_b128 v[184:187], v15 offset:1408
    v_mfma_f32_16x16x32_bf16 v[72:75], v[160:163], v[200:203], 0
    ds_read_b128 v[192:195], v15 offset:1920
    v_mfma_f32_16x16x32_bf16 v[72:75], v[156:159], v[204:207], v[72:75]
    ds_write_b128 v17, v[64:67] offset:1024
    v_mfma_f32_16x16x32_bf16 v[72:75], v[152:155], v[208:211], v[72:75]
    s_add_u32 m0, s75, 0x9000
    s_nop 0
    buffer_load_dwordx4 v47, s[48:51], s16 offen lds
    v_mfma_f32_16x16x32_bf16 v[72:75], v[148:151], v[212:215], v[72:75]
    s_waitcnt lgkmcnt(4)
    v_mfma_f32_16x16x32_bf16 v[60:63], v[132:135], v[76:79], v[60:63]
    ds_write_b128 v17, v[68:71] offset:2048
    v_mfma_f32_16x16x32_bf16 v[72:75], v[144:147], v[76:79], v[72:75]
    v_mfma_f32_16x16x32_bf16 v[72:75], v[140:143], v[96:99], v[72:75]
    v_mfma_f32_16x16x32_bf16 v[72:75], v[136:139], v[168:171], v[72:75]
    ds_read_b128 v[196:199], v15 offset:448
    v_mfma_f32_16x16x32_bf16 v[72:75], v[132:135], v[172:175], v[72:75]
    ds_read_b128 v[200:203], v15 offset:960
    s_add_u32 m0, s75, 0xa000
    v_mfma_f32_16x16x32_bf16 v[60:63], v[116:119], v[176:179], v[60:63]
    ds_read_b128 v[204:207], v15 offset:1472
    buffer_load_dwordx4 v47, s[48:51], s17 offen lds
    v_mfma_f32_16x16x32_bf16 v[72:75], v[128:131], v[176:179], v[72:75]
    ds_read_b128 v[208:211], v15 offset:1984
    s_waitcnt lgkmcnt(4)
    v_mfma_f32_16x16x32_bf16 v[72:75], v[124:127], v[180:183], v[72:75]
    ds_read_b128 v[212:215], v57 offset:2048
    v_mfma_f32_16x16x32_bf16 v[72:75], v[120:123], v[184:187], v[72:75]
    ds_read_b128 v[76:79], v4
    v_mfma_f32_16x16x32_bf16 v[72:75], v[116:119], v[192:195], v[72:75]
    ds_read_b128 v[96:99], v4 offset:3072
    s_waitcnt lgkmcnt(6)
    v_mfma_f32_16x16x32_bf16 v[60:63], v[52:55], v[196:199], v[60:63]
    s_barrier
    ds_read_b128 v[64:67], v17
    v_mfma_f32_16x16x32_bf16 v[72:75], v[112:115], v[196:199], v[72:75]
    ds_read_b128 v[68:71], v17 offset:3072
    s_waitcnt lgkmcnt(6)
    v_mfma_f32_16x16x32_bf16 v[72:75], v[108:111], v[200:203], v[72:75]
    s_add_u32 m0, s75, 0xb000
    s_nop 0
    buffer_load_dwordx4 v47, s[48:51], s18 offen lds
    v_mfma_f32_16x16x32_bf16 v[72:75], v[104:107], v[204:207], v[72:75]
    s_waitcnt lgkmcnt(4)
    v_mfma_f32_16x16x32_bf16 v[72:75], v[52:55], v[208:211], v[72:75]
    s_waitcnt lgkmcnt(3)
    v_mfma_f32_16x16x32_bf16 v[60:63], v[212:215], v[76:79], v[60:63]
    s_waitcnt lgkmcnt(2)
    v_mfma_f32_16x16x32_bf16 v[72:75], v[212:215], v[96:99], v[72:75]
    s_waitcnt lgkmcnt(1)
    s_nop 4
    v_pk_add_f32 v[60:61], v[60:61], v[64:65]
    v_pk_add_f32 v[62:63], v[62:63], v[66:67]
    v_cvt_pk_bf16_f32 v64, v60, v61
    v_cvt_pk_bf16_f32 v65, v62, v63
    buffer_store_dwordx2 v[64:65], v12, s[36:39], s91 offen sc1
    s_waitcnt lgkmcnt(0)
    v_pk_add_f32 v[72:73], v[72:73], v[68:69]
    v_pk_add_f32 v[74:75], v[74:75], v[70:71]
    v_cvt_pk_bf16_f32 v68, v72, v73
    v_cvt_pk_bf16_f32 v69, v74, v75
    buffer_store_dwordx2 v[68:69], v12, s[36:39], s92 offen sc1
    s_waitcnt vmcnt(11)
    ds_write_b128 v3, v[100:103] offset:4096
    ds_read_b128 v[176:179], v15 offset:1984
    ds_read_b128 v[180:183], v15 offset:1472
    ds_read_b128 v[184:187], v15 offset:960
    ds_read_b64 v[188:189], v15 offset:440
    ds_read_b64 v[190:191], v15 offset:448
    ds_read_b128 v[192:195], v56
    ds_read_b128 v[196:199], v56 offset:1024
    v_mfma_f32_16x16x32_bf16 v[96:99], v[164:167], v[80:83], 0
    v_lshlrev_b32_e32 v168, 16, v100
    v_lshlrev_b32_e32 v169, 16, v101
    v_mfma_f32_16x16x32_bf16 v[96:99], v[164:167], v[84:87], v[96:99]
    v_lshlrev_b32_e32 v170, 16, v102
    v_lshlrev_b32_e32 v171, 16, v103
    v_mfma_f32_16x16x32_bf16 v[96:99], v[164:167], v[88:91], v[96:99]
    v_and_b32_e32 v172, s5, v100
    v_and_b32_e32 v173, s5, v101
    v_mfma_f32_16x16x32_bf16 v[96:99], v[164:167], v[92:95], v[96:99]
    v_and_b32_e32 v174, s5, v102
    v_and_b32_e32 v175, s5, v103
    v_dot2_f32_bf16 v76, v80, v80, s6
    v_dot2_f32_bf16 v77, v81, v81, s6
    v_dot2_f32_bf16 v78, v82, v82, s6
    v_dot2_f32_bf16 v79, v83, v83, s6
    v_dot2_f32_bf16 v76, v84, v84, v76
    v_dot2_f32_bf16 v77, v85, v85, v77
    v_dot2_f32_bf16 v78, v86, v86, v78
    v_dot2_f32_bf16 v79, v87, v87, v79
    v_dot2_f32_bf16 v76, v88, v88, v76
    v_dot2_f32_bf16 v77, v89, v89, v77
    v_dot2_f32_bf16 v78, v90, v90, v78
    v_dot2_f32_bf16 v79, v91, v91, v79
    v_dot2_f32_bf16 v76, v92, v92, v76
    v_dot2_f32_bf16 v77, v93, v93, v77
    v_dot2_f32_bf16 v78, v94, v94, v78
    v_dot2_f32_bf16 v79, v95, v95, v79
    v_pk_mul_f32 v[96:97], v[96:97], 0.5 op_sel_hi:[1,0]
    v_pk_mul_f32 v[98:99], v[98:99], 0.5 op_sel_hi:[1,0]
    v_pk_fma_f32 v[76:77], v[96:97], v[96:97], v[76:77] neg_lo:[1,0,0] neg_hi:[1,0,0]
    v_pk_fma_f32 v[78:79], v[98:99], v[98:99], v[78:79] neg_lo:[1,0,0] neg_hi:[1,0,0]
    v_rsq_f32_e32 v76, v76
    v_rsq_f32_e32 v77, v77
    v_rsq_f32_e32 v78, v78
    v_rsq_f32_e32 v79, v79
    v_pk_mul_f32 v[96:97], v[96:97], v[76:77] neg_lo:[1,0] neg_hi:[1,0]
    v_pk_mul_f32 v[98:99], v[98:99], v[78:79] neg_lo:[1,0] neg_hi:[1,0]
    v_pk_fma_f32 v[168:169], v[168:169], v[76:77], v[96:97]
    v_pk_fma_f32 v[170:171], v[170:171], v[78:79], v[98:99]
    v_pk_fma_f32 v[172:173], v[172:173], v[76:77], v[96:97]
    v_pk_fma_f32 v[174:175], v[174:175], v[78:79], v[98:99]
    v_cvt_pk_bf16_f32 v100, v168, v169
    v_cvt_pk_bf16_f32 v101, v170, v171
    v_cvt_pk_bf16_f32 v102, v172, v173
    v_cvt_pk_bf16_f32 v103, v174, v175
    ds_write2st64_b64 v16, v[100:101], v[102:103] offset0:4 offset1:14
    s_waitcnt lgkmcnt(7)
    v_mfma_f32_16x16x32_bf16 v[60:63], v[104:107], v[176:179], 0
    ds_read_b64 v[200:201], v15 offset:1976
    v_lshlrev_b32_e32 v2, 5, v0
    v_mfma_f32_16x16x32_bf16 v[64:67], v[108:111], v[176:179], 0
    ds_read_b64 v[202:203], v15 offset:1984
    s_mov_b32 s69, 12288
    v_mfma_f32_16x16x32_bf16 v[68:71], v[112:115], v[176:179], 0
    ds_read_b128 v[204:207], v15 offset:1920
    s_waitcnt lgkmcnt(4)
    v_mfma_f32_16x16x32_bf16 v[60:63], v[108:111], v[180:183], v[60:63]
    s_add_u32 m0, s75, 0xc000
    s_nop 0
    buffer_load_dwordx4 v47, s[48:51], s19 offen lds
    v_mfma_f32_16x16x32_bf16 v[64:67], v[112:115], v[180:183], v[64:67]
    ds_read_b128 v[208:211], v15 offset:1408
    v_mfma_f32_16x16x32_bf16 v[60:63], v[112:115], v[184:187], v[60:63]
    ds_read_b128 v[212:215], v15 offset:896
    v_mfma_f32_16x16x32_bf16 v[76:79], v[188:191], v[192:195], 0
    ds_read_b128 v[80:83], v15 offset:1856
    v_mfma_f32_16x16x32_bf16 v[96:99], v[188:191], v[196:199], 0
    ds_read_b128 v[84:87], v15 offset:1344
    s_waitcnt lgkmcnt(5)
    v_mfma_f32_16x16x32_bf16 v[168:171], v[200:203], v[192:195], 0
    ds_read_b128 v[88:91], v15 offset:832
    v_mfma_f32_16x16x32_bf16 v[172:175], v[200:203], v[196:199], 0
    s_add_u32 m0, s75, 0xd000
    s_waitcnt lgkmcnt(5)
    v_mfma_f32_16x16x32_bf16 v[60:63], v[120:123], v[204:207], v[60:63]
    s_barrier
    buffer_load_dword v1, v2, s[36:39], s69 offen sc1
    v_mfma_f32_16x16x32_bf16 v[64:67], v[124:127], v[204:207], v[64:67]
    v_cvt_pk_bf16_f32 v76, v76, v96
    v_cvt_pk_bf16_f32 v77, v77, v97
    v_mfma_f32_16x16x32_bf16 v[68:71], v[128:131], v[204:207], v[68:71]
    v_cvt_pk_bf16_f32 v78, v78, v98
    s_waitcnt lgkmcnt(2)
    v_mfma_f32_16x16x32_bf16 v[60:63], v[124:127], v[208:211], v[60:63]
    v_cvt_pk_bf16_f32 v79, v79, v99
    v_cvt_pk_bf16_f32 v168, v168, v172
    v_mfma_f32_16x16x32_bf16 v[64:67], v[128:131], v[208:211], v[64:67]
    ds_read_b128 v[92:95], v15 offset:1792
    v_cvt_pk_bf16_f32 v169, v169, v173
    v_mfma_f32_16x16x32_bf16 v[60:63], v[128:131], v[212:215], v[60:63]
    v_cvt_pk_bf16_f32 v170, v170, v174
    v_cvt_pk_bf16_f32 v171, v171, v175
    v_mfma_f32_16x16x32_bf16 v[60:63], v[136:139], v[80:83], v[60:63]
    s_mul_i32 s70, s2, 11008
    s_add_u32 s71, s70, 0x800000
    v_mfma_f32_16x16x32_bf16 v[64:67], v[140:143], v[80:83], v[64:67]
    ds_read_b128 v[100:103], v15 offset:1280
    buffer_load_dwordx4 v47, s[48:51], s20 offen lds
    v_mfma_f32_16x16x32_bf16 v[68:71], v[144:147], v[80:83], v[68:71]
    ds_read_b128 v[164:167], v15 offset:768
    s_waitcnt lgkmcnt(3)
    v_mfma_f32_16x16x32_bf16 v[60:63], v[140:143], v[84:87], v[60:63]
    buffer_store_dwordx4 v[22:25], v13, s[36:39], s71 offen sc1
    s_add_u32 s71, s70, 0x801000
    v_mfma_f32_16x16x32_bf16 v[64:67], v[144:147], v[84:87], v[64:67]
    ds_read2_b32 v[176:177], v14 offset0:0 offset1:1
    v_mfma_f32_16x16x32_bf16 v[60:63], v[144:147], v[88:91], v[60:63]
    ds_read2_b32 v[178:179], v14 offset0:2 offset1:3
    s_waitcnt lgkmcnt(4)
    v_mfma_f32_16x16x32_bf16 v[60:63], v[152:155], v[92:95], v[60:63]
    ds_read_b128 v[180:183], v15 offset:448
    buffer_store_dwordx4 v[22:25], v13, s[36:39], s71 offen sc1
    v_mfma_f32_16x16x32_bf16 v[64:67], v[156:159], v[92:95], v[64:67]
    ds_read_b128 v[184:187], v15 offset:1984
    s_add_u32 s71, s70, 0x802000
    v_mfma_f32_16x16x32_bf16 v[68:71], v[160:163], v[92:95], v[68:71]
    ds_read2_b32 v[188:189], v18 offset0:32 offset1:33
    s_waitcnt lgkmcnt(5)
    v_mfma_f32_16x16x32_bf16 v[60:63], v[156:159], v[100:103], v[60:63]
    ds_read2_b32 v[190:191], v18 offset0:34 offset1:35
    v_add_u32_e32 v3, 80, v0
    v_mfma_f32_16x16x32_bf16 v[64:67], v[160:163], v[100:103], v[64:67]
    ds_read2_b32 v[192:193], v18 offset0:16 offset1:17
    v_lshrrev_b32_e32 v3, 8, v3
    v_mfma_f32_16x16x32_bf16 v[60:63], v[160:163], v[164:167], v[60:63]
    ds_read2_b32 v[194:195], v18 offset0:18 offset1:19
    s_waitcnt lgkmcnt(5)
    v_mfma_f32_16x16x32_bf16 v[60:63], v[176:179], v[180:183], v[60:63]
    ds_read_b128 v[200:203], v15 offset:2496
    s_waitcnt lgkmcnt(5)
    v_mfma_f32_16x16x32_bf16 v[72:75], v[176:179], v[184:187], 0
    ds_read_b128 v[196:199], v15 offset:3008
    s_waitcnt lgkmcnt(4)
    v_mfma_f32_16x16x32_bf16 v[64:67], v[76:79], v[188:191], v[64:67]
    v_lshl_add_u32 v3, v3, 26, v13
    s_waitcnt lgkmcnt(2)
    v_mfma_f32_16x16x32_bf16 v[68:71], v[76:79], v[192:195], v[68:71]
    ds_read_b128 v[204:207], v15 offset:3520
    s_waitcnt lgkmcnt(2)
    v_mfma_f32_16x16x32_bf16 v[60:63], v[52:55], v[200:203], v[60:63]
    s_add_u32 m0, s75, 0xe000
    s_nop 0
    buffer_load_dwordx4 v47, s[48:51], s21 offen lds
    v_mfma_f32_16x16x32_bf16 v[64:67], v[104:107], v[200:203], v[64:67]
    ds_read_b128 v[208:211], v15 offset:4032
    buffer_store_dwordx4 v[22:25], v3, s[36:39], s71 offen sc1
    v_mfma_f32_16x16x32_bf16 v[68:71], v[108:111], v[200:203], v[68:71]
    ds_read_b128 v[212:215], v15 offset:2432
    v_mfma_f32_16x16x32_bf16 v[72:75], v[112:115], v[200:203], v[72:75]
    ds_read_b128 v[96:99], v15 offset:2944
    s_waitcnt lgkmcnt(4)
    v_mfma_f32_16x16x32_bf16 v[64:67], v[52:55], v[196:199], v[64:67]
    ds_read_b128 v[172:175], v15 offset:3456
    v_mfma_f32_16x16x32_bf16 v[68:71], v[104:107], v[196:199], v[68:71]
    ds_read_b128 v[80:83], v15 offset:2368
    v_mfma_f32_16x16x32_bf16 v[72:75], v[108:111], v[196:199], v[72:75]
    s_add_u32 m0, s75, 0xf000
    s_waitcnt lgkmcnt(5)
    v_mfma_f32_16x16x32_bf16 v[68:71], v[52:55], v[204:207], v[68:71]
    buffer_load_dwordx4 v47, s[48:51], s22 offen lds
    ds_read_b128 v[84:87], v15 offset:2880
    v_mfma_f32_16x16x32_bf16 v[72:75], v[104:107], v[204:207], v[72:75]
    ds_read_b128 v[88:91], v15 offset:3392
    s_waitcnt lgkmcnt(5)
    v_mfma_f32_16x16x32_bf16 v[72:75], v[52:55], v[208:211], v[72:75]
    ds_read_b128 v[92:95], v15 offset:2304
    v_mfma_f32_16x16x32_bf16 v[64:67], v[120:123], v[212:215], v[64:67]
    ds_read_b128 v[100:103], v15 offset:2816
    v_mfma_f32_16x16x32_bf16 v[68:71], v[124:127], v[212:215], v[68:71]
    ds_read_b128 v[164:167], v15 offset:3328
    s_waitcnt lgkmcnt(5)
    v_mfma_f32_16x16x32_bf16 v[64:67], v[116:119], v[96:99], v[64:67]
    v_mfma_f32_16x16x32_bf16 v[68:71], v[120:123], v[96:99], v[68:71]
    ds_read_b128 v[180:183], v15 offset:3968
    v_mfma_f32_16x16x32_bf16 v[68:71], v[116:119], v[172:175], v[68:71]
    v_mfma_f32_16x16x32_bf16 v[64:67], v[136:139], v[80:83], v[64:67]
    v_mfma_f32_16x16x32_bf16 v[68:71], v[140:143], v[80:83], v[68:71]
    s_waitcnt lgkmcnt(2)
    v_mfma_f32_16x16x32_bf16 v[64:67], v[132:135], v[84:87], v[64:67]
    v_mfma_f32_16x16x32_bf16 v[68:71], v[136:139], v[84:87], v[68:71]
    s_waitcnt vmcnt(6)
    v_cmp_ne_u32_e32 vcc, s61, v1
    s_cbranch_vccnz retry_9
ok_10:
    s_barrier
    v_mfma_f32_16x16x32_bf16 v[68:71], v[132:135], v[88:91], v[68:71]
    ds_read_b128 v[176:179], v15 offset:3904
    v_mfma_f32_16x16x32_bf16 v[64:67], v[152:155], v[92:95], v[64:67]
    s_add_u32 m0, s90, 0x0
    s_nop 0
    buffer_load_dwordx4 v29, s[36:39], s82 offen sc1 lds
    v_mfma_f32_16x16x32_bf16 v[68:71], v[156:159], v[92:95], v[68:71]
    v_mfma_f32_16x16x32_bf16 v[64:67], v[148:151], v[100:103], v[64:67]
    v_mfma_f32_16x16x32_bf16 v[68:71], v[152:155], v[100:103], v[68:71]
    ds_read_b128 v[184:187], v15 offset:3840
    s_waitcnt lgkmcnt(2)
    v_mfma_f32_16x16x32_bf16 v[68:71], v[148:151], v[164:167], v[68:71]
    buffer_load_dwordx4 v29, s[36:39], s82 offen offset:1024 sc1 lds
    s_add_u32 m0, s90, 0x2000
    v_mfma_f32_16x16x32_bf16 v[60:63], v[116:119], v[212:215], v[60:63]
    ds_read2_b32 v[188:189], v18 offset0:48 offset1:49
    v_mfma_f32_16x16x32_bf16 v[72:75], v[128:131], v[212:215], v[72:75]
    ds_read2_b32 v[190:191], v18 offset0:50 offset1:51
    v_mfma_f32_16x16x32_bf16 v[72:75], v[124:127], v[96:99], v[72:75]
    ds_write_b128 v17, v[64:67] offset:5120
    v_mfma_f32_16x16x32_bf16 v[72:75], v[120:123], v[172:175], v[72:75]
    buffer_load_dwordx4 v29, s[36:39], s83 offen sc1 lds
    v_mfma_f32_16x16x32_bf16 v[72:75], v[116:119], v[180:183], v[72:75]
    v_mfma_f32_16x16x32_bf16 v[60:63], v[132:135], v[80:83], v[60:63]
    ds_write_b128 v17, v[68:71] offset:6144
    v_mfma_f32_16x16x32_bf16 v[72:75], v[144:147], v[80:83], v[72:75]
    v_mfma_f32_16x16x32_bf16 v[72:75], v[140:143], v[84:87], v[72:75]
    buffer_load_dwordx4 v29, s[36:39], s83 offen offset:1024 sc1 lds
    s_add_u32 m0, s90, 0x4000
    v_mfma_f32_16x16x32_bf16 v[72:75], v[136:139], v[88:91], v[72:75]
    ds_read2_b32 v[192:193], v18 offset0:0 offset1:1
    s_waitcnt lgkmcnt(2)
    v_mfma_f32_16x16x32_bf16 v[72:75], v[132:135], v[176:179], v[72:75]
    ds_read2_b32 v[194:195], v18 offset0:2 offset1:3
    v_mfma_f32_16x16x32_bf16 v[60:63], v[148:151], v[92:95], v[60:63]
    ds_read_b128 v[112:115], v57 offset:2048
    v_mfma_f32_16x16x32_bf16 v[72:75], v[160:163], v[92:95], v[72:75]
    ds_read_b128 v[200:203], v4 offset:4096
    buffer_load_dwordx4 v29, s[36:39], s84 offen sc1 lds
    v_mfma_f32_16x16x32_bf16 v[72:75], v[156:159], v[100:103], v[72:75]
    ds_read_b128 v[108:111], v4 offset:7168
    v_mfma_f32_16x16x32_bf16 v[72:75], v[152:155], v[164:167], v[72:75]
    v_mfma_f32_16x16x32_bf16 v[72:75], v[148:151], v[184:187], v[72:75]
    s_waitcnt vmcnt(5) lgkmcnt(4)
    s_barrier
    v_mfma_f32_16x16x32_bf16 v[60:63], v[76:79], v[188:191], v[60:63]
    ds_read_b128 v[64:67], v17 offset:4096
    buffer_load_dwordx4 v29, s[36:39], s84 offen offset:1024 sc1 lds
    v_mfma_f32_16x16x32_bf16 v[72:75], v[168:171], v[188:191], v[72:75]
    ds_read_b128 v[68:71], v17 offset:7168
    s_waitcnt lgkmcnt(4)
    v_mfma_f32_16x16x32_bf16 v[72:75], v[76:79], v[192:195], v[72:75]
    s_add_u32 m0, s90, 0x6000
    s_waitcnt lgkmcnt(3)
    v_mfma_f32_16x16x32_bf16 v[60:63], v[112:115], v[200:203], v[60:63]
    s_waitcnt lgkmcnt(2)
    v_mfma_f32_16x16x32_bf16 v[72:75], v[112:115], v[108:111], v[72:75]
    buffer_load_dwordx4 v29, s[36:39], s85 offen sc1 lds
    s_waitcnt lgkmcnt(1)
    s_nop 3
    v_pk_add_f32 v[60:61], v[60:61], v[64:65]
    v_pk_add_f32 v[62:63], v[62:63], v[66:67]
    v_cvt_pk_bf16_f32 v64, v60, v61
    v_cvt_pk_bf16_f32 v65, v62, v63
    buffer_store_dwordx2 v[64:65], v12, s[36:39], s93 offen sc1
    s_waitcnt lgkmcnt(0)
    v_pk_add_f32 v[72:73], v[72:73], v[68:69]
    v_pk_add_f32 v[74:75], v[74:75], v[70:71]
    v_cvt_pk_bf16_f32 v68, v72, v73
    v_cvt_pk_bf16_f32 v69, v74, v75
    buffer_store_dwordx2 v[68:69], v12, s[36:39], s94 offen sc1
    buffer_load_dwordx4 v29, s[36:39], s85 offen offset:1024 sc1 lds
    s_branch join_8
arm_7:
W2_1:
    s_cbranch_execz W2_5
    s_add_u32 s91, s74, 0x0
    s_add_u32 s92, s74, 0x40400
    s_add_u32 s93, s74, 0x101000
    s_add_u32 s94, s74, 0x141400
    s_waitcnt vmcnt(8) lgkmcnt(0)
    v_mfma_f32_16x16x32_bf16 v[168:171], v[164:167], v[64:67], 0
    s_waitcnt vmcnt(7)
    v_mfma_f32_16x16x32_bf16 v[168:171], v[164:167], v[68:71], v[168:171]
    s_waitcnt vmcnt(6)
    v_mfma_f32_16x16x32_bf16 v[168:171], v[164:167], v[72:75], v[168:171]
    s_waitcnt vmcnt(5)
    v_mfma_f32_16x16x32_bf16 v[168:171], v[164:167], v[76:79], v[168:171]
    s_waitcnt vmcnt(4)
    v_lshlrev_b32_e32 v172, 16, v96
    v_lshlrev_b32_e64 v173, 16, v97
    v_dot2_f32_bf16 v60, v64, v64, s6
    v_dot2_f32_bf16 v61, v65, v65, s6
    v_dot2_f32_bf16 v62, v66, v66, s6
    v_dot2_f32_bf16 v63, v67, v67, s6
    v_dot2_f32_bf16 v60, v68, v68, v60
    v_dot2_f32_bf16 v61, v69, v69, v61
    v_dot2_f32_bf16 v62, v70, v70, v62
    v_dot2_f32_bf16 v63, v71, v71, v63
    v_dot2_f32_bf16 v60, v72, v72, v60
    v_dot2_f32_bf16 v61, v73, v73, v61
    v_dot2_f32_bf16 v62, v74, v74, v62
    v_dot2_f32_bf16 v63, v75, v75, v63
    v_dot2_f32_bf16 v60, v76, v76, v60
    v_dot2_f32_bf16 v61, v77, v77, v61
    v_dot2_f32_bf16 v62, v78, v78, v62
    v_dot2_f32_bf16 v63, v79, v79, v63
    ds_write_b128 v3, v[96:99]
    v_pk_mul_f32 v[168:169], v[168:169], 0.5 op_sel_hi:[1,0]
    v_pk_mul_f32 v[170:171], v[170:171], 0.5 op_sel_hi:[1,0]
    v_lshlrev_b32_e32 v174, 16, v98
    v_pk_fma_f32 v[60:61], v[168:169], v[168:169], v[60:61] neg_lo:[1,0,0] neg_hi:[1,0,0]
    v_pk_fma_f32 v[62:63], v[170:171], v[170:171], v[62:63] neg_lo:[1,0,0] neg_hi:[1,0,0]
    v_rsq_f32_e32 v60, v60
    v_rsq_f32_e32 v61, v61
    v_rsq_f32_e32 v62, v62
    v_rsq_f32_e32 v63, v63
    v_lshlrev_b32_e32 v175, 16, v99
    v_and_b32_e32 v176, s5, v96
    v_and_b32_e32 v177, s5, v97
    v_and_b32_e32 v178, s5, v98
    v_and_b32_e32 v179, s5, v99
    v_pk_mul_f32 v[168:169], v[168:169], v[60:61] neg_lo:[1,0] neg_hi:[1,0]
    v_pk_mul_f32 v[170:171], v[170:171], v[62:63] neg_lo:[1,0] neg_hi:[1,0]
    v_pk_fma_f32 v[172:173], v[172:173], v[60:61], v[168:169]
    v_pk_fma_f32 v[174:175], v[174:175], v[62:63], v[170:171]
    v_pk_fma_f32 v[176:177], v[176:177], v[60:61], v[168:169]
    v_pk_fma_f32 v[178:179], v[178:179], v[62:63], v[170:171]
    v_cvt_pk_bf16_f32 v96, v172, v173
    v_cvt_pk_bf16_f32 v97, v174, v175
    v_cvt_pk_bf16_f32 v98, v176, v177
    v_cvt_pk_bf16_f32 v99, v178, v179
    ds_write2st64_b64 v16, v[96:97], v[98:99] offset0:0 offset1:10
    buffer_load_dwordx4 v[80:83], v13, s[36:39], s29 offen sc1
    buffer_load_dwordx4 v[84:87], v13, s[36:39], s30 offen sc1
    buffer_load_dwordx4 v[88:91], v13, s[36:39], s31 offen sc1
    buffer_load_dwordx4 v[92:95], v13, s[36:39], s52 offen sc1
    buffer_load_dwordx4 v[100:103], v13, s[36:39], s53 offen sc1
    s_add_u32 m0, s75, 0x24000
    s_nop 0
    buffer_load_dwordx4 v47, s[48:51], s19 offen lds
    s_lshl_b32 s68, s2, 5
    s_add_u32 s68, s68, 0x3000
    v_min_u32_e32 v2, 1, v0
    v_mov_b32_e32 v1, s61
    v_lshlrev_b32_e32 v2, 30, v2
    s_waitcnt lgkmcnt(0)
    s_barrier
    buffer_store_dword v1, v2, s[36:39], s68 offen sc1
    ds_read_b128 v[76:79], v15 offset:192
    ds_read_b128 v[96:99], v15 offset:704
    ds_read_b128 v[168:171], v15 offset:1216
    ds_read_b128 v[172:175], v15 offset:1728
    ds_read_b128 v[176:179], v15 offset:128
    s_waitcnt lgkmcnt(4)
    v_mfma_f32_16x16x32_bf16 v[60:63], v[52:55], v[76:79], 0
    ds_read_b128 v[180:183], v15 offset:640
    s_add_u32 m0, s75, 0x25000
    v_mfma_f32_16x16x32_bf16 v[72:75], v[112:115], v[76:79], 0
    ds_read_b128 v[184:187], v15 offset:1152
    s_waitcnt lgkmcnt(5)
    v_mfma_f32_16x16x32_bf16 v[72:75], v[108:111], v[96:99], v[72:75]
    ds_read_b128 v[192:195], v15 offset:1664
    s_waitcnt lgkmcnt(5)
    v_mfma_f32_16x16x32_bf16 v[72:75], v[104:107], v[168:171], v[72:75]
    ds_read_b128 v[196:199], v15 offset:64
    s_waitcnt lgkmcnt(5)
    v_mfma_f32_16x16x32_bf16 v[72:75], v[52:55], v[172:175], v[72:75]
    ds_read_b128 v[200:203], v15 offset:576
    s_waitcnt lgkmcnt(5)
    v_mfma_f32_16x16x32_bf16 v[60:63], v[116:119], v[176:179], v[60:63]
    ds_read_b128 v[204:207], v15 offset:1088
    buffer_load_dwordx4 v47, s[48:51], s20 offen lds
    v_mfma_f32_16x16x32_bf16 v[72:75], v[128:131], v[176:179], v[72:75]
    ds_read_b128 v[208:211], v15 offset:1600
    s_waitcnt lgkmcnt(6)
    v_mfma_f32_16x16x32_bf16 v[72:75], v[124:127], v[180:183], v[72:75]
    ds_read_b128 v[212:215], v15
    s_waitcnt lgkmcnt(6)
    v_mfma_f32_16x16x32_bf16 v[72:75], v[120:123], v[184:187], v[72:75]
    s_add_u32 m0, s75, 0x26000
    s_waitcnt lgkmcnt(5)
    v_mfma_f32_16x16x32_bf16 v[72:75], v[116:119], v[192:195], v[72:75]
    ds_read_b128 v[76:79], v15 offset:512
    s_waitcnt lgkmcnt(5)
    v_mfma_f32_16x16x32_bf16 v[60:63], v[132:135], v[196:199], v[60:63]
    ds_read_b128 v[96:99], v15 offset:1024
    buffer_load_dwordx4 v47, s[48:51], s21 offen lds
    v_mfma_f32_16x16x32_bf16 v[72:75], v[144:147], v[196:199], v[72:75]
    ds_read_b128 v[168:171], v15 offset:1536
    s_waitcnt lgkmcnt(5)
    v_mfma_f32_16x16x32_bf16 v[72:75], v[140:143], v[200:203], v[72:75]
    s_add_u32 m0, s75, 0x27000
    ds_read_b128 v[172:175], v15 offset:64
    v_mfma_f32_16x16x32_bf16 v[72:75], v[136:139], v[204:207], v[72:75]
    ds_read_b128 v[176:179], v15 offset:576
    s_waitcnt lgkmcnt(5)
    v_mfma_f32_16x16x32_bf16 v[72:75], v[132:135], v[208:211], v[72:75]
    buffer_load_dwordx4 v47, s[48:51], s22 offen lds
    v_add_u32_e32 v47, 0xc0800, v46
    v_mfma_f32_16x16x32_bf16 v[60:63], v[148:151], v[212:215], v[60:63]
    ds_read_b128 v[180:183], v15 offset:1088
    v_mfma_f32_16x16x32_bf16 v[72:75], v[160:163], v[212:215], v[72:75]
    ds_read_b128 v[184:187], v15 offset:128
    s_waitcnt lgkmcnt(5)
    v_mfma_f32_16x16x32_bf16 v[72:75], v[156:159], v[76:79], v[72:75]
    v_mfma_f32_16x16x32_bf16 v[72:75], v[152:155], v[96:99], v[72:75]
    ds_read_b128 v[192:195], v15 offset:640
    s_waitcnt lgkmcnt(4)
    v_mfma_f32_16x16x32_bf16 v[72:75], v[148:151], v[168:171], v[72:75]
    v_mfma_f32_16x16x32_bf16 v[64:67], v[152:155], v[212:215], 0
    s_add_u32 m0, s75, 0x8000
    s_nop 0
    buffer_load_dwordx4 v47, s[48:51], s15 offen lds
    v_mfma_f32_16x16x32_bf16 v[68:71], v[156:159], v[212:215], 0
    ds_read_b128 v[196:199], v15 offset:1152
    v_mfma_f32_16x16x32_bf16 v[64:67], v[148:151], v[76:79], v[64:67]
    ds_write_b128 v17, v[60:63]
    v_mfma_f32_16x16x32_bf16 v[68:71], v[152:155], v[76:79], v[68:71]
    v_mfma_f32_16x16x32_bf16 v[68:71], v[148:151], v[96:99], v[68:71]
    v_mfma_f32_16x16x32_bf16 v[64:67], v[136:139], v[172:175], v[64:67]
    ds_write_b128 v17, v[72:75] offset:3072
    v_mfma_f32_16x16x32_bf16 v[68:71], v[140:143], v[172:175], v[68:71]
    s_add_u32 m0, s75, 0x9000
    s_waitcnt lgkmcnt(3)
    v_mfma_f32_16x16x32_bf16 v[64:67], v[132:135], v[176:179], v[64:67]
    buffer_load_dwordx4 v47, s[48:51], s16 offen lds
    v_mfma_f32_16x16x32_bf16 v[68:71], v[136:139], v[176:179], v[68:71]
    ds_read_b128 v[200:203], v15 offset:192
    v_mfma_f32_16x16x32_bf16 v[68:71], v[132:135], v[180:183], v[68:71]
    ds_read_b128 v[204:207], v15 offset:704
    v_mfma_f32_16x16x32_bf16 v[64:67], v[120:123], v[184:187], v[64:67]
    ds_read_b128 v[208:211], v15 offset:1216
    v_mfma_f32_16x16x32_bf16 v[68:71], v[124:127], v[184:187], v[68:71]
    ds_read_b128 v[168:171], v57 offset:2048
    v_mfma_f32_16x16x32_bf16 v[64:67], v[116:119], v[192:195], v[64:67]
    ds_read_b128 v[212:215], v4 offset:1024
    v_mfma_f32_16x16x32_bf16 v[68:71], v[120:123], v[192:195], v[68:71]
    ds_read_b128 v[76:79], v4 offset:2048
    s_waitcnt lgkmcnt(6)
    v_mfma_f32_16x16x32_bf16 v[68:71], v[116:119], v[196:199], v[68:71]
    s_barrier
    s_waitcnt lgkmcnt(5)
    v_mfma_f32_16x16x32_bf16 v[64:67], v[104:107], v[200:203], v[64:67]
    ds_read_b128 v[60:63], v17 offset:1024
    s_add_u32 m0, s75, 0xa000
    v_mfma_f32_16x16x32_bf16 v[68:71], v[108:111], v[200:203], v[68:71]
    ds_read_b128 v[72:75], v17 offset:2048
    s_waitcnt lgkmcnt(5)
    v_mfma_f32_16x16x32_bf16 v[64:67], v[52:55], v[204:207], v[64:67]
    buffer_load_dwordx4 v47, s[48:51], s17 offen lds
    v_mfma_f32_16x16x32_bf16 v[68:71], v[104:107], v[204:207], v[68:71]
    v_mfma_f32_16x16x32_bf16 v[68:71], v[52:55], v[208:211], v[68:71]
    s_waitcnt lgkmcnt(2)
    v_mfma_f32_16x16x32_bf16 v[64:67], v[168:171], v[212:215], v[64:67]
    v_mfma_f32_16x16x32_bf16 v[68:71], v[168:171], v[76:79], v[68:71]
    s_waitcnt lgkmcnt(1)
    s_nop 5
    v_pk_add_f32 v[64:65], v[64:65], v[60:61]
    v_pk_add_f32 v[66:67], v[66:67], v[62:63]
    v_cvt_pk_bf16_f32 v60, v64, v65
    v_cvt_pk_bf16_f32 v61, v66, v67
    buffer_store_dwordx2 v[60:61], v12, s[36:39], s91 offen sc1
    s_waitcnt lgkmcnt(0)
    v_pk_add_f32 v[68:69], v[68:69], v[72:73]
    v_pk_add_f32 v[70:71], v[70:71], v[74:75]
    v_cvt_pk_bf16_f32 v72, v68, v69
    v_cvt_pk_bf16_f32 v73, v70, v71
    buffer_store_dwordx2 v[72:73], v12, s[36:39], s92 offen sc1
    s_waitcnt vmcnt(10)
    ds_write_b128 v3, v[100:103] offset:4096
    ds_read_b128 v[176:179], v15 offset:1728
    ds_read_b128 v[180:183], v15 offset:1216
    ds_read_b128 v[184:187], v15 offset:704
    ds_read_b64 v[188:189], v15 offset:952
    ds_read_b64 v[190:191], v15 offset:960
    ds_read_b128 v[192:195], v56
    ds_read_b128 v[196:199], v56 offset:1024
    v_mfma_f32_16x16x32_bf16 v[96:99], v[164:167], v[80:83], 0
    v_lshlrev_b32_e32 v168, 16, v100
    v_lshlrev_b32_e32 v169, 16, v101
    v_mfma_f32_16x16x32_bf16 v[96:99], v[164:167], v[84:87], v[96:99]
    v_lshlrev_b32_e32 v170, 16, v102
    v_lshlrev_b32_e32 v171, 16, v103
    v_mfma_f32_16x16x32_bf16 v[96:99], v[164:167], v[88:91], v[96:99]
    v_and_b32_e32 v172, s5, v100
    v_and_b32_e32 v173, s5, v101
    v_mfma_f32_16x16x32_bf16 v[96:99], v[164:167], v[92:95], v[96:99]
    v_and_b32_e32 v174, s5, v102
    v_and_b32_e64 v175, s5, v103
    v_dot2_f32_bf16 v76, v80, v80, s6
    v_dot2_f32_bf16 v77, v81, v81, s6
    v_dot2_f32_bf16 v78, v82, v82, s6
    v_dot2_f32_bf16 v79, v83, v83, s6
    v_dot2_f32_bf16 v76, v84, v84, v76
    v_dot2_f32_bf16 v77, v85, v85, v77
    v_dot2_f32_bf16 v78, v86, v86, v78
    v_dot2_f32_bf16 v79, v87, v87, v79
    v_dot2_f32_bf16 v76, v88, v88, v76
    v_dot2_f32_bf16 v77, v89, v89, v77
    v_dot2_f32_bf16 v78, v90, v90, v78
    v_dot2_f32_bf16 v79, v91, v91, v79
    v_dot2_f32_bf16 v76, v92, v92, v76
    v_dot2_f32_bf16 v77, v93, v93, v77
    v_dot2_f32_bf16 v78, v94, v94, v78
    v_dot2_f32_bf16 v79, v95, v95, v79
    v_pk_mul_f32 v[96:97], v[96:97], 0.5 op_sel_hi:[1,0]
    v_pk_mul_f32 v[98:99], v[98:99], 0.5 op_sel_hi:[1,0]
    v_pk_fma_f32 v[76:77], v[96:97], v[96:97], v[76:77] neg_lo:[1,0,0] neg_hi:[1,0,0]
    v_pk_fma_f32 v[78:79], v[98:99], v[98:99], v[78:79] neg_lo:[1,0,0] neg_hi:[1,0,0]
W2_2:
    s_cbranch_execz W2_ret
    v_rsq_f32_e32 v76, v76
    v_rsq_f32_e32 v77, v77
    v_rsq_f32_e32 v78, v78
    v_rsq_f32_e64 v79, v79
    v_pk_mul_f32 v[96:97], v[96:97], v[76:77] neg_lo:[1,0] neg_hi:[1,0]
    v_pk_mul_f32 v[98:99], v[98:99], v[78:79] neg_lo:[1,0] neg_hi:[1,0]
    v_pk_fma_f32 v[168:169], v[168:169], v[76:77], v[96:97]
    v_pk_fma_f32 v[170:171], v[170:171], v[78:79], v[98:99]
    v_pk_fma_f32 v[172:173], v[172:173], v[76:77], v[96:97]
    v_pk_fma_f32 v[174:175], v[174:175], v[78:79], v[98:99]
    v_cvt_pk_bf16_f32 v100, v168, v169
    v_cvt_pk_bf16_f32 v101, v170, v171
    v_cvt_pk_bf16_f32 v102, v172, v173
    v_cvt_pk_bf16_f32 v103, v174, v175
    ds_write2st64_b64 v16, v[100:101], v[102:103] offset0:4 offset1:14
    s_waitcnt lgkmcnt(7)
    v_mfma_f32_16x16x32_bf16 v[60:63], v[104:107], v[176:179], 0
    ds_read_b64 v[200:201], v15 offset:1464
    v_lshlrev_b32_e32 v2, 5, v0
    v_mfma_f32_16x16x32_bf16 v[64:67], v[108:111], v[176:179], 0
    ds_read_b64 v[202:203], v15 offset:1472
    s_mov_b32 s69, 12288
    v_mfma_f32_16x16x32_bf16 v[68:71], v[112:115], v[176:179], 0
    ds_read_b128 v[204:207], v15 offset:1664
    s_waitcnt lgkmcnt(4)
    v_mfma_f32_16x16x32_bf16 v[60:63], v[108:111], v[180:183], v[60:63]
    s_add_u32 m0, s75, 0xb000
    s_nop 0
    buffer_load_dwordx4 v47, s[48:51], s18 offen lds
    v_mfma_f32_16x16x32_bf16 v[64:67], v[112:115], v[180:183], v[64:67]
    ds_read_b128 v[208:211], v15 offset:1152
    v_mfma_f32_16x16x32_bf16 v[60:63], v[112:115], v[184:187], v[60:63]
    ds_read_b128 v[212:215], v15 offset:640
    v_mfma_f32_16x16x32_bf16 v[76:79], v[188:191], v[192:195], 0
    ds_read_b128 v[80:83], v15 offset:1600
    v_mfma_f32_16x16x32_bf16 v[96:99], v[188:191], v[196:199], 0
    ds_read_b128 v[84:87], v15 offset:1088
    s_waitcnt lgkmcnt(5)
    v_mfma_f32_16x16x32_bf16 v[168:171], v[200:203], v[192:195], 0
    ds_read_b128 v[88:91], v15 offset:576
    v_mfma_f32_16x16x32_bf16 v[172:175], v[200:203], v[196:199], 0
    s_add_u32 m0, s75, 0xc000
    s_waitcnt lgkmcnt(5)
    v_mfma_f32_16x16x32_bf16 v[60:63], v[120:123], v[204:207], v[60:63]
    s_barrier
    buffer_load_dword v1, v2, s[36:39], s69 offen sc1
    v_mfma_f32_16x16x32_bf16 v[64:67], v[124:127], v[204:207], v[64:67]
    v_cvt_pk_bf16_f32 v76, v76, v96
    v_cvt_pk_bf16_f32 v77, v77, v97
    v_mfma_f32_16x16x32_bf16 v[68:71], v[128:131], v[204:207], v[68:71]
    v_cvt_pk_bf16_f32 v78, v78, v98
    s_waitcnt lgkmcnt(2)
    v_mfma_f32_16x16x32_bf16 v[60:63], v[124:127], v[208:211], v[60:63]
    v_cvt_pk_bf16_f32 v79, v79, v99
    v_cvt_pk_bf16_f32 v168, v168, v172
    v_mfma_f32_16x16x32_bf16 v[64:67], v[128:131], v[208:211], v[64:67]
    ds_read_b128 v[92:95], v15 offset:1536
    v_cvt_pk_bf16_f32 v169, v169, v173
    v_mfma_f32_16x16x32_bf16 v[60:63], v[128:131], v[212:215], v[60:63]
    v_cvt_pk_bf16_f32 v170, v170, v174
    v_cvt_pk_bf16_f32 v171, v171, v175
    v_mfma_f32_16x16x32_bf16 v[60:63], v[136:139], v[80:83], v[60:63]
    s_mul_i32 s70, s2, 11008
    s_add_u32 s71, s70, 0x800000
    v_mfma_f32_16x16x32_bf16 v[64:67], v[140:143], v[80:83], v[64:67]
    ds_read_b128 v[100:103], v15 offset:1024
    buffer_load_dwordx4 v47, s[48:51], s19 offen lds
    v_mfma_f32_16x16x32_bf16 v[68:71], v[144:147], v[80:83], v[68:71]
    ds_read_b128 v[164:167], v15 offset:512
    s_waitcnt lgkmcnt(3)
    v_mfma_f32_16x16x32_bf16 v[60:63], v[140:143], v[84:87], v[60:63]
    buffer_store_dwordx4 v[22:25], v13, s[36:39], s71 offen sc1
    s_add_u32 s71, s70, 0x801000
    v_mfma_f32_16x16x32_bf16 v[64:67], v[144:147], v[84:87], v[64:67]
    ds_read2_b32 v[176:177], v14 offset0:0 offset1:1
    v_mfma_f32_16x16x32_bf16 v[60:63], v[144:147], v[88:91], v[60:63]
    ds_read2_b32 v[178:179], v14 offset0:2 offset1:3
    s_waitcnt lgkmcnt(4)
    v_mfma_f32_16x16x32_bf16 v[60:63], v[152:155], v[92:95], v[60:63]
    ds_read_b128 v[180:183], v15 offset:960
    buffer_store_dwordx4 v[22:25], v13, s[36:39], s71 offen sc1
    v_mfma_f32_16x16x32_bf16 v[64:67], v[156:159], v[92:95], v[64:67]
    ds_read_b128 v[184:187], v15 offset:1472
    s_add_u32 s71, s70, 0x802000
    v_mfma_f32_16x16x32_bf16 v[68:71], v[160:163], v[92:95], v[68:71]
    ds_read2_b32 v[188:189], v18 offset0:32 offset1:33
    s_waitcnt lgkmcnt(5)
    v_mfma_f32_16x16x32_bf16 v[60:63], v[156:159], v[100:103], v[60:63]
    ds_read2_b32 v[190:191], v18 offset0:34 offset1:35
    v_add_u32_e32 v3, 80, v0
    v_mfma_f32_16x16x32_bf16 v[64:67], v[160:163], v[100:103], v[64:67]
    ds_read2_b32 v[192:193], v18 offset0:16 offset1:17
    v_lshrrev_b32_e32 v3, 8, v3
    v_mfma_f32_16x16x32_bf16 v[60:63], v[160:163], v[164:167], v[60:63]
    ds_read2_b32 v[194:195], v18 offset0:18 offset1:19
    s_waitcnt lgkmcnt(5)
    v_mfma_f32_16x16x32_bf16 v[64:67], v[176:179], v[180:183], v[64:67]
    ds_read_b128 v[200:203], v15 offset:2240
    s_waitcnt lgkmcnt(5)
    v_mfma_f32_16x16x32_bf16 v[68:71], v[176:179], v[184:187], v[68:71]
    ds_read_b128 v[196:199], v15 offset:2752
    s_waitcnt lgkmcnt(4)
    v_mfma_f32_16x16x32_bf16 v[72:75], v[168:171], v[188:191], 0
    v_lshl_add_u32 v3, v3, 26, v13
    s_waitcnt lgkmcnt(2)
    v_mfma_f32_16x16x32_bf16 v[72:75], v[76:79], v[192:195], v[72:75]
    ds_read_b128 v[204:207], v15 offset:3264
    s_waitcnt lgkmcnt(2)
    v_mfma_f32_16x16x32_bf16 v[60:63], v[52:55], v[200:203], v[60:63]
    s_add_u32 m0, s75, 0xd000
    s_nop 0
    buffer_load_dwordx4 v47, s[48:51], s20 offen lds
    v_mfma_f32_16x16x32_bf16 v[64:67], v[104:107], v[200:203], v[64:67]
    ds_read_b128 v[208:211], v15 offset:3776
    buffer_store_dwordx4 v[22:25], v3, s[36:39], s71 offen sc1
    v_mfma_f32_16x16x32_bf16 v[68:71], v[108:111], v[200:203], v[68:71]
    ds_read_b128 v[212:215], v15 offset:2176
    v_mfma_f32_16x16x32_bf16 v[72:75], v[112:115], v[200:203], v[72:75]
    ds_read_b128 v[96:99], v15 offset:2688
    s_waitcnt lgkmcnt(4)
    v_mfma_f32_16x16x32_bf16 v[64:67], v[52:55], v[196:199], v[64:67]
    ds_read_b128 v[172:175], v15 offset:3200
    v_mfma_f32_16x16x32_bf16 v[68:71], v[104:107], v[196:199], v[68:71]
    ds_read_b128 v[80:83], v15 offset:3712
    v_mfma_f32_16x16x32_bf16 v[72:75], v[108:111], v[196:199], v[72:75]
    s_add_u32 m0, s75, 0xe000
    s_waitcnt lgkmcnt(5)
    v_mfma_f32_16x16x32_bf16 v[68:71], v[52:55], v[204:207], v[68:71]
    ds_read_b128 v[84:87], v15 offset:2112
    buffer_load_dwordx4 v47, s[48:51], s21 offen lds
    v_mfma_f32_16x16x32_bf16 v[72:75], v[104:107], v[204:207], v[72:75]
    ds_read_b128 v[88:91], v15 offset:2624
    s_waitcnt lgkmcnt(5)
    v_mfma_f32_16x16x32_bf16 v[72:75], v[52:55], v[208:211], v[72:75]
    ds_read_b128 v[92:95], v15 offset:3136
    v_mfma_f32_16x16x32_bf16 v[60:63], v[116:119], v[212:215], v[60:63]
    ds_read_b128 v[100:103], v15 offset:3648
    v_mfma_f32_16x16x32_bf16 v[72:75], v[128:131], v[212:215], v[72:75]
    ds_read_b128 v[164:167], v15 offset:2048
    s_waitcnt lgkmcnt(5)
    v_mfma_f32_16x16x32_bf16 v[72:75], v[124:127], v[96:99], v[72:75]
    ds_read_b128 v[180:183], v15 offset:2560
    v_mfma_f32_16x16x32_bf16 v[72:75], v[120:123], v[172:175], v[72:75]
    s_add_u32 m0, s75, 0xf000
    s_nop 0
    buffer_load_dwordx4 v47, s[48:51], s22 offen lds
    v_mfma_f32_16x16x32_bf16 v[72:75], v[116:119], v[80:83], v[72:75]
    ds_read_b128 v[176:179], v15 offset:3072
    s_waitcnt lgkmcnt(5)
    v_mfma_f32_16x16x32_bf16 v[60:63], v[132:135], v[84:87], v[60:63]
    ds_read_b128 v[184:187], v15 offset:3584
    v_mfma_f32_16x16x32_bf16 v[72:75], v[144:147], v[84:87], v[72:75]
    v_mfma_f32_16x16x32_bf16 v[72:75], v[140:143], v[88:91], v[72:75]
    s_waitcnt lgkmcnt(3)
    v_mfma_f32_16x16x32_bf16 v[72:75], v[136:139], v[92:95], v[72:75]
    s_waitcnt vmcnt(7)
    v_cmp_ne_u32_e32 vcc, s61, v1
    s_cbranch_vccnz retry_11
ok_12:
    s_barrier
    v_mfma_f32_16x16x32_bf16 v[72:75], v[132:135], v[100:103], v[72:75]
    v_mfma_f32_16x16x32_bf16 v[60:63], v[148:151], v[164:167], v[60:63]
    s_add_u32 m0, s90, 0x0
    s_nop 0
    buffer_load_dwordx4 v29, s[36:39], s82 offen sc1 lds
    v_mfma_f32_16x16x32_bf16 v[72:75], v[160:163], v[164:167], v[72:75]
    s_waitcnt lgkmcnt(0)
    v_mfma_f32_16x16x32_bf16 v[72:75], v[156:159], v[180:183], v[72:75]
    v_mfma_f32_16x16x32_bf16 v[72:75], v[152:155], v[176:179], v[72:75]
    v_mfma_f32_16x16x32_bf16 v[72:75], v[148:151], v[184:187], v[72:75]
    buffer_load_dwordx4 v29, s[36:39], s82 offen offset:1024 sc1 lds
    s_add_u32 m0, s90, 0x2000
    v_mfma_f32_16x16x32_bf16 v[64:67], v[120:123], v[212:215], v[64:67]
    ds_read2_b32 v[192:193], v18 offset0:48 offset1:49
    v_mfma_f32_16x16x32_bf16 v[68:71], v[124:127], v[212:215], v[68:71]
    ds_read2_b32 v[194:195], v18 offset0:50 offset1:51
    v_mfma_f32_16x16x32_bf16 v[64:67], v[116:119], v[96:99], v[64:67]
    ds_write_b128 v17, v[60:63] offset:4096
    v_mfma_f32_16x16x32_bf16 v[68:71], v[120:123], v[96:99], v[68:71]
    buffer_load_dwordx4 v29, s[36:39], s83 offen sc1 lds
    v_mfma_f32_16x16x32_bf16 v[68:71], v[116:119], v[172:175], v[68:71]
    v_mfma_f32_16x16x32_bf16 v[64:67], v[136:139], v[84:87], v[64:67]
    ds_write_b128 v17, v[72:75] offset:7168
    v_mfma_f32_16x16x32_bf16 v[68:71], v[140:143], v[84:87], v[68:71]
    v_mfma_f32_16x16x32_bf16 v[64:67], v[132:135], v[88:91], v[64:67]
    buffer_load_dwordx4 v29, s[36:39], s83 offen offset:1024 sc1 lds
    s_add_u32 m0, s90, 0x4000
    v_mfma_f32_16x16x32_bf16 v[68:71], v[136:139], v[88:91], v[68:71]
    ds_read_b128 v[112:115], v57 offset:2048
    v_mfma_f32_16x16x32_bf16 v[68:71], v[132:135], v[92:95], v[68:71]
    ds_read_b128 v[200:203], v4 offset:5120
    v_mfma_f32_16x16x32_bf16 v[64:67], v[152:155], v[164:167], v[64:67]
    ds_read_b128 v[108:111], v4 offset:6144
    v_mfma_f32_16x16x32_bf16 v[68:71], v[156:159], v[164:167], v[68:71]
    buffer_load_dwordx4 v29, s[36:39], s84 offen sc1 lds
    v_mfma_f32_16x16x32_bf16 v[64:67], v[148:151], v[180:183], v[64:67]
    v_mfma_f32_16x16x32_bf16 v[68:71], v[152:155], v[180:183], v[68:71]
    v_mfma_f32_16x16x32_bf16 v[68:71], v[148:151], v[176:179], v[68:71]
    s_waitcnt vmcnt(5) lgkmcnt(2)
    s_barrier
    v_mfma_f32_16x16x32_bf16 v[64:67], v[76:79], v[192:195], v[64:67]
    ds_read_b128 v[60:63], v17 offset:5120
    buffer_load_dwordx4 v29, s[36:39], s84 offen offset:1024 sc1 lds
    v_mfma_f32_16x16x32_bf16 v[68:71], v[168:171], v[192:195], v[68:71]
    ds_read_b128 v[72:75], v17 offset:6144
    s_add_u32 m0, s90, 0x6000
    v_mfma_f32_16x16x32_bf16 v[68:71], v[76:79], v[188:191], v[68:71]
    s_waitcnt lgkmcnt(2)
    v_mfma_f32_16x16x32_bf16 v[64:67], v[112:115], v[200:203], v[64:67]
    v_mfma_f32_16x16x32_bf16 v[68:71], v[112:115], v[108:111], v[68:71]
    buffer_load_dwordx4 v29, s[36:39], s85 offen sc1 lds
    s_waitcnt lgkmcnt(1)
    s_nop 4
    v_pk_add_f32 v[64:65], v[64:65], v[60:61]
    v_pk_add_f32 v[66:67], v[66:67], v[62:63]
    v_cvt_pk_bf16_f32 v60, v64, v65
    v_cvt_pk_bf16_f32 v61, v66, v67
    buffer_store_dwordx2 v[60:61], v12, s[36:39], s93 offen sc1
    s_waitcnt lgkmcnt(0)
    v_pk_add_f32 v[68:69], v[68:69], v[72:73]
    v_pk_add_f32 v[70:71], v[70:71], v[74:75]
    v_cvt_pk_bf16_f32 v72, v68, v69
    v_cvt_pk_bf16_f32 v73, v70, v71
    buffer_store_dwordx2 v[72:73], v12, s[36:39], s94 offen sc1
    buffer_load_dwordx4 v29, s[36:39], s85 offen offset:1024 sc1 lds
join_8:
W2_3:
    s_cbranch_execz W2_ret
    v_mov_b32_e32 v52, s4
    v_mov_b32_e32 v53, s4
    v_mov_b32_e32 v54, s4
    v_mov_b32_e64 v55, s4
    ds_read_b64_tr_b16 a[64:65], v50
    ds_read_b64_tr_b16 a[66:67], v50 offset:2048
    ds_read_b64_tr_b16 a[68:69], v50 offset:4096
    ds_read_b64_tr_b16 a[70:71], v50 offset:6144
    ds_read_b64_tr_b16 a[72:73], v50 offset:8192
    ds_read_b64_tr_b16 a[74:75], v50 offset:10240
    ds_read_b64_tr_b16 a[76:77], v50 offset:12288
    ds_read_b64_tr_b16 a[78:79], v50 offset:14336
    ds_read_b64_tr_b16 a[80:81], v51
    ds_read_b64_tr_b16 a[82:83], v51 offset:2048
    ds_read_b64_tr_b16 a[84:85], v51 offset:4096
    ds_read_b64_tr_b16 a[86:87], v51 offset:6144
    ds_read_b64_tr_b16 a[88:89], v51 offset:8192
    ds_read_b64_tr_b16 a[90:91], v51 offset:10240
    ds_read_b64_tr_b16 a[92:93], v51 offset:12288
    ds_read_b64_tr_b16 a[94:95], v51 offset:14336
    v_mfma_f32_16x16x32_bf16 v[68:71], v[52:55], a[0:3], 0
    ds_read_b64_tr_b16 a[96:97], v48 offset:32768
    s_lshl2_add_u32 s54, s59, s56
    v_mfma_f32_16x16x32_bf16 v[68:71], v[52:55], a[4:7], v[68:71]
    ds_read_b64_tr_b16 a[98:99], v48 offset:34816
    s_lshl2_add_u32 s54, s54, s65
    v_mfma_f32_16x16x32_bf16 v[68:71], v[52:55], a[8:11], v[68:71]
    ds_read_b64_tr_b16 a[100:101], v48 offset:36864
    s_lshl_b32 s54, s54, 12
    v_mfma_f32_16x16x32_bf16 v[68:71], v[52:55], a[12:15], v[68:71]
    ds_read_b64_tr_b16 a[102:103], v48 offset:38912
    s_add_u32 s54, s54, 0x100000
    v_mfma_f32_16x16x32_bf16 v[68:71], v[52:55], a[16:19], v[68:71]
    ds_read_b64_tr_b16 a[104:105], v48 offset:40960
    s_xor_b32 s55, s54, 0x1000
    v_mfma_f32_16x16x32_bf16 v[68:71], v[52:55], a[20:23], v[68:71]
    ds_read_b64_tr_b16 a[106:107], v48 offset:43008
    s_xor_b32 s62, s54, 0x2000
    v_mfma_f32_16x16x32_bf16 v[68:71], v[52:55], a[24:27], v[68:71]
    ds_read_b64_tr_b16 a[108:109], v48 offset:45056
    s_xor_b32 s76, s54, 0x3000
    v_mfma_f32_16x16x32_bf16 v[68:71], v[52:55], a[28:31], v[68:71]
    ds_read_b64_tr_b16 a[110:111], v48 offset:47104
    v_and_b32_e32 v21, 0x3c0, v6
    v_mfma_f32_16x16x32_bf16 v[68:71], v[52:55], a[32:35], v[68:71]
    ds_read_b64_tr_b16 a[112:113], v49 offset:32768
    v_and_b32_e32 v3, 3, v0
    v_mfma_f32_16x16x32_bf16 v[68:71], v[52:55], a[36:39], v[68:71]
    ds_read_b64_tr_b16 a[114:115], v49 offset:34816
    v_lshl_add_u32 v21, v3, 3, v21
    v_mfma_f32_16x16x32_bf16 v[68:71], v[52:55], a[40:43], v[68:71]
    ds_read_b64_tr_b16 a[116:117], v49 offset:36864
    v_and_b32_e64 v3, 16, v0
    v_mfma_f32_16x16x32_bf16 v[68:71], v[52:55], a[44:47], v[68:71]
    ds_read_b64_tr_b16 a[118:119], v49 offset:38912
    v_lshl_add_u32 v21, v3, 1, v21
    v_mfma_f32_16x16x32_bf16 v[68:71], v[52:55], a[48:51], v[68:71]
    ds_read_b64_tr_b16 a[120:121], v49 offset:40960
    s_lshl_b32 s70, s65, 8
    v_mfma_f32_16x16x32_bf16 v[68:71], v[52:55], a[52:55], v[68:71]
    ds_read_b64_tr_b16 a[122:123], v49 offset:43008
    s_add_u32 s70, s70, s66
    v_mfma_f32_16x16x32_bf16 v[68:71], v[52:55], a[56:59], v[68:71]
    ds_read_b64_tr_b16 a[124:125], v49 offset:45056
    s_lshl_b32 s70, s70, 5
    v_mfma_f32_16x16x32_bf16 v[68:71], v[52:55], a[60:63], v[68:71]
    ds_read_b64_tr_b16 a[126:127], v49 offset:47104
    v_xor_b32_e32 v21, s70, v21
    s_waitcnt lgkmcnt(6)
    v_mfma_f32_16x16x32_bf16 v[72:75], v[52:55], a[64:67], 0
    v_xor_b32_e32 v27, 32, v21
    v_xor_b32_e32 v26, 0x2000, v21
    v_mfma_f32_16x16x32_bf16 v[72:75], v[52:55], a[68:71], v[72:75]
    buffer_load_dwordx4 v[192:195], v6, s[36:39], s54 offen sc1
    v_xor_b32_e32 v28, 0x2020, v21
    v_mfma_f32_16x16x32_bf16 v[72:75], v[52:55], a[72:75], v[72:75]
    s_mov_b32 s46, 0xaaaaaaaa
    s_mov_b32 s47, 0xaaaaaaaa
    v_mfma_f32_16x16x32_bf16 v[72:75], v[52:55], a[76:79], v[72:75]
    s_mov_b32 s78, 0xcccccccc
    s_mov_b32 s79, 0xcccccccc
    v_mfma_f32_16x16x32_bf16 v[72:75], v[52:55], a[80:83], v[72:75]
    s_lshl2_add_u32 s15, s60, s56
    s_lshl2_add_u32 s15, s15, s56
    v_mfma_f32_16x16x32_bf16 v[72:75], v[52:55], a[84:87], v[72:75]
    buffer_load_dwordx4 v[196:199], v6, s[36:39], s54 offen offset:1024 sc1
    s_lshl_b32 s15, s15, 13
    v_mfma_f32_16x16x32_bf16 v[72:75], v[52:55], a[88:91], v[72:75]
    s_add_u32 s15, s15, 0x80000
    s_xor_b32 s16, s15, 0x1000
    v_mfma_f32_16x16x32_bf16 v[72:75], v[52:55], a[92:95], v[72:75]
    s_xor_b32 s17, s15, 0x2000
    s_xor_b32 s18, s15, 0x3000
    v_mfma_f32_16x16x32_bf16 v[72:75], v[52:55], a[96:99], v[72:75]
    s_xor_b32 s19, s15, 0x4000
    s_xor_b32 s20, s15, 0x5000
    v_mfma_f32_16x16x32_bf16 v[72:75], v[52:55], a[100:103], v[72:75]
    buffer_load_dwordx4 v[200:203], v6, s[36:39], s54 offen offset:2048 sc1
    s_xor_b32 s21, s15, 0x6000
    v_mfma_f32_16x16x32_bf16 v[72:75], v[52:55], a[104:107], v[72:75]
    s_xor_b32 s22, s15, 0x7000
    v_mfma_f32_16x16x32_bf16 v[72:75], v[52:55], a[108:111], v[72:75]
    v_mfma_f32_16x16x32_bf16 v[72:75], v[52:55], a[112:115], v[72:75]
    s_waitcnt lgkmcnt(0)
    v_mfma_f32_16x16x32_bf16 v[72:75], v[52:55], a[116:119], v[72:75]
    buffer_load_dwordx4 v[204:207], v6, s[36:39], s54 offen offset:3072 sc1
    v_mfma_f32_16x16x32_bf16 v[72:75], v[52:55], a[120:123], v[72:75]
    v_mfma_f32_16x16x32_bf16 v[72:75], v[52:55], a[124:127], v[72:75]
    v_mov_b32_e32 v38, v68
    s_nop 6
    v_mov_b32_e32 v39, v72
    s_mov_b32 s81, 0
    s_waitcnt vmcnt(8)
    ds_read_b128 v[68:71], v30
    ds_read_b128 v[72:75], v30 offset:1024
    ds_read_b128 v[76:79], v30 offset:8192
    ds_read_b128 v[80:83], v30 offset:9216
    ds_read_b128 v[84:87], v30 offset:16384
    ds_read_b128 v[88:91], v30 offset:17408
    s_waitcnt lgkmcnt(5)
    v_max_u32_e32 v4, v68, v70
    s_waitcnt lgkmcnt(4)
    v_max3_u32 v4, v4, v72, v74
    s_waitcnt lgkmcnt(3)
    v_max3_u32 v4, v4, v76, v78
    s_waitcnt lgkmcnt(2)
    v_max3_u32 v4, v4, v80, v82
    s_waitcnt lgkmcnt(1)
    v_max3_u32 v4, v4, v84, v86
    s_waitcnt lgkmcnt(0)
    v_max3_u32 v4, v4, v88, v90
    s_waitcnt vmcnt(4)
    ds_read_b128 v[92:95], v30 offset:24576
    ds_read_b128 v[96:99], v30 offset:25600
    s_waitcnt lgkmcnt(1)
    v_max3_u32 v4, v4, v92, v94
    s_waitcnt lgkmcnt(0)
    v_max3_u32 v4, v4, v96, v98
    v_cmp_eq_u32_e32 vcc, -1, v4
    s_cbranch_vccnz retry_13
ok_14:
    s_barrier
pass_15:
    ds_read_b64_tr_b16 v[140:141], v21
    ds_read_b64_tr_b16 v[142:143], v21 offset:1024
    ds_read_b64_tr_b16 v[144:145], v21 offset:2048
    ds_read_b64_tr_b16 v[146:147], v21 offset:3072
    s_waitcnt lgkmcnt(2)
    v_mfma_f32_16x16x32_bf16 v[128:131], v[52:55], v[140:143], 0
    ds_read_b64_tr_b16 v[148:149], v21 offset:4096
    v_and_b32_e32 v1, 15, v0
    v_mfma_f32_16x16x32_bf16 v[132:135], v[140:143], v[140:143], 0
    ds_read_b64_tr_b16 v[150:151], v21 offset:5120
    s_lshl_b32 s68, s56, 7
    v_mfma_f32_16x16x32_bf16 v[68:71], v[140:143], a[0:3], 0
    s_add_u32 s68, s68, 0x1bc00
    v_lshl_add_u32 v2, v1, 3, s68
    v_mfma_f32_16x16x32_bf16 v[76:79], v[140:143], a[64:67], 0
    v_mov_b32_e32 v3, 0x1be00
    s_waitcnt lgkmcnt(2)
    v_mfma_f32_16x16x32_bf16 v[128:131], v[52:55], v[144:147], v[128:131]
    ds_read_b64_tr_b16 v[152:153], v21 offset:6144
    v_cndmask_b32_e64 v60, v3, v2, s[32:33]
    v_mfma_f32_16x16x32_bf16 v[132:135], v[144:147], v[144:147], v[132:135]
    ds_read_b64_tr_b16 v[154:155], v21 offset:7168
    v_bfe_u32 v2, v0, 4, 1
    v_mfma_f32_16x16x32_bf16 v[68:71], v[144:147], a[4:7], v[68:71]
    v_xor_b32_e32 v3, s66, v2
    v_lshlrev_b32_e32 v3, 7, v3
    v_mfma_f32_16x16x32_bf16 v[76:79], v[144:147], a[68:71], v[76:79]
    v_lshl_add_u32 v3, v1, 3, v3
    s_waitcnt lgkmcnt(2)
    v_mfma_f32_16x16x32_bf16 v[128:131], v[52:55], v[148:151], v[128:131]
    ds_read_b64_tr_b16 v[156:157], v21 offset:16384
    v_add_u32_e32 v61, 0x1bc00, v3
    v_mfma_f32_16x16x32_bf16 v[132:135], v[148:151], v[148:151], v[132:135]
    ds_read_b64_tr_b16 v[158:159], v21 offset:17408
    s_lshl_b32 s68, s56, 8
    v_mfma_f32_16x16x32_bf16 v[68:71], v[148:151], a[8:11], v[68:71]
    s_add_u32 s68, s68, 0x1c000
    v_lshl_add_u32 v64, v1, 2, s68
    v_mfma_f32_16x16x32_bf16 v[76:79], v[148:151], a[72:75], v[76:79]
    v_lshl_add_u32 v62, v2, 6, v64
    s_waitcnt lgkmcnt(2)
    v_mfma_f32_16x16x32_bf16 v[128:131], v[52:55], v[152:155], v[128:131]
    ds_read_b64_tr_b16 v[160:161], v21 offset:18432
    v_and_b32_e32 v1, 48, v0
    v_mfma_f32_16x16x32_bf16 v[132:135], v[152:155], v[152:155], v[132:135]
    ds_read_b64_tr_b16 v[162:163], v21 offset:19456
    v_add_u32_e64 v63, s68, v1
    v_mfma_f32_16x16x32_bf16 v[68:71], v[152:155], a[12:15], v[68:71]
    v_mov_b32_e32 v65, 0x3727c5ac
    v_mov_b32_e32 v56, 0x358637bd
    v_mfma_f32_16x16x32_bf16 v[76:79], v[152:155], a[76:79], v[76:79]
    v_mov_b32_e32 v57, 0x3fb8aa3b
    s_waitcnt lgkmcnt(2)
    v_mfma_f32_16x16x32_bf16 v[128:131], v[52:55], v[156:159], v[128:131]
    ds_read_b64_tr_b16 v[164:165], v21 offset:20480
    buffer_load_dwordx4 v[224:227], v6, s[36:39], s62 offen sc1
    v_mfma_f32_16x16x32_bf16 v[132:135], v[156:159], v[156:159], v[132:135]
    ds_read_b64_tr_b16 v[166:167], v21 offset:21504
    buffer_load_dwordx4 v[228:231], v6, s[36:39], s62 offen offset:1024 sc1
    v_mfma_f32_16x16x32_bf16 v[68:71], v[156:159], a[32:35], v[68:71]
    buffer_load_dwordx4 v[232:235], v6, s[36:39], s62 offen offset:2048 sc1
    ds_read_b64_tr_b16 v[168:169], v21 offset:22528
    v_mfma_f32_16x16x32_bf16 v[76:79], v[156:159], a[96:99], v[76:79]
    ds_read_b64_tr_b16 v[170:171], v21 offset:23552
    s_waitcnt lgkmcnt(4)
    v_mfma_f32_16x16x32_bf16 v[128:131], v[52:55], v[160:163], v[128:131]
    buffer_load_dwordx4 v[236:239], v6, s[36:39], s62 offen offset:3072 sc1
    ds_read_b64_tr_b16 v[172:173], v27
    v_mfma_f32_16x16x32_bf16 v[132:135], v[160:163], v[160:163], v[132:135]
    ds_read_b64_tr_b16 v[174:175], v27 offset:1024
    v_mfma_f32_16x16x32_bf16 v[68:71], v[160:163], a[36:39], v[68:71]
    ds_read_b64_tr_b16 v[176:177], v27 offset:2048
    v_mfma_f32_16x16x32_bf16 v[76:79], v[160:163], a[100:103], v[76:79]
    ds_read_b64_tr_b16 v[178:179], v27 offset:3072
    s_waitcnt lgkmcnt(6)
    v_mfma_f32_16x16x32_bf16 v[128:131], v[52:55], v[164:167], v[128:131]
    ds_read_b64_tr_b16 v[180:181], v27 offset:4096
    v_mfma_f32_16x16x32_bf16 v[132:135], v[164:167], v[164:167], v[132:135]
    ds_read_b64_tr_b16 v[182:183], v27 offset:5120
    v_mfma_f32_16x16x32_bf16 v[68:71], v[164:167], a[40:43], v[68:71]
    buffer_load_dwordx4 v[208:211], v6, s[36:39], s55 offen sc1
    ds_read_b64_tr_b16 v[140:141], v27 offset:6144
    v_mfma_f32_16x16x32_bf16 v[76:79], v[164:167], a[104:107], v[76:79]
    ds_read_b64_tr_b16 v[142:143], v27 offset:7168
    s_waitcnt lgkmcnt(6)
    v_mfma_f32_16x16x32_bf16 v[128:131], v[52:55], v[168:171], v[128:131]
    ds_read_b64_tr_b16 v[144:145], v27 offset:16384
    v_mfma_f32_16x16x32_bf16 v[132:135], v[168:171], v[168:171], v[132:135]
    ds_read_b64_tr_b16 v[146:147], v27 offset:17408
    v_mfma_f32_16x16x32_bf16 v[68:71], v[168:171], a[44:47], v[68:71]
    ds_read_b64_tr_b16 v[148:149], v27 offset:18432
    v_mfma_f32_16x16x32_bf16 v[76:79], v[168:171], a[108:111], v[76:79]
    ds_read_b64_tr_b16 v[150:151], v27 offset:19456
    v_mfma_f32_16x16x32_bf16 v[72:75], v[172:175], a[0:3], 0
    s_nop 1
    v_cndmask_b32_e64 v132, v132, v133, s[46:47]
    v_cndmask_b32_e64 v134, v134, v135, s[46:47]
    v_mfma_f32_16x16x32_bf16 v[80:83], v[172:175], a[64:67], 0
    v_cndmask_b32_e64 v129, v132, v134, s[78:79]
    s_waitcnt lgkmcnt(4)
    v_mfma_f32_16x16x32_bf16 v[72:75], v[176:179], a[4:7], v[72:75]
    ds_write_b64 v60, v[128:129]
    buffer_load_dwordx4 v[212:215], v6, s[36:39], s55 offen offset:1024 sc1
    v_mfma_f32_16x16x32_bf16 v[80:83], v[176:179], a[68:71], v[80:83]
    s_lshl2_add_u32 s70, s59, s56
    s_lshl_b32 s23, s70, 5
    v_mfma_f32_16x16x32_bf16 v[72:75], v[180:183], a[8:11], v[72:75]
    ds_read_b64_tr_b16 v[152:153], v27 offset:20480
    s_add_u32 s23, s23, s58
    v_mfma_f32_16x16x32_bf16 v[80:83], v[180:183], a[72:75], v[80:83]
    ds_read_b64_tr_b16 v[154:155], v27 offset:21504
    s_mul_i32 s23, s23, 640
    v_mfma_f32_16x16x32_bf16 v[72:75], v[140:143], a[12:15], v[72:75]
    ds_read_b64_tr_b16 v[156:157], v27 offset:22528
    buffer_load_dwordx4 v[216:219], v6, s[36:39], s55 offen offset:2048 sc1
    v_mfma_f32_16x16x32_bf16 v[80:83], v[140:143], a[76:79], v[80:83]
    ds_read_b64_tr_b16 v[158:159], v27 offset:23552
    s_waitcnt lgkmcnt(5)
    v_mfma_f32_16x16x32_bf16 v[72:75], v[144:147], a[32:35], v[72:75]
    ds_read_b64_tr_b16 v[160:161], v26
    s_add_u32 s23, s23, 0xa00000
    v_mfma_f32_16x16x32_bf16 v[80:83], v[144:147], a[96:99], v[80:83]
    ds_read_b64_tr_b16 v[162:163], v26 offset:1024
    s_lshl_b32 s34, s58, 5
    v_mfma_f32_16x16x32_bf16 v[72:75], v[148:151], a[36:39], v[72:75]
    ds_read_b64_tr_b16 v[164:165], v28
    s_add_u32 s34, s34, s70
    v_mfma_f32_16x16x32_bf16 v[80:83], v[148:151], a[100:103], v[80:83]
    ds_read_b64_tr_b16 v[166:167], v28 offset:1024
    s_waitcnt lgkmcnt(6)
    v_mfma_f32_16x16x32_bf16 v[72:75], v[152:155], a[40:43], v[72:75]
    ds_read_b64_tr_b16 v[168:169], v26 offset:2048
    s_barrier
    v_mfma_f32_16x16x32_bf16 v[80:83], v[152:155], a[104:107], v[80:83]
    ds_read_b64_tr_b16 v[170:171], v26 offset:3072
    s_waitcnt lgkmcnt(6)
    v_mfma_f32_16x16x32_bf16 v[72:75], v[156:159], a[44:47], v[72:75]
    ds_read_b64_tr_b16 v[172:173], v28 offset:2048
    buffer_load_dwordx4 v[220:223], v6, s[36:39], s55 offen offset:3072 sc1
    v_mfma_f32_16x16x32_bf16 v[80:83], v[156:159], a[108:111], v[80:83]
    ds_read_b64_tr_b16 v[174:175], v28 offset:3072
    s_waitcnt lgkmcnt(6)
    v_mfma_f32_16x16x32_bf16 v[68:71], v[160:163], a[16:19], v[68:71]
    ds_read_b64_tr_b16 v[176:177], v26 offset:4096
    s_lshl1_add_u32 s34, s34, s66
    v_mfma_f32_16x16x32_bf16 v[76:79], v[160:163], a[80:83], v[76:79]
    ds_read_b64_tr_b16 v[178:179], v26 offset:5120
    s_waitcnt lgkmcnt(6)
    v_mfma_f32_16x16x32_bf16 v[72:75], v[164:167], a[16:19], v[72:75]
    ds_read_b64_tr_b16 v[180:181], v28 offset:4096
    buffer_load_dwordx4 v[240:243], v6, s[36:39], s76 offen sc1
    v_mfma_f32_16x16x32_bf16 v[80:83], v[164:167], a[80:83], v[80:83]
    ds_read_b64_tr_b16 v[182:183], v28 offset:5120
    s_waitcnt lgkmcnt(6)
    v_mfma_f32_16x16x32_bf16 v[68:71], v[168:171], a[20:23], v[68:71]
    ds_read_b64_tr_b16 v[140:141], v26 offset:6144
    s_lshl_b32 s34, s34, 9
    v_mfma_f32_16x16x32_bf16 v[76:79], v[168:171], a[84:87], v[76:79]
    ds_read_b64_tr_b16 v[142:143], v26 offset:7168
    s_waitcnt lgkmcnt(6)
    v_mfma_f32_16x16x32_bf16 v[72:75], v[172:175], a[20:23], v[72:75]
    ds_read_b64_tr_b16 v[144:145], v28 offset:6144
    s_add_u32 s34, s34, 0x800000
    v_mfma_f32_16x16x32_bf16 v[80:83], v[172:175], a[84:87], v[80:83]
    ds_read_b64_tr_b16 v[146:147], v28 offset:7168
    s_waitcnt lgkmcnt(6)
    v_mfma_f32_16x16x32_bf16 v[68:71], v[176:179], a[24:27], v[68:71]
    ds_read_b64_tr_b16 v[148:149], v26 offset:16384
    buffer_load_dwordx4 v[244:247], v6, s[36:39], s76 offen offset:1024 sc1
    v_mfma_f32_16x16x32_bf16 v[76:79], v[176:179], a[88:91], v[76:79]
    ds_read_b64_tr_b16 v[150:151], v26 offset:17408
    s_waitcnt lgkmcnt(6)
    v_mfma_f32_16x16x32_bf16 v[72:75], v[180:183], a[24:27], v[72:75]
    ds_read_b64_tr_b16 v[152:153], v28 offset:16384
    s_xor_b32 s45, s34, 0x200
    v_mfma_f32_16x16x32_bf16 v[80:83], v[180:183], a[88:91], v[80:83]
    ds_read_b64_tr_b16 v[154:155], v28 offset:17408
    s_waitcnt lgkmcnt(6)
    v_mfma_f32_16x16x32_bf16 v[68:71], v[140:143], a[28:31], v[68:71]
    ds_read_b64_tr_b16 v[156:157], v26 offset:18432
    s_xor_b32 s77, s34, 0x100000
    v_mfma_f32_16x16x32_bf16 v[76:79], v[140:143], a[92:95], v[76:79]
    ds_read_b64_tr_b16 v[158:159], v26 offset:19456
    s_waitcnt lgkmcnt(6)
    v_mfma_f32_16x16x32_bf16 v[72:75], v[144:147], a[28:31], v[72:75]
    ds_read_b64_tr_b16 v[160:161], v28 offset:18432
    s_xor_b32 s80, s34, 0x100200
    v_mfma_f32_16x16x32_bf16 v[80:83], v[144:147], a[92:95], v[80:83]
    ds_read_b64_tr_b16 v[162:163], v28 offset:19456
    s_waitcnt lgkmcnt(6)
    v_mfma_f32_16x16x32_bf16 v[68:71], v[148:151], a[48:51], v[68:71]
    ds_read_b64_tr_b16 v[164:165], v26 offset:20480
    v_lshrrev_b32_e32 v19, 1, v20
    v_mfma_f32_16x16x32_bf16 v[76:79], v[148:151], a[112:115], v[76:79]
    ds_read_b64_tr_b16 v[166:167], v26 offset:21504
    s_waitcnt lgkmcnt(6)
    v_mfma_f32_16x16x32_bf16 v[72:75], v[152:155], a[48:51], v[72:75]
    ds_read_b64_tr_b16 v[168:169], v28 offset:20480
    s_add_u32 m0, s90, 0x8000
    v_mfma_f32_16x16x32_bf16 v[80:83], v[152:155], a[112:115], v[80:83]
    ds_read_b64_tr_b16 v[170:171], v28 offset:21504
    s_waitcnt lgkmcnt(6)
    v_mfma_f32_16x16x32_bf16 v[68:71], v[156:159], a[52:55], v[68:71]
    ds_read_b64_tr_b16 v[172:173], v26 offset:22528
W2_4:
    s_cbranch_execz W2_ret
    buffer_load_dwordx4 v29, s[36:39], s86 offen sc1 lds
    v_mfma_f32_16x16x32_bf16 v[76:79], v[156:159], a[116:119], v[76:79]
    ds_read_b64_tr_b16 v[174:175], v26 offset:23552
    s_waitcnt lgkmcnt(6)
    v_mfma_f32_16x16x32_bf16 v[72:75], v[160:163], a[52:55], v[72:75]
    ds_read_b64_tr_b16 v[176:177], v28 offset:22528
    v_and_b32_e32 v3, 12, v0
    v_mfma_f32_16x16x32_bf16 v[80:83], v[160:163], a[116:119], v[80:83]
    ds_read_b64_tr_b16 v[178:179], v28 offset:23552
    s_waitcnt lgkmcnt(6)
    v_mfma_f32_16x16x32_bf16 v[68:71], v[164:167], a[56:59], v[68:71]
    ds_read2_b64 v[136:139], v61 offset0:0 offset1:32
    buffer_load_dwordx4 v29, s[36:39], s86 offen offset:1024 sc1 lds
    v_mfma_f32_16x16x32_bf16 v[76:79], v[164:167], a[120:123], v[76:79]
    s_add_u32 m0, s90, 0xa000
    s_waitcnt lgkmcnt(5)
    v_mfma_f32_16x16x32_bf16 v[72:75], v[168:171], a[56:59], v[72:75]
    v_lshl_add_u32 v32, v3, 26, v19
    v_and_b32_e32 v34, 0x70, v6
    v_mfma_f32_16x16x32_bf16 v[80:83], v[168:171], a[120:123], v[80:83]
    v_bfe_u32 v3, v0, 4, 1
    s_waitcnt lgkmcnt(3)
    v_mfma_f32_16x16x32_bf16 v[68:71], v[172:175], a[60:63], v[68:71]
    v_lshl_add_u32 v34, v3, 3, v34
    v_and_b32_e32 v3, 0x28, v0
    v_mfma_f32_16x16x32_bf16 v[76:79], v[172:175], a[124:127], v[76:79]
    buffer_load_dwordx4 v29, s[36:39], s87 offen sc1 lds
    s_waitcnt lgkmcnt(1)
    v_mfma_f32_16x16x32_bf16 v[72:75], v[176:179], a[60:63], v[72:75]
    s_waitcnt lgkmcnt(0)
    v_add_f32_e32 v136, v136, v138
    v_mfma_f32_16x16x32_bf16 v[80:83], v[176:179], a[124:127], v[80:83]
    v_add_f32_e32 v137, v137, v139
    v_mul_f32_e32 v136, 0x3b000000, v136
    v_fmamk_f32 v137, v137, 0x3b000000, v65
    v_fma_f32 v137, -v136, v136, v137
    v_rsq_f32_e32 v137, v137
    s_nop 0
    ds_write2_b32 v62, v136, v137 offset0:0 offset1:32
    ds_read_b128 v[100:103], v63
    ds_read_b128 v[108:111], v63 offset:128
    ds_read_b128 v[104:107], v63 offset:64
    ds_read_b128 v[112:115], v63 offset:192
    ds_read2_b32 v[116:117], v64 offset0:0 offset1:32
    ds_read2_b32 v[118:119], v64 offset0:16 offset1:48
    buffer_load_dwordx4 v29, s[36:39], s87 offen offset:1024 sc1 lds
    s_add_u32 m0, s90, 0xc000
    s_nop 0
    buffer_load_dwordx4 v29, s[36:39], s88 offen sc1 lds
    buffer_load_dwordx4 v29, s[36:39], s88 offen offset:1024 sc1 lds
    s_add_u32 m0, s90, 0xe000
    s_nop 0
    buffer_load_dwordx4 v29, s[36:39], s89 offen sc1 lds
    buffer_load_dwordx4 v29, s[36:39], s89 offen offset:1024 sc1 lds
    v_lshl_add_u32 v34, v3, 22, v34
    s_and_b32 s70, s2, 7
    s_lshr_b32 s35, s2, 3
    s_mul_i32 s44, s35, 5
    s_add_u32 s44, s44, s70
    s_lshl_b32 s44, s44, 7
    s_add_u32 s44, s44, 0xaa0000
    s_cmp_lt_u32 s70, 5
    s_cselect_b32 s44, s44, 0x40000000
    s_cselect_b32 s69, 0, 5
    s_sub_u32 s70, s70, s69
    s_mul_i32 s35, s35, 160
    s_add_u32 s35, s35, s70
    v_and_b32_e32 v31, 0xc0, v6
    v_and_b32_e32 v36, 3, v0
    v_lshl_add_u32 v31, v36, 3, v31
    v_and_b32_e32 v3, 16, v0
    v_lshl_add_u32 v31, v3, 1, v31
    v_and_b32_e32 v3, 32, v0
    v_lshl_add_u32 v31, v3, 5, v31
    s_lshl2_add_u32 s70, s60, s56
    s_and_b32 s69, s59, 1
    s_lshl4_add_u32 s70, s69, s70
    s_lshl_b32 s70, s70, 11
    v_add_u32_e32 v31, s70, v31
    s_lshl_b32 s35, s35, 7
    s_add_u32 s35, s35, 0xa00000
    v_bfe_u32 v33, v0, 3, 3
    v_lshl_add_u32 v33, v33, 9, v6
    v_lshrrev_b32_e32 v3, 1, v3
    v_and_b32_e32 v35, 31, v0
    v_lshl_add_u32 v35, v35, 5, v3
    v_and_b32_e32 v2, 4, v0
    v_lshl_add_u32 v36, v2, 1, v36
    v_bfe_u32 v2, v0, 3, 1
    v_lshl_add_u32 v36, v2, 2, v36
    v_and_or_b32 v36, v0, 16, v36
    v_min_u32_e64 v36, 16, v36
    v_lshl_add_u32 v36, v36, 5, v3
    s_mov_b32 s42, 0x200000
    s_mov_b32 s43, 0x20000
    v_lshrrev_b32_e32 v3, 7, v6
    v_mul_u32_u24_e32 v3, 8192, v3
    v_add_u32_e32 v3, v6, v3
    s_add_u32 s71, s73, 0x8000
    buffer_store_dword v22, v8, s[36:39], s71 offen sc1
    s_add_u32 s71, s72, 0x280000
    buffer_store_dwordx4 v[22:25], v3, s[36:39], s71 offen sc1
    s_add_u32 s71, s72, 0x290400
    buffer_store_dwordx4 v[22:25], v3, s[36:39], s71 offen sc1
    s_waitcnt lgkmcnt(5)
    v_pk_fma_f32 v[68:69], v[100:101], v[38:39], v[68:69] op_sel_hi:[1,0,1] neg_lo:[1,0,0] neg_hi:[1,0,0]
    v_pk_fma_f32 v[76:77], v[100:101], v[38:39], v[76:77] op_sel:[0,1,0] op_sel_hi:[1,1,1] neg_lo:[1,0,0] neg_hi:[1,0,0]
    s_waitcnt lgkmcnt(4)
    v_pk_fma_f32 v[68:69], v[68:69], v[108:109], v[56:57] op_sel_hi:[1,1,0]
    v_pk_mul_f32 v[76:77], v[76:77], v[108:109]
    v_pk_mul_f32 v[58:59], v[68:69], v[56:57] op_sel:[0,1] op_sel_hi:[1,1]
    v_exp_f32_e64 v58, v58 clamp
    v_exp_f32_e64 v59, v59 clamp
    v_max_f32_e32 v68, v56, v68
    v_max_f32_e32 v69, v56, v69
    v_pk_add_f32 v[68:69], v[68:69], v[58:59]
    v_cvt_pk_bf16_f32 v132, v76, v77
    v_cvt_pk_bf16_f32 v128, v68, v69
    v_pk_fma_f32 v[70:71], v[102:103], v[38:39], v[70:71] op_sel_hi:[1,0,1] neg_lo:[1,0,0] neg_hi:[1,0,0]
    v_pk_fma_f32 v[78:79], v[102:103], v[38:39], v[78:79] op_sel:[0,1,0] op_sel_hi:[1,1,1] neg_lo:[1,0,0] neg_hi:[1,0,0]
    v_pk_fma_f32 v[70:71], v[70:71], v[110:111], v[56:57] op_sel_hi:[1,1,0]
    v_pk_mul_f32 v[78:79], v[78:79], v[110:111]
    v_pk_mul_f32 v[58:59], v[70:71], v[56:57] op_sel:[0,1] op_sel_hi:[1,1]
    v_exp_f32_e64 v58, v58 clamp
    v_exp_f32_e64 v59, v59 clamp
    v_max_f32_e32 v70, v56, v70
    v_max_f32_e32 v71, v56, v71
    v_pk_add_f32 v[70:71], v[70:71], v[58:59]
    v_cvt_pk_bf16_f32 v133, v78, v79
    v_cvt_pk_bf16_f32 v129, v70, v71
    s_waitcnt lgkmcnt(3)
    v_pk_fma_f32 v[72:73], v[104:105], v[38:39], v[72:73] op_sel_hi:[1,0,1] neg_lo:[1,0,0] neg_hi:[1,0,0]
    v_pk_fma_f32 v[80:81], v[104:105], v[38:39], v[80:81] op_sel:[0,1,0] op_sel_hi:[1,1,1] neg_lo:[1,0,0] neg_hi:[1,0,0]
    s_waitcnt lgkmcnt(2)
    v_pk_fma_f32 v[72:73], v[72:73], v[112:113], v[56:57] op_sel_hi:[1,1,0]
    v_pk_mul_f32 v[80:81], v[80:81], v[112:113]
    v_pk_mul_f32 v[58:59], v[72:73], v[56:57] op_sel:[0,1] op_sel_hi:[1,1]
    v_exp_f32_e64 v58, v58 clamp
    v_exp_f32_e64 v59, v59 clamp
    v_max_f32_e32 v72, v56, v72
    v_max_f32_e32 v73, v56, v73
    v_pk_add_f32 v[72:73], v[72:73], v[58:59]
    v_cvt_pk_bf16_f32 v134, v80, v81
    v_cvt_pk_bf16_f32 v130, v72, v73
    v_pk_fma_f32 v[74:75], v[106:107], v[38:39], v[74:75] op_sel_hi:[1,0,1] neg_lo:[1,0,0] neg_hi:[1,0,0]
    v_pk_fma_f32 v[82:83], v[106:107], v[38:39], v[82:83] op_sel:[0,1,0] op_sel_hi:[1,1,1] neg_lo:[1,0,0] neg_hi:[1,0,0]
    v_pk_fma_f32 v[74:75], v[74:75], v[114:115], v[56:57] op_sel_hi:[1,1,0]
    v_pk_mul_f32 v[82:83], v[82:83], v[114:115]
    v_pk_mul_f32 v[58:59], v[74:75], v[56:57] op_sel:[0,1] op_sel_hi:[1,1]
    v_exp_f32_e64 v58, v58 clamp
    v_exp_f32_e64 v59, v59 clamp
    v_max_f32_e32 v74, v56, v74
    v_max_f32_e32 v75, v56, v75
    v_pk_add_f32 v[74:75], v[74:75], v[58:59]
    v_cvt_pk_bf16_f32 v135, v82, v83
    v_cvt_pk_bf16_f32 v131, v74, v75
    s_nop 1
    v_mfma_f32_16x16x32_bf16 v[48:51], v[128:131], v[132:135], 0
    v_mfma_f32_16x16x32_bf16 v[124:127], v[128:131], v[52:55], 0
    s_mov_b32 s81, 0
    s_waitcnt vmcnt(3)
    s_barrier
pass_16:
    ds_read_b64_tr_b16 v[140:141], v21 offset:32768
    ds_read_b64_tr_b16 v[142:143], v21 offset:33792
    ds_read_b64_tr_b16 v[144:145], v21 offset:34816
    ds_read_b64_tr_b16 v[146:147], v21 offset:35840
    s_waitcnt lgkmcnt(2)
    v_mfma_f32_16x16x32_bf16 v[128:131], v[52:55], v[140:143], 0
    ds_read_b64_tr_b16 v[148:149], v21 offset:36864
    buffer_load_dwordx4 v[248:251], v6, s[36:39], s76 offen offset:2048 sc1
    v_mfma_f32_16x16x32_bf16 v[132:135], v[140:143], v[140:143], 0
    ds_read_b64_tr_b16 v[150:151], v21 offset:37888
    v_mfma_f32_16x16x32_bf16 v[68:71], v[140:143], a[0:3], 0
    ds_read_b64_tr_b16 v[152:153], v21 offset:38912
    v_mfma_f32_16x16x32_bf16 v[76:79], v[140:143], a[64:67], 0
    ds_read_b64_tr_b16 v[154:155], v21 offset:39936
    s_waitcnt lgkmcnt(4)
    v_mfma_f32_16x16x32_bf16 v[128:131], v[52:55], v[144:147], v[128:131]
    ds_read_b64_tr_b16 v[156:157], v21 offset:49152
    v_mfma_f32_16x16x32_bf16 v[132:135], v[144:147], v[144:147], v[132:135]
    ds_read_b64_tr_b16 v[158:159], v21 offset:50176
    v_mfma_f32_16x16x32_bf16 v[68:71], v[144:147], a[4:7], v[68:71]
    buffer_load_dwordx4 v[252:255], v6, s[36:39], s76 offen offset:3072 sc1
    ds_read_b64_tr_b16 v[160:161], v21 offset:51200
    v_mfma_f32_16x16x32_bf16 v[76:79], v[144:147], a[68:71], v[76:79]
    ds_read_b64_tr_b16 v[162:163], v21 offset:52224
    s_waitcnt lgkmcnt(6)
    v_mfma_f32_16x16x32_bf16 v[128:131], v[52:55], v[148:151], v[128:131]
    ds_read_b64_tr_b16 v[164:165], v21 offset:53248
    v_mfma_f32_16x16x32_bf16 v[132:135], v[148:151], v[148:151], v[132:135]
    ds_read_b64_tr_b16 v[166:167], v21 offset:54272
    v_mfma_f32_16x16x32_bf16 v[68:71], v[148:151], a[8:11], v[68:71]
    ds_read_b64_tr_b16 v[168:169], v21 offset:55296
    v_mfma_f32_16x16x32_bf16 v[76:79], v[148:151], a[72:75], v[76:79]
    ds_read_b64_tr_b16 v[170:171], v21 offset:56320
    s_waitcnt lgkmcnt(6)
    v_mfma_f32_16x16x32_bf16 v[128:131], v[52:55], v[152:155], v[128:131]
    buffer_load_dwordx4 a[128:131], v6, s[36:39], s15 offen sc1
    ds_read_b64_tr_b16 v[172:173], v27 offset:32768
    v_mfma_f32_16x16x32_bf16 v[132:135], v[152:155], v[152:155], v[132:135]
    ds_read_b64_tr_b16 v[174:175], v27 offset:33792
    v_mfma_f32_16x16x32_bf16 v[68:71], v[152:155], a[12:15], v[68:71]
    ds_read_b64_tr_b16 v[176:177], v27 offset:34816
    v_mfma_f32_16x16x32_bf16 v[76:79], v[152:155], a[76:79], v[76:79]
    ds_read_b64_tr_b16 v[178:179], v27 offset:35840
    v_mfma_f32_16x16x32_bf16 v[128:131], v[52:55], v[156:159], v[128:131]
    ds_read_b64_tr_b16 v[180:181], v27 offset:36864
    v_mfma_f32_16x16x32_bf16 v[132:135], v[156:159], v[156:159], v[132:135]
    ds_read_b64_tr_b16 v[182:183], v27 offset:37888
    v_mfma_f32_16x16x32_bf16 v[68:71], v[156:159], a[32:35], v[68:71]
    buffer_load_dwordx4 a[132:135], v6, s[36:39], s15 offen offset:1024 sc1
    ds_read_b64_tr_b16 v[140:141], v27 offset:38912
    v_mfma_f32_16x16x32_bf16 v[76:79], v[156:159], a[96:99], v[76:79]
    ds_read_b64_tr_b16 v[142:143], v27 offset:39936
    s_waitcnt lgkmcnt(6)
    v_mfma_f32_16x16x32_bf16 v[128:131], v[52:55], v[160:163], v[128:131]
    ds_read_b64_tr_b16 v[144:145], v27 offset:49152
    v_mfma_f32_16x16x32_bf16 v[132:135], v[160:163], v[160:163], v[132:135]
    ds_read_b64_tr_b16 v[146:147], v27 offset:50176
    v_mfma_f32_16x16x32_bf16 v[68:71], v[160:163], a[36:39], v[68:71]
    ds_read_b64_tr_b16 v[148:149], v27 offset:51200
    v_mfma_f32_16x16x32_bf16 v[76:79], v[160:163], a[100:103], v[76:79]
    ds_read_b64_tr_b16 v[150:151], v27 offset:52224
    v_mfma_f32_16x16x32_bf16 v[128:131], v[52:55], v[164:167], v[128:131]
    buffer_load_dwordx4 a[136:139], v6, s[36:39], s15 offen offset:2048 sc1
    ds_read_b64_tr_b16 v[152:153], v27 offset:53248
    v_mfma_f32_16x16x32_bf16 v[132:135], v[164:167], v[164:167], v[132:135]
    ds_read_b64_tr_b16 v[154:155], v27 offset:54272
    v_mfma_f32_16x16x32_bf16 v[68:71], v[164:167], a[40:43], v[68:71]
    ds_read_b64_tr_b16 v[156:157], v27 offset:55296
    v_mfma_f32_16x16x32_bf16 v[76:79], v[164:167], a[104:107], v[76:79]
    ds_read_b64_tr_b16 v[158:159], v27 offset:56320
    v_mfma_f32_16x16x32_bf16 v[128:131], v[52:55], v[168:171], v[128:131]
    ds_read_b64_tr_b16 v[160:161], v26 offset:32768
    v_mfma_f32_16x16x32_bf16 v[132:135], v[168:171], v[168:171], v[132:135]
    ds_read_b64_tr_b16 v[162:163], v26 offset:33792
    v_mfma_f32_16x16x32_bf16 v[68:71], v[168:171], a[44:47], v[68:71]
    buffer_load_dwordx4 a[140:143], v6, s[36:39], s15 offen offset:3072 sc1
    ds_read_b64_tr_b16 v[164:165], v28 offset:32768
    v_mfma_f32_16x16x32_bf16 v[76:79], v[168:171], a[108:111], v[76:79]
    ds_read_b64_tr_b16 v[166:167], v28 offset:33792
    v_mfma_f32_16x16x32_bf16 v[72:75], v[172:175], a[0:3], 0
    s_nop 0
    v_cndmask_b32_e64 v132, v132, v133, s[46:47]
    v_cndmask_b32_e64 v134, v134, v135, s[46:47]
    v_mfma_f32_16x16x32_bf16 v[80:83], v[172:175], a[64:67], 0
    v_cndmask_b32_e64 v129, v132, v134, s[78:79]
    s_waitcnt lgkmcnt(4)
    v_mfma_f32_16x16x32_bf16 v[72:75], v[176:179], a[4:7], v[72:75]
    ds_write_b64 v60, v[128:129]
    v_mfma_f32_16x16x32_bf16 v[80:83], v[176:179], a[68:71], v[80:83]
    ds_read_b64_tr_b16 v[168:169], v26 offset:34816
    v_mfma_f32_16x16x32_bf16 v[72:75], v[180:183], a[8:11], v[72:75]
    buffer_load_dwordx4 a[144:147], v6, s[36:39], s16 offen sc1
    ds_read_b64_tr_b16 v[170:171], v26 offset:35840
    v_mfma_f32_16x16x32_bf16 v[80:83], v[180:183], a[72:75], v[80:83]
    ds_read_b64_tr_b16 v[172:173], v28 offset:34816
    v_mfma_f32_16x16x32_bf16 v[72:75], v[140:143], a[12:15], v[72:75]
    ds_read_b64_tr_b16 v[174:175], v28 offset:35840
    v_mfma_f32_16x16x32_bf16 v[80:83], v[140:143], a[76:79], v[80:83]
    ds_read_b64_tr_b16 v[176:177], v26 offset:36864
    v_mfma_f32_16x16x32_bf16 v[72:75], v[144:147], a[32:35], v[72:75]
    ds_read_b64_tr_b16 v[178:179], v26 offset:37888
    v_mfma_f32_16x16x32_bf16 v[80:83], v[144:147], a[96:99], v[80:83]
    ds_read_b64_tr_b16 v[180:181], v28 offset:36864
    v_mfma_f32_16x16x32_bf16 v[72:75], v[148:151], a[36:39], v[72:75]
    buffer_load_dwordx4 a[148:151], v6, s[36:39], s16 offen offset:1024 sc1
    ds_read_b64_tr_b16 v[182:183], v28 offset:37888
    v_mfma_f32_16x16x32_bf16 v[80:83], v[148:151], a[100:103], v[80:83]
    ds_read_b64_tr_b16 v[140:141], v26 offset:38912
    v_mfma_f32_16x16x32_bf16 v[72:75], v[152:155], a[40:43], v[72:75]
    s_waitcnt lgkmcnt(5)
    s_barrier
    v_mfma_f32_16x16x32_bf16 v[80:83], v[152:155], a[104:107], v[80:83]
    ds_read2_b64 v[136:139], v61 offset0:0 offset1:32
    v_mfma_f32_16x16x32_bf16 v[72:75], v[156:159], a[44:47], v[72:75]
    ds_read_b64_tr_b16 v[142:143], v26 offset:39936
    v_mfma_f32_16x16x32_bf16 v[80:83], v[156:159], a[108:111], v[80:83]
    ds_read_b64_tr_b16 v[144:145], v28 offset:38912
    v_mfma_f32_16x16x32_bf16 v[68:71], v[160:163], a[16:19], v[68:71]
    buffer_load_dwordx4 a[152:155], v6, s[36:39], s16 offen offset:2048 sc1
    ds_read_b64_tr_b16 v[146:147], v28 offset:39936
    v_mfma_f32_16x16x32_bf16 v[76:79], v[160:163], a[80:83], v[76:79]
    ds_read_b64_tr_b16 v[148:149], v26 offset:49152
    v_mfma_f32_16x16x32_bf16 v[72:75], v[164:167], a[16:19], v[72:75]
    ds_read_b64_tr_b16 v[150:151], v26 offset:50176
    v_mfma_f32_16x16x32_bf16 v[80:83], v[164:167], a[80:83], v[80:83]
    s_waitcnt lgkmcnt(5)
    v_add_f32_e32 v136, v136, v138
    v_mfma_f32_16x16x32_bf16 v[68:71], v[168:171], a[20:23], v[68:71]
    v_add_f32_e32 v137, v137, v139
    v_cmp_u_f32_e64 vcc, v136, v136
    v_mfma_f32_16x16x32_bf16 v[76:79], v[168:171], a[84:87], v[76:79]
    v_mul_f32_e32 v136, 0x3b000000, v136
    v_fmamk_f32 v137, v137, 0x3b000000, v65
    v_mfma_f32_16x16x32_bf16 v[72:75], v[172:175], a[20:23], v[72:75]
    v_fma_f32 v137, -v136, v136, v137
    v_rsq_f32_e32 v137, v137
    v_mfma_f32_16x16x32_bf16 v[80:83], v[172:175], a[84:87], v[80:83]
    s_cbranch_vccnz redo_17
back_18:
    v_mfma_f32_16x16x32_bf16 v[68:71], v[176:179], a[24:27], v[68:71]
    ds_write2_b32 v62, v136, v137 offset0:0 offset1:32
    buffer_load_dwordx4 a[156:159], v6, s[36:39], s16 offen offset:3072 sc1
    v_mfma_f32_16x16x32_bf16 v[76:79], v[176:179], a[88:91], v[76:79]
    ds_read_b128 v[100:103], v63
    v_mfma_f32_16x16x32_bf16 v[72:75], v[180:183], a[24:27], v[72:75]
    ds_read_b64_tr_b16 v[152:153], v28 offset:49152
    v_mfma_f32_16x16x32_bf16 v[80:83], v[180:183], a[88:91], v[80:83]
    ds_read_b64_tr_b16 v[154:155], v28 offset:50176
    s_waitcnt lgkmcnt(4)
    v_mfma_f32_16x16x32_bf16 v[68:71], v[140:143], a[28:31], v[68:71]
    ds_read_b64_tr_b16 v[156:157], v26 offset:51200
    v_mfma_f32_16x16x32_bf16 v[76:79], v[140:143], a[92:95], v[76:79]
    ds_read_b64_tr_b16 v[158:159], v26 offset:52224
    v_mfma_f32_16x16x32_bf16 v[72:75], v[144:147], a[28:31], v[72:75]
    ds_read_b64_tr_b16 v[160:161], v28 offset:51200
    buffer_load_dwordx4 a[160:163], v6, s[36:39], s17 offen sc1
    v_mfma_f32_16x16x32_bf16 v[80:83], v[144:147], a[92:95], v[80:83]
    ds_read_b64_tr_b16 v[162:163], v28 offset:52224
    v_mfma_f32_16x16x32_bf16 v[68:71], v[148:151], a[48:51], v[68:71]
    ds_read_b64_tr_b16 v[164:165], v26 offset:53248
    v_mfma_f32_16x16x32_bf16 v[76:79], v[148:151], a[112:115], v[76:79]
    ds_read_b64_tr_b16 v[166:167], v26 offset:54272
    s_waitcnt lgkmcnt(6)
    v_mfma_f32_16x16x32_bf16 v[72:75], v[152:155], a[48:51], v[72:75]
    ds_read_b64_tr_b16 v[168:169], v28 offset:53248
    v_mfma_f32_16x16x32_bf16 v[80:83], v[152:155], a[112:115], v[80:83]
    ds_read_b64_tr_b16 v[170:171], v28 offset:54272
    s_waitcnt lgkmcnt(6)
    v_mfma_f32_16x16x32_bf16 v[68:71], v[156:159], a[52:55], v[68:71]
    ds_read_b64_tr_b16 v[172:173], v26 offset:55296
    buffer_load_dwordx4 a[164:167], v6, s[36:39], s17 offen offset:1024 sc1
    v_mfma_f32_16x16x32_bf16 v[76:79], v[156:159], a[116:119], v[76:79]
    ds_read_b64_tr_b16 v[174:175], v26 offset:56320
    s_waitcnt lgkmcnt(6)
    v_mfma_f32_16x16x32_bf16 v[72:75], v[160:163], a[52:55], v[72:75]
    ds_read_b64_tr_b16 v[176:177], v28 offset:55296
    v_mfma_f32_16x16x32_bf16 v[80:83], v[160:163], a[116:119], v[80:83]
    ds_read_b64_tr_b16 v[178:179], v28 offset:56320
    s_waitcnt lgkmcnt(6)
    v_mfma_f32_16x16x32_bf16 v[68:71], v[164:167], a[56:59], v[68:71]
    ds_read_b128 v[108:111], v63 offset:128
    v_mfma_f32_16x16x32_bf16 v[76:79], v[164:167], a[120:123], v[76:79]
    ds_read_b128 v[104:107], v63 offset:64
    s_waitcnt lgkmcnt(6)
    v_mfma_f32_16x16x32_bf16 v[72:75], v[168:171], a[56:59], v[72:75]
    ds_read_b128 v[112:115], v63 offset:192
    buffer_load_dwordx4 a[168:171], v6, s[36:39], s17 offen offset:2048 sc1
    v_mfma_f32_16x16x32_bf16 v[80:83], v[168:171], a[120:123], v[80:83]
    ds_read2_b32 v[120:121], v64 offset0:0 offset1:32
    s_waitcnt lgkmcnt(6)
    v_mfma_f32_16x16x32_bf16 v[68:71], v[172:175], a[60:63], v[68:71]
    ds_read2_b32 v[122:123], v64 offset0:16 offset1:48
    v_mfma_f32_16x16x32_bf16 v[76:79], v[172:175], a[124:127], v[76:79]
    s_waitcnt lgkmcnt(5)
    v_mfma_f32_16x16x32_bf16 v[72:75], v[176:179], a[60:63], v[72:75]
    v_mfma_f32_16x16x32_bf16 v[80:83], v[176:179], a[124:127], v[80:83]
    s_nop 2
    v_pk_fma_f32 v[68:69], v[100:101], v[38:39], v[68:69] op_sel_hi:[1,0,1] neg_lo:[1,0,0] neg_hi:[1,0,0]
    s_nop 0
    v_pk_fma_f32 v[76:77], v[100:101], v[38:39], v[76:77] op_sel:[0,1,0] op_sel_hi:[1,1,1] neg_lo:[1,0,0] neg_hi:[1,0,0]
    s_waitcnt lgkmcnt(3)
    v_pk_fma_f32 v[68:69], v[68:69], v[108:109], v[56:57] op_sel_hi:[1,1,0]
    v_pk_mul_f32 v[76:77], v[76:77], v[108:109]
    v_pk_mul_f32 v[58:59], v[68:69], v[56:57] op_sel:[0,1] op_sel_hi:[1,1]
    v_exp_f32_e64 v58, v58 clamp
    v_exp_f32_e64 v59, v59 clamp
    v_max_f32_e32 v68, v56, v68
    v_max_f32_e64 v69, v56, v69
    v_pk_add_f32 v[68:69], v[68:69], v[58:59]
    v_cvt_pk_bf16_f32 v132, v76, v77
    v_cvt_pk_bf16_f32 v128, v68, v69
    v_pk_fma_f32 v[70:71], v[102:103], v[38:39], v[70:71] op_sel_hi:[1,0,1] neg_lo:[1,0,0] neg_hi:[1,0,0]
    v_pk_fma_f32 v[78:79], v[102:103], v[38:39], v[78:79] op_sel:[0,1,0] op_sel_hi:[1,1,1] neg_lo:[1,0,0] neg_hi:[1,0,0]
    v_pk_fma_f32 v[70:71], v[70:71], v[110:111], v[56:57] op_sel_hi:[1,1,0]
    v_pk_mul_f32 v[78:79], v[78:79], v[110:111]
    v_pk_mul_f32 v[58:59], v[70:71], v[56:57] op_sel:[0,1] op_sel_hi:[1,1]
    v_exp_f32_e64 v58, v58 clamp
    v_exp_f32_e64 v59, v59 clamp
    v_max_f32_e32 v70, v56, v70
    v_max_f32_e32 v71, v56, v71
    v_pk_add_f32 v[70:71], v[70:71], v[58:59]
    v_cvt_pk_bf16_f32 v133, v78, v79
    v_cvt_pk_bf16_f32 v129, v70, v71
    v_pk_fma_f32 v[72:73], v[104:105], v[38:39], v[72:73] op_sel_hi:[1,0,1] neg_lo:[1,0,0] neg_hi:[1,0,0]
    v_pk_fma_f32 v[80:81], v[104:105], v[38:39], v[80:81] op_sel:[0,1,0] op_sel_hi:[1,1,1] neg_lo:[1,0,0] neg_hi:[1,0,0]
    s_waitcnt lgkmcnt(2)
    v_pk_fma_f32 v[72:73], v[72:73], v[112:113], v[56:57] op_sel_hi:[1,1,0]
    v_pk_mul_f32 v[80:81], v[80:81], v[112:113]
    v_pk_mul_f32 v[58:59], v[72:73], v[56:57] op_sel:[0,1] op_sel_hi:[1,1]
    v_exp_f32_e64 v58, v58 clamp
    v_exp_f32_e64 v59, v59 clamp
    v_max_f32_e32 v72, v56, v72
    v_max_f32_e64 v73, v56, v73
    v_pk_add_f32 v[72:73], v[72:73], v[58:59]
    v_cvt_pk_bf16_f32 v134, v80, v81
    v_cvt_pk_bf16_f32 v130, v72, v73
    v_pk_fma_f32 v[74:75], v[106:107], v[38:39], v[74:75] op_sel_hi:[1,0,1] neg_lo:[1,0,0] neg_hi:[1,0,0]
    v_pk_fma_f32 v[82:83], v[106:107], v[38:39], v[82:83] op_sel:[0,1,0] op_sel_hi:[1,1,1] neg_lo:[1,0,0] neg_hi:[1,0,0]
    v_pk_fma_f32 v[74:75], v[74:75], v[114:115], v[56:57] op_sel_hi:[1,1,0]
    v_pk_mul_f32 v[82:83], v[82:83], v[114:115]
    v_pk_mul_f32 v[58:59], v[74:75], v[56:57] op_sel:[0,1] op_sel_hi:[1,1]
    v_exp_f32_e64 v58, v58 clamp
    v_exp_f32_e64 v59, v59 clamp
    v_max_f32_e32 v74, v56, v74
    v_max_f32_e32 v75, v56, v75
    v_pk_add_f32 v[74:75], v[74:75], v[58:59]
    v_cvt_pk_bf16_f32 v135, v82, v83
    v_cvt_pk_bf16_f32 v131, v74, v75
    s_nop 1
    v_mfma_f32_16x16x32_bf16 v[48:51], v[128:131], v[132:135], v[48:51]
    v_mfma_f32_16x16x32_bf16 v[124:127], v[128:131], v[52:55], v[124:127]
    v_xor_b32_e32 v1, 32, v31
    ds_read_b64_tr_b16 v[60:61], v31
    ds_read_b64_tr_b16 v[62:63], v1 offset:256
    ds_read_b64_tr_b16 v[64:65], v31 offset:512
    ds_read_b64_tr_b16 v[66:67], v1 offset:768
    s_waitcnt vmcnt(13)
    s_nop 0
    v_cvt_pk_bf16_f32 v48, v48, v49
    v_cvt_pk_bf16_f32 v49, v50, v51
    buffer_store_dwordx2 v[48:49], v19, s[36:39], s23 offen sc1
    v_cvt_pk_bf16_f32 v124, v124, v125
    v_cvt_pk_bf16_f32 v125, v126, v127
    buffer_store_dwordx2 v[124:125], v32, s[36:39], s23 offen offset:512 sc1
    ds_read_b64_tr_b16 v[100:101], v21
    ds_read_b64_tr_b16 v[102:103], v21 offset:1024
    ds_read_b64_tr_b16 v[104:105], v27
    ds_read_b64_tr_b16 v[106:107], v27 offset:1024
    ds_read_b64_tr_b16 v[108:109], v21 offset:2048
    ds_read_b64_tr_b16 v[110:111], v21 offset:3072
    ds_read_b64_tr_b16 v[112:113], v27 offset:2048
    ds_read_b64_tr_b16 v[114:115], v27 offset:3072
    s_waitcnt lgkmcnt(6)
    v_mfma_f32_16x16x32_bf16 v[84:87], v[192:195], v[100:103], 0
    ds_read_b64_tr_b16 v[128:129], v21 offset:4096
    ds_read_b64_tr_b16 v[130:131], v21 offset:5120
    s_waitcnt lgkmcnt(6)
    v_mfma_f32_16x16x32_bf16 v[88:91], v[192:195], v[104:107], 0
    ds_read_b64_tr_b16 v[132:133], v27 offset:4096
    ds_read_b64_tr_b16 v[134:135], v27 offset:5120
    s_add_u32 s24, s35, 0x0
    v_mfma_f32_16x16x32_bf16 v[40:43], v[192:195], v[52:55], 0
    ds_read_b64_tr_b16 v[136:137], v21 offset:6144
    ds_read_b64_tr_b16 v[138:139], v21 offset:7168
    s_waitcnt lgkmcnt(8)
    v_mfma_f32_16x16x32_bf16 v[84:87], v[196:199], v[108:111], v[84:87]
    ds_read_b64_tr_b16 v[140:141], v27 offset:6144
    ds_read_b64_tr_b16 v[142:143], v27 offset:7168
    s_waitcnt lgkmcnt(8)
    v_mfma_f32_16x16x32_bf16 v[88:91], v[196:199], v[112:115], v[88:91]
    ds_read_b64_tr_b16 v[100:101], v26
    ds_read_b64_tr_b16 v[102:103], v26 offset:1024
    s_add_u32 s25, s35, 0x1400
    v_mfma_f32_16x16x32_bf16 v[40:43], v[196:199], v[52:55], v[40:43]
    ds_read_b64_tr_b16 v[104:105], v28
    ds_read_b64_tr_b16 v[106:107], v28 offset:1024
    s_waitcnt lgkmcnt(10)
    v_mfma_f32_16x16x32_bf16 v[84:87], v[200:203], v[128:131], v[84:87]
    s_add_u32 s26, s35, 0x2800
    s_add_u32 s27, s35, 0x3c00
    s_waitcnt lgkmcnt(8)
    v_mfma_f32_16x16x32_bf16 v[88:91], v[200:203], v[132:135], v[88:91]
    ds_read_b64_tr_b16 v[108:109], v26 offset:2048
    ds_read_b64_tr_b16 v[110:111], v26 offset:3072
    s_add_u32 s28, s44, 0x0
    v_mfma_f32_16x16x32_bf16 v[40:43], v[200:203], v[52:55], v[40:43]
    ds_read_b64_tr_b16 v[112:113], v28 offset:2048
    ds_read_b64_tr_b16 v[114:115], v28 offset:3072
    s_waitcnt lgkmcnt(10)
    v_mfma_f32_16x16x32_bf16 v[84:87], v[204:207], v[136:139], v[84:87]
    s_waitcnt lgkmcnt(8)
    v_mfma_f32_16x16x32_bf16 v[88:91], v[204:207], v[140:143], v[88:91]
    ds_read_b64_tr_b16 v[128:129], v26 offset:4096
    ds_read_b64_tr_b16 v[130:131], v26 offset:5120
    v_mfma_f32_16x16x32_bf16 v[40:43], v[204:207], v[52:55], v[40:43]
    ds_read_b64_tr_b16 v[132:133], v28 offset:4096
    ds_read_b64_tr_b16 v[134:135], v28 offset:5120
    s_waitcnt lgkmcnt(8)
    v_mfma_f32_16x16x32_bf16 v[84:87], v[208:211], v[100:103], v[84:87]
    v_mfma_f32_16x16x32_bf16 v[88:91], v[208:211], v[104:107], v[88:91]
    ds_read_b64_tr_b16 v[136:137], v26 offset:6144
    ds_read_b64_tr_b16 v[138:139], v26 offset:7168
    v_mfma_f32_16x16x32_bf16 v[40:43], v[208:211], v[52:55], v[40:43]
    ds_read_b64_tr_b16 v[140:141], v28 offset:6144
    ds_read_b64_tr_b16 v[142:143], v28 offset:7168
    s_waitcnt lgkmcnt(8)
    v_mfma_f32_16x16x32_bf16 v[84:87], v[212:215], v[108:111], v[84:87]
    v_mfma_f32_16x16x32_bf16 v[88:91], v[212:215], v[112:115], v[88:91]
    ds_read_b64_tr_b16 v[100:101], v21 offset:16384
    ds_read_b64_tr_b16 v[102:103], v21 offset:17408
    v_mfma_f32_16x16x32_bf16 v[40:43], v[212:215], v[52:55], v[40:43]
    ds_read_b64_tr_b16 v[104:105], v27 offset:16384
    ds_read_b64_tr_b16 v[106:107], v27 offset:17408
    s_waitcnt lgkmcnt(8)
    v_mfma_f32_16x16x32_bf16 v[84:87], v[216:219], v[128:131], v[84:87]
    v_mfma_f32_16x16x32_bf16 v[88:91], v[216:219], v[132:135], v[88:91]
    ds_read_b64_tr_b16 v[108:109], v21 offset:18432
    ds_read_b64_tr_b16 v[110:111], v21 offset:19456
    v_mfma_f32_16x16x32_bf16 v[40:43], v[216:219], v[52:55], v[40:43]
    ds_read_b64_tr_b16 v[112:113], v27 offset:18432
    ds_read_b64_tr_b16 v[114:115], v27 offset:19456
    s_waitcnt lgkmcnt(8)
    v_mfma_f32_16x16x32_bf16 v[84:87], v[220:223], v[136:139], v[84:87]
    v_mfma_f32_16x16x32_bf16 v[88:91], v[220:223], v[140:143], v[88:91]
    ds_read_b64_tr_b16 v[128:129], v21 offset:20480
    ds_read_b64_tr_b16 v[130:131], v21 offset:21504
    v_mfma_f32_16x16x32_bf16 v[40:43], v[220:223], v[52:55], v[40:43]
    ds_read_b64_tr_b16 v[132:133], v27 offset:20480
    ds_read_b64_tr_b16 v[134:135], v27 offset:21504
    s_waitcnt lgkmcnt(8)
    v_mfma_f32_16x16x32_bf16 v[84:87], v[224:227], v[100:103], v[84:87]
    v_mfma_f32_16x16x32_bf16 v[88:91], v[224:227], v[104:107], v[88:91]
    ds_read_b64_tr_b16 v[136:137], v21 offset:22528
    ds_read_b64_tr_b16 v[138:139], v21 offset:23552
    v_mfma_f32_16x16x32_bf16 v[40:43], v[224:227], v[52:55], v[40:43]
    ds_read_b64_tr_b16 v[140:141], v27 offset:22528
    ds_read_b64_tr_b16 v[142:143], v27 offset:23552
    s_waitcnt lgkmcnt(8)
    v_mfma_f32_16x16x32_bf16 v[84:87], v[228:231], v[108:111], v[84:87]
    v_mfma_f32_16x16x32_bf16 v[88:91], v[228:231], v[112:115], v[88:91]
    ds_read_b64_tr_b16 v[100:101], v26 offset:16384
    ds_read_b64_tr_b16 v[102:103], v26 offset:17408
    v_mfma_f32_16x16x32_bf16 v[40:43], v[228:231], v[52:55], v[40:43]
    ds_read_b64_tr_b16 v[104:105], v28 offset:16384
    ds_read_b64_tr_b16 v[106:107], v28 offset:17408
    s_waitcnt lgkmcnt(8)
    v_mfma_f32_16x16x32_bf16 v[84:87], v[232:235], v[128:131], v[84:87]
    v_mfma_f32_16x16x32_bf16 v[88:91], v[232:235], v[132:135], v[88:91]
    ds_read_b64_tr_b16 v[108:109], v26 offset:18432
    ds_read_b64_tr_b16 v[110:111], v26 offset:19456
    v_mfma_f32_16x16x32_bf16 v[40:43], v[232:235], v[52:55], v[40:43]
    ds_read_b64_tr_b16 v[112:113], v28 offset:18432
    ds_read_b64_tr_b16 v[114:115], v28 offset:19456
    s_waitcnt lgkmcnt(8)
    v_mfma_f32_16x16x32_bf16 v[84:87], v[236:239], v[136:139], v[84:87]
    v_mfma_f32_16x16x32_bf16 v[88:91], v[236:239], v[140:143], v[88:91]
    ds_read_b64_tr_b16 v[128:129], v26 offset:20480
    ds_read_b64_tr_b16 v[130:131], v26 offset:21504
    v_mfma_f32_16x16x32_bf16 v[40:43], v[236:239], v[52:55], v[40:43]
    ds_read_b64_tr_b16 v[132:133], v28 offset:20480
    ds_read_b64_tr_b16 v[134:135], v28 offset:21504
    s_waitcnt lgkmcnt(8)
    v_mfma_f32_16x16x32_bf16 v[84:87], v[240:243], v[100:103], v[84:87]
    v_mfma_f32_16x16x32_bf16 v[88:91], v[240:243], v[104:107], v[88:91]
    ds_read_b64_tr_b16 v[136:137], v26 offset:22528
    ds_read_b64_tr_b16 v[138:139], v26 offset:23552
    v_mfma_f32_16x16x32_bf16 v[40:43], v[240:243], v[52:55], v[40:43]
    ds_read_b64_tr_b16 v[140:141], v28 offset:22528
    ds_read_b64_tr_b16 v[142:143], v28 offset:23552
    s_waitcnt lgkmcnt(8)
    v_mfma_f32_16x16x32_bf16 v[84:87], v[244:247], v[108:111], v[84:87]
    v_mfma_f32_16x16x32_bf16 v[88:91], v[244:247], v[112:115], v[88:91]
    v_mfma_f32_16x16x32_bf16 v[40:43], v[244:247], v[52:55], v[40:43]
    s_waitcnt vmcnt(14) lgkmcnt(4)
    v_mfma_f32_16x16x32_bf16 v[84:87], v[248:251], v[128:131], v[84:87]
    v_mfma_f32_16x16x32_bf16 v[88:91], v[248:251], v[132:135], v[88:91]
    v_mfma_f32_16x16x32_bf16 v[40:43], v[248:251], v[52:55], v[40:43]
    s_waitcnt vmcnt(13) lgkmcnt(0)
    v_mfma_f32_16x16x32_bf16 v[84:87], v[252:255], v[136:139], v[84:87]
    v_mfma_f32_16x16x32_bf16 v[88:91], v[252:255], v[140:143], v[88:91]
    v_mfma_f32_16x16x32_bf16 v[40:43], v[252:255], v[52:55], v[40:43]
    s_nop 7
    v_pk_fma_f32 v[84:85], v[40:41], v[116:117], v[84:85] op_sel_hi:[1,0,1] neg_lo:[1,0,0] neg_hi:[1,0,0]
    v_pk_fma_f32 v[84:85], v[84:85], v[116:117], v[56:57] op_sel:[0,1,0] op_sel_hi:[1,1,0]
    v_pk_mul_f32 v[58:59], v[84:85], v[56:57] op_sel:[0,1] op_sel_hi:[1,1]
    v_exp_f32_e64 v58, v58 clamp
    v_exp_f32_e64 v59, v59 clamp
W2_5:
    s_cbranch_execz W2_ret
    v_max_f32_e32 v84, v56, v84
    v_max_f32_e32 v85, v56, v85
    v_pk_add_f32 v[84:85], v[84:85], v[58:59]
    v_cvt_pk_bf16_f32 v100, v84, v85
    v_pk_fma_f32 v[86:87], v[42:43], v[116:117], v[86:87] op_sel_hi:[1,0,1] neg_lo:[1,0,0] neg_hi:[1,0,0]
    v_pk_fma_f32 v[86:87], v[86:87], v[116:117], v[56:57] op_sel:[0,1,0] op_sel_hi:[1,1,0]
    v_pk_mul_f32 v[58:59], v[86:87], v[56:57] op_sel:[0,1] op_sel_hi:[1,1]
    v_exp_f32_e64 v58, v58 clamp
    v_exp_f32_e64 v59, v59 clamp
    v_max_f32_e32 v86, v56, v86
    v_max_f32_e32 v87, v56, v87
    v_pk_add_f32 v[86:87], v[86:87], v[58:59]
    v_cvt_pk_bf16_f32 v101, v86, v87
    v_pk_fma_f32 v[88:89], v[40:41], v[118:119], v[88:89] op_sel_hi:[1,0,1] neg_lo:[1,0,0] neg_hi:[1,0,0]
    v_pk_fma_f32 v[88:89], v[88:89], v[118:119], v[56:57] op_sel:[0,1,0] op_sel_hi:[1,1,0]
    v_pk_mul_f32 v[58:59], v[88:89], v[56:57] op_sel:[0,1] op_sel_hi:[1,1]
    v_exp_f32_e64 v58, v58 clamp
    v_exp_f32_e64 v59, v59 clamp
    v_max_f32_e32 v88, v56, v88
    v_max_f32_e32 v89, v56, v89
    v_pk_add_f32 v[88:89], v[88:89], v[58:59]
    v_cvt_pk_bf16_f32 v102, v88, v89
    v_pk_fma_f32 v[90:91], v[42:43], v[118:119], v[90:91] op_sel_hi:[1,0,1] neg_lo:[1,0,0] neg_hi:[1,0,0]
    v_pk_fma_f32 v[90:91], v[90:91], v[118:119], v[56:57] op_sel:[0,1,0] op_sel_hi:[1,1,0]
    v_pk_mul_f32 v[58:59], v[90:91], v[56:57] op_sel:[0,1] op_sel_hi:[1,1]
    v_exp_f32_e64 v58, v58 clamp
    v_exp_f32_e64 v59, v59 clamp
    v_max_f32_e32 v90, v56, v90
    v_max_f32_e32 v91, v56, v91
    v_pk_add_f32 v[90:91], v[90:91], v[58:59]
    v_cvt_pk_bf16_f32 v103, v90, v91
    s_cmp_lg_u32 s56, 3
    s_cbranch_scc1 nw_21
    s_waitcnt vmcnt(0)
    buffer_load_dwordx4 v[68:71], v33, s[36:39], s24 offen sc1
    buffer_load_dwordx4 v[72:75], v33, s[36:39], s25 offen sc1
    buffer_load_dwordx4 v[76:79], v33, s[36:39], s26 offen sc1
    buffer_load_dwordx4 v[80:83], v33, s[36:39], s27 offen sc1
    v_bfe_u32 v1, v0, 1, 2
    v_mov_b32_e32 v2, 0x3f80
    v_cndmask_b32_e64 v2, v2, 1.0, s[46:47]
    v_cmp_eq_u32_e32 vcc, 0, v1
    s_nop 1
    v_cndmask_b32_e32 v124, 0, v2, vcc
    v_cmp_eq_u32_e32 vcc, 1, v1
    s_nop 1
    v_cndmask_b32_e32 v125, 0, v2, vcc
    v_cmp_eq_u32_e32 vcc, 2, v1
    s_nop 1
    v_cndmask_b32_e32 v126, 0, v2, vcc
    v_cmp_eq_u32_e32 vcc, 3, v1
    s_nop 1
    v_cndmask_b32_e32 v127, 0, v2, vcc
    s_branch chk_23
retry_22:
    s_cmp_eq_u32 s63, 0
    s_cbranch_scc1 ok_24
    s_sub_u32 s63, s63, 1
    s_mov_b64 exec, vcc
    buffer_load_dwordx4 v[68:71], v33, s[36:39], s24 offen sc1
    buffer_load_dwordx4 v[72:75], v33, s[36:39], s25 offen sc1
    buffer_load_dwordx4 v[76:79], v33, s[36:39], s26 offen sc1
    buffer_load_dwordx4 v[80:83], v33, s[36:39], s27 offen sc1
    s_mov_b64 exec, -1
    s_waitcnt vmcnt(0)
chk_23:
    s_waitcnt vmcnt(3)
    v_max_u32_e32 v1, v68, v70
    s_waitcnt vmcnt(2)
    v_max3_u32 v1, v1, v72, v74
    s_waitcnt vmcnt(1)
    v_max3_u32 v1, v1, v76, v78
    s_waitcnt vmcnt(0)
    v_max3_u32 v1, v1, v80, v82
    v_cmp_eq_u32_e32 vcc, -1, v1
    s_cbranch_vccnz retry_22
ok_24:
    v_mfma_f32_16x16x32_bf16 v[48:51], v[124:127], v[68:71], 0
    v_mfma_f32_16x16x32_bf16 v[48:51], v[124:127], v[72:75], v[48:51]
    v_mfma_f32_16x16x32_bf16 v[48:51], v[124:127], v[76:79], v[48:51]
    v_mfma_f32_16x16x32_bf16 v[48:51], v[124:127], v[80:83], v[48:51]
    s_nop 7
    v_add_f32_dpp v68, v48, v48 row_ror:8 row_mask:0xf bank_mask:0xf
    v_add_f32_dpp v69, v49, v49 row_ror:8 row_mask:0xf bank_mask:0xf
    v_add_f32_dpp v70, v50, v50 row_ror:8 row_mask:0xf bank_mask:0xf
    v_add_f32_dpp v71, v51, v51 row_ror:8 row_mask:0xf bank_mask:0xf
    v_cvt_pk_bf16_f32 v68, v68, v69
    v_cvt_pk_bf16_f32 v69, v70, v71
    buffer_store_dwordx2 v[68:69], v34, s[36:39], s28 offen sc1
nw_21:
    buffer_store_dwordx2 v[100:101], v19, s[36:39], s34 offen sc1
    buffer_store_dwordx2 v[102:103], v19, s[36:39], s45 offen sc1
    ds_read_b64_tr_b16 v[48:49], v21 offset:32768
    ds_read_b64_tr_b16 v[50:51], v21 offset:33792
    ds_read_b64_tr_b16 v[68:69], v27 offset:32768
    ds_read_b64_tr_b16 v[70:71], v27 offset:33792
    ds_read_b64_tr_b16 v[72:73], v21 offset:34816
    ds_read_b64_tr_b16 v[74:75], v21 offset:35840
    ds_read_b64_tr_b16 v[76:77], v27 offset:34816
    ds_read_b64_tr_b16 v[78:79], v27 offset:35840
    ds_read_b64_tr_b16 v[80:81], v21 offset:36864
    ds_read_b64_tr_b16 v[82:83], v21 offset:37888
    s_waitcnt lgkmcnt(8)
    v_mfma_f32_16x16x32_bf16 v[92:95], v[192:195], v[48:51], 0
    ds_read_b64_tr_b16 v[100:101], v27 offset:36864
    ds_read_b64_tr_b16 v[102:103], v27 offset:37888
    s_waitcnt lgkmcnt(8)
    v_mfma_f32_16x16x32_bf16 v[96:99], v[192:195], v[68:71], 0
    ds_read_b64_tr_b16 v[104:105], v21 offset:38912
    ds_read_b64_tr_b16 v[106:107], v21 offset:39936
    s_waitcnt lgkmcnt(8)
    v_mfma_f32_16x16x32_bf16 v[92:95], v[196:199], v[72:75], v[92:95]
    ds_read_b64_tr_b16 v[108:109], v27 offset:38912
    ds_read_b64_tr_b16 v[110:111], v27 offset:39936
    s_waitcnt lgkmcnt(8)
    v_mfma_f32_16x16x32_bf16 v[96:99], v[196:199], v[76:79], v[96:99]
    ds_read_b64_tr_b16 v[48:49], v26 offset:32768
    ds_read_b64_tr_b16 v[50:51], v26 offset:33792
    s_waitcnt lgkmcnt(8)
    v_mfma_f32_16x16x32_bf16 v[92:95], v[200:203], v[80:83], v[92:95]
    ds_read_b64_tr_b16 v[68:69], v28 offset:32768
    ds_read_b64_tr_b16 v[70:71], v28 offset:33792
    s_waitcnt lgkmcnt(8)
    v_mfma_f32_16x16x32_bf16 v[96:99], v[200:203], v[100:103], v[96:99]
    ds_read_b64_tr_b16 v[72:73], v26 offset:34816
    ds_read_b64_tr_b16 v[74:75], v26 offset:35840
    s_waitcnt lgkmcnt(8)
    v_mfma_f32_16x16x32_bf16 v[92:95], v[204:207], v[104:107], v[92:95]
    ds_read_b64_tr_b16 v[76:77], v28 offset:34816
    ds_read_b64_tr_b16 v[78:79], v28 offset:35840
    s_waitcnt lgkmcnt(8)
    v_mfma_f32_16x16x32_bf16 v[96:99], v[204:207], v[108:111], v[96:99]
    ds_read_b64_tr_b16 v[80:81], v26 offset:36864
    ds_read_b64_tr_b16 v[82:83], v26 offset:37888
    s_waitcnt lgkmcnt(8)
    v_mfma_f32_16x16x32_bf16 v[92:95], v[208:211], v[48:51], v[92:95]
    ds_read_b64_tr_b16 v[100:101], v28 offset:36864
    ds_read_b64_tr_b16 v[102:103], v28 offset:37888
    s_waitcnt lgkmcnt(8)
    v_mfma_f32_16x16x32_bf16 v[96:99], v[208:211], v[68:71], v[96:99]
    ds_read_b64_tr_b16 v[104:105], v26 offset:38912
    ds_read_b64_tr_b16 v[106:107], v26 offset:39936
    s_waitcnt lgkmcnt(8)
    v_mfma_f32_16x16x32_bf16 v[92:95], v[212:215], v[72:75], v[92:95]
    ds_read_b64_tr_b16 v[108:109], v28 offset:38912
    ds_read_b64_tr_b16 v[110:111], v28 offset:39936
    s_waitcnt lgkmcnt(8)
    v_mfma_f32_16x16x32_bf16 v[96:99], v[212:215], v[76:79], v[96:99]
    ds_read_b64_tr_b16 v[48:49], v21 offset:49152
    ds_read_b64_tr_b16 v[50:51], v21 offset:50176
    s_waitcnt lgkmcnt(8)
    v_mfma_f32_16x16x32_bf16 v[92:95], v[216:219], v[80:83], v[92:95]
    ds_read_b64_tr_b16 v[68:69], v27 offset:49152
    ds_read_b64_tr_b16 v[70:71], v27 offset:50176
    s_waitcnt lgkmcnt(8)
    v_mfma_f32_16x16x32_bf16 v[96:99], v[216:219], v[100:103], v[96:99]
    ds_read_b64_tr_b16 v[72:73], v21 offset:51200
    ds_read_b64_tr_b16 v[74:75], v21 offset:52224
    s_waitcnt lgkmcnt(8)
    v_mfma_f32_16x16x32_bf16 v[92:95], v[220:223], v[104:107], v[92:95]
    ds_read_b64_tr_b16 v[76:77], v27 offset:51200
    ds_read_b64_tr_b16 v[78:79], v27 offset:52224
    s_waitcnt lgkmcnt(8)
    v_mfma_f32_16x16x32_bf16 v[96:99], v[220:223], v[108:111], v[96:99]
    ds_read_b64_tr_b16 v[80:81], v21 offset:53248
    ds_read_b64_tr_b16 v[82:83], v21 offset:54272
    s_waitcnt lgkmcnt(8)
    v_mfma_f32_16x16x32_bf16 v[92:95], v[224:227], v[48:51], v[92:95]
    ds_read_b64_tr_b16 v[100:101], v27 offset:53248
    ds_read_b64_tr_b16 v[102:103], v27 offset:54272
    s_waitcnt lgkmcnt(8)
    v_mfma_f32_16x16x32_bf16 v[96:99], v[224:227], v[68:71], v[96:99]
    ds_read_b64_tr_b16 v[104:105], v21 offset:55296
    ds_read_b64_tr_b16 v[106:107], v21 offset:56320
    s_waitcnt lgkmcnt(8)
    v_mfma_f32_16x16x32_bf16 v[92:95], v[228:231], v[72:75], v[92:95]
    ds_read_b64_tr_b16 v[108:109], v27 offset:55296
    ds_read_b64_tr_b16 v[110:111], v27 offset:56320
    s_waitcnt lgkmcnt(8)
    v_mfma_f32_16x16x32_bf16 v[96:99], v[228:231], v[76:79], v[96:99]
    ds_read_b64_tr_b16 v[48:49], v26 offset:49152
    ds_read_b64_tr_b16 v[50:51], v26 offset:50176
    s_waitcnt lgkmcnt(8)
    v_mfma_f32_16x16x32_bf16 v[92:95], v[232:235], v[80:83], v[92:95]
    ds_read_b64_tr_b16 v[68:69], v28 offset:49152
    ds_read_b64_tr_b16 v[70:71], v28 offset:50176
    s_waitcnt lgkmcnt(8)
    v_mfma_f32_16x16x32_bf16 v[96:99], v[232:235], v[100:103], v[96:99]
    ds_read_b64_tr_b16 v[72:73], v26 offset:51200
    ds_read_b64_tr_b16 v[74:75], v26 offset:52224
    s_waitcnt lgkmcnt(8)
    v_mfma_f32_16x16x32_bf16 v[92:95], v[236:239], v[104:107], v[92:95]
    ds_read_b64_tr_b16 v[76:77], v28 offset:51200
    ds_read_b64_tr_b16 v[78:79], v28 offset:52224
    s_waitcnt lgkmcnt(8)
    v_mfma_f32_16x16x32_bf16 v[96:99], v[236:239], v[108:111], v[96:99]
    ds_read_b64_tr_b16 v[80:81], v26 offset:53248
    ds_read_b64_tr_b16 v[82:83], v26 offset:54272
    s_waitcnt lgkmcnt(8)
    v_mfma_f32_16x16x32_bf16 v[92:95], v[240:243], v[48:51], v[92:95]
    ds_read_b64_tr_b16 v[100:101], v28 offset:53248
    ds_read_b64_tr_b16 v[102:103], v28 offset:54272
    s_waitcnt lgkmcnt(8)
    v_mfma_f32_16x16x32_bf16 v[96:99], v[240:243], v[68:71], v[96:99]
    ds_read_b64_tr_b16 v[104:105], v26 offset:55296
    ds_read_b64_tr_b16 v[106:107], v26 offset:56320
    s_waitcnt lgkmcnt(8)
    v_mfma_f32_16x16x32_bf16 v[92:95], v[244:247], v[72:75], v[92:95]
    ds_read_b64_tr_b16 v[108:109], v28 offset:55296
    ds_read_b64_tr_b16 v[110:111], v28 offset:56320
    s_waitcnt lgkmcnt(8)
    v_mfma_f32_16x16x32_bf16 v[96:99], v[244:247], v[76:79], v[96:99]
    s_waitcnt lgkmcnt(6)
    v_mfma_f32_16x16x32_bf16 v[92:95], v[248:251], v[80:83], v[92:95]
    s_waitcnt lgkmcnt(4)
    v_mfma_f32_16x16x32_bf16 v[96:99], v[248:251], v[100:103], v[96:99]
    s_waitcnt lgkmcnt(2)
    v_mfma_f32_16x16x32_bf16 v[92:95], v[252:255], v[104:107], v[92:95]
    s_waitcnt lgkmcnt(0)
    v_mfma_f32_16x16x32_bf16 v[96:99], v[252:255], v[108:111], v[96:99]
    s_nop 5
    v_pk_fma_f32 v[92:93], v[40:41], v[120:121], v[92:93] op_sel_hi:[1,0,1] neg_lo:[1,0,0] neg_hi:[1,0,0]
    v_pk_fma_f32 v[92:93], v[92:93], v[120:121], v[56:57] op_sel:[0,1,0] op_sel_hi:[1,1,0]
    v_pk_mul_f32 v[58:59], v[92:93], v[56:57] op_sel:[0,1] op_sel_hi:[1,1]
    v_exp_f32_e64 v58, v58 clamp
    v_exp_f32_e64 v59, v59 clamp
    v_max_f32_e32 v92, v56, v92
    v_max_f32_e64 v93, v56, v93
    v_pk_add_f32 v[92:93], v[92:93], v[58:59]
    v_cvt_pk_bf16_f32 v48, v92, v93
    v_pk_fma_f32 v[94:95], v[42:43], v[120:121], v[94:95] op_sel_hi:[1,0,1] neg_lo:[1,0,0] neg_hi:[1,0,0]
    v_pk_fma_f32 v[94:95], v[94:95], v[120:121], v[56:57] op_sel:[0,1,0] op_sel_hi:[1,1,0]
    v_pk_mul_f32 v[58:59], v[94:95], v[56:57] op_sel:[0,1] op_sel_hi:[1,1]
    v_exp_f32_e64 v58, v58 clamp
    v_exp_f32_e64 v59, v59 clamp
    v_max_f32_e32 v94, v56, v94
    v_max_f32_e32 v95, v56, v95
    v_pk_add_f32 v[94:95], v[94:95], v[58:59]
    v_cvt_pk_bf16_f32 v49, v94, v95
    v_pk_fma_f32 v[96:97], v[40:41], v[122:123], v[96:97] op_sel_hi:[1,0,1] neg_lo:[1,0,0] neg_hi:[1,0,0]
    v_pk_fma_f32 v[96:97], v[96:97], v[122:123], v[56:57] op_sel:[0,1,0] op_sel_hi:[1,1,0]
    v_pk_mul_f32 v[58:59], v[96:97], v[56:57] op_sel:[0,1] op_sel_hi:[1,1]
    v_exp_f32_e64 v58, v58 clamp
    v_exp_f32_e64 v59, v59 clamp
    v_max_f32_e32 v96, v56, v96
    v_max_f32_e32 v97, v56, v97
    v_pk_add_f32 v[96:97], v[96:97], v[58:59]
    v_cvt_pk_bf16_f32 v50, v96, v97
    v_pk_fma_f32 v[98:99], v[42:43], v[122:123], v[98:99] op_sel_hi:[1,0,1] neg_lo:[1,0,0] neg_hi:[1,0,0]
    v_pk_fma_f32 v[98:99], v[98:99], v[122:123], v[56:57] op_sel:[0,1,0] op_sel_hi:[1,1,0]
    v_pk_mul_f32 v[58:59], v[98:99], v[56:57] op_sel:[0,1] op_sel_hi:[1,1]
    v_exp_f32_e64 v58, v58 clamp
    v_exp_f32_e64 v59, v59 clamp
    v_max_f32_e32 v98, v56, v98
    v_max_f32_e32 v99, v56, v99
    v_pk_add_f32 v[98:99], v[98:99], v[58:59]
    v_cvt_pk_bf16_f32 v51, v98, v99
    buffer_store_dwordx2 v[48:49], v19, s[36:39], s77 offen sc1
    buffer_store_dwordx2 v[50:51], v19, s[36:39], s80 offen sc1
    v_lshlrev_b32_e32 v68, 16, v60
    v_and_b32_e32 v69, s5, v60
    v_lshlrev_b32_e32 v70, 16, v61
    v_and_b32_e32 v71, s5, v61
    v_lshlrev_b32_e32 v72, 16, v62
    v_and_b32_e32 v73, s5, v62
    v_lshlrev_b32_e32 v74, 16, v63
    v_and_b32_e32 v75, s5, v63
    v_lshlrev_b32_e32 v76, 16, v64
    v_and_b32_e32 v77, s5, v64
    v_lshlrev_b32_e32 v78, 16, v65
    v_and_b32_e32 v79, s5, v65
    v_lshlrev_b32_e32 v80, 16, v66
    v_and_b32_e32 v81, s5, v66
    v_lshlrev_b32_e32 v82, 16, v67
    v_and_b32_e32 v83, s5, v67
    s_lshl_b32 s68, s67, 10
    s_lshl3_add_u32 s68, s75, s68
    s_add_u32 s24, s68, 0x800000
    s_add_u32 s25, s68, 0x801000
    s_mul_i32 s68, s56, 5120
    s_add_u32 s26, s68, 0xaa0000
    s_add_u32 s27, s68, 0xaa0a00
    s_lshl3_add_u32 s68, s75, 0x20000
    v_add_u32_e32 v3, s68, v6
    s_barrier
    buffer_load_dwordx4 v[84:87], v35, s[36:39], s24 offen sc1
    buffer_load_dwordx4 v[88:91], v35, s[36:39], s24 offen offset:1024 sc1
    buffer_load_dwordx4 v[92:95], v35, s[36:39], s24 offen offset:2048 sc1
    buffer_load_dwordx4 v[100:103], v35, s[36:39], s25 offen sc1
    buffer_load_dwordx4 v[104:107], v35, s[36:39], s25 offen offset:1024 sc1
    buffer_load_dwordx4 v[108:111], v35, s[36:39], s25 offen offset:2048 sc1
    buffer_load_dwordx4 v[116:119], v36, s[36:39], s26 offen sc1
    buffer_load_dwordx4 v[120:123], v36, s[36:39], s26 offen offset:640 sc1
    buffer_load_dwordx4 v[124:127], v36, s[36:39], s26 offen offset:1280 sc1
    buffer_load_dwordx4 v[132:135], v36, s[36:39], s27 offen sc1
    buffer_load_dwordx4 v[136:139], v36, s[36:39], s27 offen offset:640 sc1
    buffer_load_dwordx4 v[140:143], v36, s[36:39], s27 offen offset:1280 sc1
    buffer_load_dwordx4 v[128:131], v36, s[36:39], s26 offen offset:1920 sc1
    buffer_load_dwordx4 v[144:147], v36, s[36:39], s27 offen offset:1920 sc1
    s_mov_b64 exec, 0
    s_cmp_eq_u32 s56, 0
    s_cbranch_scc1 W3_0
    s_cmp_eq_u32 s56, 1
    s_cbranch_scc1 W3_1
    s_cmp_eq_u32 s56, 2
    s_cbranch_scc1 W3_2
    s_branch W3_3
W3_ret:
    s_mov_b64 exec, -1
    v_or_b32_e32 v2, s2, v0
    v_min_u32_e32 v2, 1, v2
    v_lshlrev_b32_e32 v2, 30, v2
    v_mov_b32_e32 v1, s61
    s_mov_b32 s71, 0
    buffer_store_dword v1, v2, s[36:39], s71 offen sc1
    s_waitcnt vmcnt(15)
    s_barrier
    buffer_load_dwordx4 v[96:99], v35, s[36:39], s24 offen offset:3072 sc1
    buffer_load_dwordx4 v[112:115], v35, s[36:39], s25 offen offset:3072 sc1
    s_branch chk_26
retry_25:
    s_cmp_eq_u32 s63, 0
    s_cbranch_scc1 ok_27
    s_sub_u32 s63, s63, 1
    s_mov_b64 exec, vcc
    buffer_load_dwordx4 v[84:87], v35, s[36:39], s24 offen sc1
    buffer_load_dwordx4 v[88:91], v35, s[36:39], s24 offen offset:1024 sc1
    buffer_load_dwordx4 v[92:95], v35, s[36:39], s24 offen offset:2048 sc1
    buffer_load_dwordx4 v[100:103], v35, s[36:39], s25 offen sc1
    buffer_load_dwordx4 v[104:107], v35, s[36:39], s25 offen offset:1024 sc1
    buffer_load_dwordx4 v[108:111], v35, s[36:39], s25 offen offset:2048 sc1
    s_mov_b64 exec, -1
    s_waitcnt vmcnt(0)
chk_26:
    s_waitcnt vmcnt(16)
    v_or_b32_e32 v1, v84, v86
    s_waitcnt vmcnt(15)
    v_or3_b32 v1, v1, v88, v90
    s_waitcnt vmcnt(14)
    v_or3_b32 v1, v1, v92, v94
    s_waitcnt vmcnt(13)
    v_or3_b32 v1, v1, v100, v102
    s_waitcnt vmcnt(12)
    v_or3_b32 v1, v1, v104, v106
    s_waitcnt vmcnt(11)
    v_or3_b32 v1, v1, v108, v110
    v_cmp_gt_i32_e32 vcc, 0, v1
    s_cbranch_vccnz retry_25
ok_27:
    s_waitcnt vmcnt(10)
    v_max_u32_e32 v1, v116, v118
    s_waitcnt vmcnt(9)
    v_max3_u32 v1, v1, v120, v122
    s_waitcnt vmcnt(8)
    v_max3_u32 v1, v1, v124, v126
    s_waitcnt vmcnt(7)
    v_max3_u32 v1, v1, v132, v134
    s_waitcnt vmcnt(6)
    v_max3_u32 v1, v1, v136, v138
    s_waitcnt vmcnt(5)
    v_max3_u32 v1, v1, v140, v142
    s_waitcnt vmcnt(4)
    v_max3_u32 v1, v1, v128, v130
    s_waitcnt vmcnt(3)
    v_max3_u32 v1, v1, v144, v146
    v_cmp_eq_u32_e32 vcc, -1, v1
    s_cbranch_vccnz retry_28
ok_29:
    v_mfma_f32_32x32x16_bf16 v[48:63], v[116:119], v[84:87], 0
    buffer_load_dwordx4 a[172:175], v6, s[36:39], s17 offen offset:3072 sc1
    buffer_load_dwordx4 a[176:179], v6, s[36:39], s18 offen sc1
    v_mfma_f32_32x32x16_bf16 v[148:163], v[120:123], v[88:91], 0
    v_mfma_f32_32x32x16_bf16 v[164:179], v[124:127], v[92:95], 0
    buffer_load_dwordx4 a[180:183], v6, s[36:39], s18 offen offset:1024 sc1
    s_nop 6
    v_add_f32_e32 v46, 0x358637bd, v56
    v_rcp_f32_e32 v46, v46
    s_nop 0
    v_pk_mul_f32 v[48:49], v[48:49], v[46:47] op_sel_hi:[1,0]
    v_pk_mul_f32 v[50:51], v[50:51], v[46:47] op_sel_hi:[1,0]
    v_pk_mul_f32 v[52:53], v[52:53], v[46:47] op_sel_hi:[1,0]
    v_pk_mul_f32 v[54:55], v[54:55], v[46:47] op_sel_hi:[1,0]
    v_cvt_pk_bf16_f32 v84, v48, v49
    v_cvt_pk_bf16_f32 v85, v50, v51
    v_cvt_pk_bf16_f32 v86, v52, v53
    v_cvt_pk_bf16_f32 v87, v54, v55
    v_mfma_f32_32x32x16_bf16 v[48:63], v[132:135], v[100:103], 0
    buffer_load_dwordx4 a[184:187], v6, s[36:39], s18 offen offset:2048 sc1
    v_add_f32_e32 v46, 0x358637bd, v156
    v_rcp_f32_e64 v46, v46
    ds_write_b128 v3, v[84:87]
    v_pk_mul_f32 v[148:149], v[148:149], v[46:47] op_sel_hi:[1,0]
    v_pk_mul_f32 v[150:151], v[150:151], v[46:47] op_sel_hi:[1,0]
    v_pk_mul_f32 v[152:153], v[152:153], v[46:47] op_sel_hi:[1,0]
    v_pk_mul_f32 v[154:155], v[154:155], v[46:47] op_sel_hi:[1,0]
    v_cvt_pk_bf16_f32 v88, v148, v149
    v_cvt_pk_bf16_f32 v89, v150, v151
    v_cvt_pk_bf16_f32 v90, v152, v153
    v_cvt_pk_bf16_f32 v91, v154, v155
    v_mfma_f32_32x32x16_bf16 v[148:163], v[136:139], v[104:107], 0
    buffer_load_dwordx4 a[188:191], v6, s[36:39], s18 offen offset:3072 sc1
    v_add_f32_e32 v46, 0x358637bd, v172
    v_rcp_f32_e64 v46, v46
    ds_write_b128 v3, v[88:91] offset:1024
    v_pk_mul_f32 v[164:165], v[164:165], v[46:47] op_sel_hi:[1,0]
    v_pk_mul_f32 v[166:167], v[166:167], v[46:47] op_sel_hi:[1,0]
    v_pk_mul_f32 v[168:169], v[168:169], v[46:47] op_sel_hi:[1,0]
    v_pk_mul_f32 v[170:171], v[170:171], v[46:47] op_sel_hi:[1,0]
    v_cvt_pk_bf16_f32 v92, v164, v165
    v_cvt_pk_bf16_f32 v93, v166, v167
    v_cvt_pk_bf16_f32 v94, v168, v169
    v_cvt_pk_bf16_f32 v95, v170, v171
    v_mfma_f32_32x32x16_bf16 v[164:179], v[140:143], v[108:111], 0
    buffer_load_dwordx4 a[192:195], v6, s[36:39], s19 offen sc1
    v_add_f32_e32 v46, 0x358637bd, v56
    v_rcp_f32_e64 v46, v46
    ds_write_b128 v3, v[92:95] offset:2048
    v_pk_mul_f32 v[48:49], v[48:49], v[46:47] op_sel_hi:[1,0]
    v_pk_mul_f32 v[50:51], v[50:51], v[46:47] op_sel_hi:[1,0]
    v_pk_mul_f32 v[52:53], v[52:53], v[46:47] op_sel_hi:[1,0]
    v_pk_mul_f32 v[54:55], v[54:55], v[46:47] op_sel_hi:[1,0]
    v_cvt_pk_bf16_f32 v100, v48, v49
    v_cvt_pk_bf16_f32 v101, v50, v51
    v_cvt_pk_bf16_f32 v102, v52, v53
    v_cvt_pk_bf16_f32 v103, v54, v55
    s_waitcnt vmcnt(7)
    v_or_b32_e32 v1, v96, v98
    s_waitcnt vmcnt(6)
    v_or3_b32 v1, v1, v112, v114
    v_cmp_gt_i32_e32 vcc, 0, v1
    s_cbranch_vccnz retry_30
ok_31:
    v_mfma_f32_32x32x16_bf16 v[48:63], v[128:131], v[96:99], 0
    buffer_load_dwordx4 a[196:199], v6, s[36:39], s19 offen offset:1024 sc1
    v_add_f32_e32 v46, 0x358637bd, v156
    v_rcp_f32_e32 v46, v46
    ds_write_b128 v3, v[100:103] offset:4096
    v_pk_mul_f32 v[148:149], v[148:149], v[46:47] op_sel_hi:[1,0]
    v_pk_mul_f32 v[150:151], v[150:151], v[46:47] op_sel_hi:[1,0]
    v_pk_mul_f32 v[152:153], v[152:153], v[46:47] op_sel_hi:[1,0]
    v_pk_mul_f32 v[154:155], v[154:155], v[46:47] op_sel_hi:[1,0]
    v_cvt_pk_bf16_f32 v104, v148, v149
    v_cvt_pk_bf16_f32 v105, v150, v151
    v_cvt_pk_bf16_f32 v106, v152, v153
    v_cvt_pk_bf16_f32 v107, v154, v155
    v_mfma_f32_32x32x16_bf16 v[148:163], v[144:147], v[112:115], 0
    buffer_load_dwordx4 a[200:203], v6, s[36:39], s19 offen offset:2048 sc1
    v_add_f32_e32 v46, 0x358637bd, v172
    v_rcp_f32_e64 v46, v46
    ds_write_b128 v3, v[104:107] offset:5120
    v_pk_mul_f32 v[164:165], v[164:165], v[46:47] op_sel_hi:[1,0]
    v_pk_mul_f32 v[166:167], v[166:167], v[46:47] op_sel_hi:[1,0]
    v_pk_mul_f32 v[168:169], v[168:169], v[46:47] op_sel_hi:[1,0]
    v_pk_mul_f32 v[170:171], v[170:171], v[46:47] op_sel_hi:[1,0]
    v_cvt_pk_bf16_f32 v108, v164, v165
    v_cvt_pk_bf16_f32 v109, v166, v167
    v_cvt_pk_bf16_f32 v110, v168, v169
    v_cvt_pk_bf16_f32 v111, v170, v171
    buffer_load_dwordx4 a[204:207], v6, s[36:39], s19 offen offset:3072 sc1
    v_add_f32_e32 v46, 0x358637bd, v56
    v_rcp_f32_e64 v46, v46
    ds_write_b128 v3, v[108:111] offset:6144
    v_pk_mul_f32 v[48:49], v[48:49], v[46:47] op_sel_hi:[1,0]
    v_pk_mul_f32 v[50:51], v[50:51], v[46:47] op_sel_hi:[1,0]
    v_pk_mul_f32 v[52:53], v[52:53], v[46:47] op_sel_hi:[1,0]
    v_pk_mul_f32 v[54:55], v[54:55], v[46:47] op_sel_hi:[1,0]
    v_cvt_pk_bf16_f32 v96, v48, v49
    v_cvt_pk_bf16_f32 v97, v50, v51
    v_cvt_pk_bf16_f32 v98, v52, v53
    v_cvt_pk_bf16_f32 v99, v54, v55
    buffer_load_dwordx4 a[208:211], v6, s[36:39], s20 offen sc1
    v_add_f32_e32 v46, 0x358637bd, v156
    v_rcp_f32_e64 v46, v46
    ds_write_b128 v3, v[96:99] offset:3072
    v_pk_mul_f32 v[148:149], v[148:149], v[46:47] op_sel_hi:[1,0]
    v_pk_mul_f32 v[150:151], v[150:151], v[46:47] op_sel_hi:[1,0]
    v_pk_mul_f32 v[152:153], v[152:153], v[46:47] op_sel_hi:[1,0]
    v_pk_mul_f32 v[154:155], v[154:155], v[46:47] op_sel_hi:[1,0]
    v_cvt_pk_bf16_f32 v112, v148, v149
    v_cvt_pk_bf16_f32 v113, v150, v151
    v_cvt_pk_bf16_f32 v114, v152, v153
    v_cvt_pk_bf16_f32 v115, v154, v155
    buffer_load_dwordx4 a[212:215], v6, s[36:39], s20 offen offset:1024 sc1
    ds_write_b128 v3, v[112:115] offset:7168
    v_mfma_f32_32x32x16_bf16 v[68:83], a[128:131], v[84:87], v[68:83]
    v_xor_b32_e32 v1, 0x2000, v3
    buffer_load_dwordx4 a[216:219], v6, s[36:39], s20 offen offset:2048 sc1
    buffer_load_dwordx4 a[220:223], v6, s[36:39], s20 offen offset:3072 sc1
    v_mfma_f32_32x32x16_bf16 v[68:83], a[132:135], v[88:91], v[68:83]
    v_xor_b32_e32 v2, 0x4000, v3
    buffer_load_dwordx4 a[224:227], v6, s[36:39], s21 offen sc1
    buffer_load_dwordx4 a[228:231], v6, s[36:39], s21 offen offset:1024 sc1
    v_mfma_f32_32x32x16_bf16 v[68:83], a[136:139], v[92:95], v[68:83]
    v_xor_b32_e32 v4, 0x6000, v3
    buffer_load_dwordx4 a[232:235], v6, s[36:39], s21 offen offset:2048 sc1
    buffer_load_dwordx4 a[236:239], v6, s[36:39], s21 offen offset:3072 sc1
    v_mfma_f32_32x32x16_bf16 v[68:83], a[140:143], v[96:99], v[68:83]
    buffer_load_dwordx4 a[240:243], v6, s[36:39], s22 offen sc1
    buffer_load_dwordx4 a[244:247], v6, s[36:39], s22 offen offset:1024 sc1
    v_mfma_f32_32x32x16_bf16 v[68:83], a[144:147], v[100:103], v[68:83]
    s_waitcnt lgkmcnt(0)
    s_barrier
    ds_read_b128 v[56:59], v1
    ds_read_b128 v[60:63], v1 offset:1024
    buffer_load_dwordx4 a[248:251], v6, s[36:39], s22 offen offset:2048 sc1
    buffer_load_dwordx4 a[252:255], v6, s[36:39], s22 offen offset:3072 sc1
    v_mfma_f32_32x32x16_bf16 v[68:83], a[148:151], v[104:107], v[68:83]
    ds_read_b128 v[64:67], v1 offset:2048
    ds_read_b128 v[116:119], v1 offset:3072
    v_mfma_f32_32x32x16_bf16 v[68:83], a[152:155], v[108:111], v[68:83]
    ds_read_b128 v[48:51], v1 offset:4096
    v_mfma_f32_32x32x16_bf16 v[68:83], a[156:159], v[112:115], v[68:83]
    ds_read_b128 v[52:55], v1 offset:5120
    s_waitcnt lgkmcnt(4)
    v_mfma_f32_32x32x16_bf16 v[68:83], a[160:163], v[56:59], v[68:83]
    ds_read_b128 v[56:59], v1 offset:6144
    s_add_u32 s7, s7, 0x280000
    v_mfma_f32_32x32x16_bf16 v[68:83], a[164:167], v[60:63], v[68:83]
    ds_read_b128 v[60:63], v1 offset:7168
    s_add_u32 s8, s8, 0x280000
    s_waitcnt lgkmcnt(3)
    v_mfma_f32_32x32x16_bf16 v[68:83], a[168:171], v[64:67], v[68:83]
    ds_read_b128 v[64:67], v2
    s_add_u32 s9, s9, 0x280000
    s_waitcnt vmcnt(20)
    v_mfma_f32_32x32x16_bf16 v[68:83], a[172:175], v[116:119], v[68:83]
    ds_read_b128 v[116:119], v2 offset:1024
    s_add_u32 s10, s10, 0x280000
    s_waitcnt vmcnt(19)
    v_mfma_f32_32x32x16_bf16 v[68:83], a[176:179], v[48:51], v[68:83]
    ds_read_b128 v[48:51], v2 offset:2048
    s_add_u32 s11, s11, 0x280000
    s_add_u32 s71, s74, 0x210000
    buffer_store_dwordx4 v[22:25], v11, s[36:39], s71 offen sc1
    s_add_u32 s71, s74, 0x311000
    buffer_store_dwordx4 v[22:25], v11, s[36:39], s71 offen sc1
    s_waitcnt vmcnt(20) lgkmcnt(3)
    v_mfma_f32_32x32x16_bf16 v[68:83], a[180:183], v[52:55], v[68:83]
    ds_read_b128 v[52:55], v2 offset:3072
    s_add_u32 s12, s12, 0x280000
    s_waitcnt vmcnt(19)
    v_mfma_f32_32x32x16_bf16 v[68:83], a[184:187], v[56:59], v[68:83]
    ds_read_b128 v[56:59], v2 offset:4096
    s_add_u32 s13, s13, 0x280000
    s_waitcnt vmcnt(18)
    v_mfma_f32_32x32x16_bf16 v[68:83], a[188:191], v[60:63], v[68:83]
    ds_read_b128 v[60:63], v2 offset:5120
    s_add_u32 s14, s14, 0x280000
    s_waitcnt vmcnt(17) lgkmcnt(3)
    v_mfma_f32_32x32x16_bf16 v[68:83], a[192:195], v[64:67], v[68:83]
    ds_read_b128 v[64:67], v2 offset:6144
    s_waitcnt vmcnt(16)
    v_mfma_f32_32x32x16_bf16 v[68:83], a[196:199], v[116:119], v[68:83]
    ds_read_b128 v[116:119], v2 offset:7168
    s_waitcnt vmcnt(15)
    v_mfma_f32_32x32x16_bf16 v[68:83], a[200:203], v[48:51], v[68:83]
    ds_read_b128 v[48:51], v4
    s_waitcnt vmcnt(14) lgkmcnt(3)
    v_mfma_f32_32x32x16_bf16 v[68:83], a[204:207], v[52:55], v[68:83]
    ds_read_b128 v[52:55], v4 offset:1024
    s_waitcnt vmcnt(13)
    v_mfma_f32_32x32x16_bf16 v[68:83], a[208:211], v[56:59], v[68:83]
    ds_read_b128 v[56:59], v4 offset:2048
    s_waitcnt vmcnt(12)
    v_mfma_f32_32x32x16_bf16 v[68:83], a[212:215], v[60:63], v[68:83]
    ds_read_b128 v[60:63], v4 offset:3072
    s_waitcnt vmcnt(11) lgkmcnt(3)
    v_mfma_f32_32x32x16_bf16 v[68:83], a[216:219], v[64:67], v[68:83]
    ds_read_b128 v[64:67], v4 offset:4096
    s_waitcnt vmcnt(10)
    v_mfma_f32_32x32x16_bf16 v[68:83], a[220:223], v[116:119], v[68:83]
    ds_read_b128 v[116:119], v4 offset:5120
    s_waitcnt vmcnt(9)
    v_mfma_f32_32x32x16_bf16 v[68:83], a[224:227], v[48:51], v[68:83]
    ds_read_b128 v[48:51], v4 offset:6144
    s_waitcnt vmcnt(8) lgkmcnt(3)
    v_mfma_f32_32x32x16_bf16 v[68:83], a[228:231], v[52:55], v[68:83]
    ds_read_b128 v[52:55], v4 offset:7168
    s_waitcnt vmcnt(7)
    v_mfma_f32_32x32x16_bf16 v[68:83], a[232:235], v[56:59], v[68:83]
    s_waitcnt vmcnt(6)
    v_mfma_f32_32x32x16_bf16 v[68:83], a[236:239], v[60:63], v[68:83]
    s_waitcnt vmcnt(5) lgkmcnt(1)
    v_mfma_f32_32x32x16_bf16 v[68:83], a[240:243], v[64:67], v[68:83]
    s_waitcnt vmcnt(4)
    v_mfma_f32_32x32x16_bf16 v[68:83], a[244:247], v[116:119], v[68:83]
    s_waitcnt vmcnt(3)
    v_mfma_f32_32x32x16_bf16 v[68:83], a[248:251], v[48:51], v[68:83]
    s_waitcnt vmcnt(2) lgkmcnt(0)
    v_mfma_f32_32x32x16_bf16 v[68:83], a[252:255], v[52:55], v[68:83]
    s_mov_b32 s15, 0x10000
    s_mov_b32 s16, 0x12000
    s_mov_b32 s17, 0x14000
    s_mov_b32 s18, 0x16000
    s_mov_b32 s20, 0x11000
    s_mov_b32 s21, 0x13000
    s_mov_b32 s22, 0x15000
    s_mov_b32 s24, 0x17000
    s_mul_i32 s68, s57, 8320
    s_add_u32 s19, s68, 0x580000
    s_add_u32 s25, s68, 0x581000
    s_nop 0
    v_cvt_pk_bf16_f32 v48, v68, v69
    v_cvt_pk_bf16_f32 v49, v70, v71
    v_cvt_pk_bf16_f32 v50, v72, v73
    v_cvt_pk_bf16_f32 v51, v74, v75
    v_cvt_pk_bf16_f32 v52, v76, v77
    v_cvt_pk_bf16_f32 v53, v78, v79
    v_cvt_pk_bf16_f32 v54, v80, v81
W3_0:
    s_cbranch_execz W3_4
    v_cvt_pk_bf16_f32 v55, v82, v83
    v_dot2_f32_bf16 v1, v48, s4, 0
    v_dot2_f32_bf16 v2, v48, v48, 0
    v_dot2_f32_bf16 v1, v49, s4, v1
    v_dot2_f32_bf16 v2, v49, v49, v2
    v_dot2_f32_bf16 v1, v50, s4, v1
    v_dot2_f32_bf16 v2, v50, v50, v2
    v_dot2_f32_bf16 v1, v51, s4, v1
    v_dot2_f32_bf16 v2, v51, v51, v2
    v_dot2_f32_bf16 v1, v52, s4, v1
    v_dot2_f32_bf16 v2, v52, v52, v2
    v_dot2_f32_bf16 v1, v53, s4, v1
    v_dot2_f32_bf16 v2, v53, v53, v2
    v_dot2_f32_bf16 v1, v54, s4, v1
    v_dot2_f32_bf16 v2, v54, v54, v2
    v_dot2_f32_bf16 v1, v55, s4, v1
    v_dot2_f32_bf16 v2, v55, v55, v2
    buffer_store_dword v48, v7, s[36:39], s7 offen sc1
    buffer_store_dword v49, v7, s[36:39], s8 offen sc1
    buffer_store_dword v50, v7, s[36:39], s9 offen sc1
    v_permlane32_swap_b32 v1, v2
    v_add_f32_e64 v1, v1, v2
    ds_write_b32 v9, v1
    buffer_store_dword v51, v7, s[36:39], s10 offen sc1
    buffer_store_dword v52, v7, s[36:39], s11 offen sc1
    buffer_store_dword v53, v7, s[36:39], s12 offen sc1
    buffer_store_dword v54, v7, s[36:39], s13 offen sc1
    buffer_store_dword v55, v7, s[36:39], s14 offen sc1
    s_waitcnt vmcnt(8)
    s_waitcnt lgkmcnt(0)
    s_barrier
    s_cmp_lg_u32 s56, 0
    s_cbranch_scc1 nw_32
    ds_read_b128 v[56:59], v10
    ds_read_b128 v[60:63], v10 offset:512
    s_add_u32 s71, s73, 0x8000
    s_waitcnt lgkmcnt(1)
    v_pk_add_f32 v[56:57], v[56:57], v[58:59]
    s_waitcnt lgkmcnt(0)
    v_pk_add_f32 v[60:61], v[60:61], v[62:63]
    v_add_f32_e32 v56, v56, v57
    v_add_f32_e64 v60, v60, v61
    v_mul_f32_e32 v56, 0x3b800000, v56
    v_mul_f32_e32 v60, 0x3b000000, v60
    v_fma_f32 v60, -v56, v56, v60
    v_max_f32_e32 v60, 0, v60
    v_sqrt_f32_e32 v60, v60
    s_nop 0
    v_cvt_pk_bf16_f32 v56, v56, v60
    buffer_store_dword v56, v8, s[36:39], s71 offen sc1
nw_32:
    s_waitcnt vmcnt(0)
    s_barrier
    s_lshl_b32 s68, s66, 8
    s_sub_u32 s68, 0x100, s68
    v_add_u32_e64 v1, s68, v14
    v_add_u32_e32 v2, 0x400, v1
    ds_read2_b32 v[48:49], v2 offset0:192 offset1:193
    ds_read2_b32 v[50:51], v2 offset0:194 offset1:195
    ds_read2_b32 v[52:53], v2 offset0:64 offset1:65
    ds_read2_b32 v[54:55], v2 offset0:66 offset1:67
    ds_read2_b32 v[56:57], v1 offset0:192 offset1:193
    ds_read2_b32 v[58:59], v1 offset0:194 offset1:195
    ds_read2_b32 v[60:61], v1 offset0:64 offset1:65
    ds_read2_b32 v[62:63], v1 offset0:66 offset1:67
    ds_read2_b32 v[64:65], v2 offset0:176 offset1:177
    ds_read2_b32 v[66:67], v2 offset0:178 offset1:179
    ds_read2_b32 v[68:69], v2 offset0:48 offset1:49
    ds_read2_b32 v[70:71], v2 offset0:50 offset1:51
    ds_read2_b32 v[72:73], v1 offset0:176 offset1:177
    ds_read2_b32 v[74:75], v1 offset0:178 offset1:179
    ds_read2_b32 v[76:77], v1 offset0:48 offset1:49
    ds_read2_b32 v[78:79], v1 offset0:50 offset1:51
    ds_read2_b32 v[80:81], v2 offset0:160 offset1:161
    ds_read2_b32 v[82:83], v2 offset0:162 offset1:163
    ds_read2_b32 v[84:85], v2 offset0:32 offset1:33
    ds_read2_b32 v[86:87], v2 offset0:34 offset1:35
    ds_read2_b32 v[88:89], v1 offset0:160 offset1:161
    ds_read2_b32 v[90:91], v1 offset0:162 offset1:163
    ds_read2_b32 v[92:93], v1 offset0:32 offset1:33
    ds_read2_b32 v[94:95], v1 offset0:34 offset1:35
    ds_read2_b32 v[96:97], v2 offset0:144 offset1:145
    ds_read2_b32 v[98:99], v2 offset0:146 offset1:147
    ds_read2_b32 v[100:101], v2 offset0:16 offset1:17
    ds_read2_b32 v[102:103], v2 offset0:18 offset1:19
    ds_read2_b32 v[104:105], v1 offset0:144 offset1:145
    ds_read2_b32 v[106:107], v1 offset0:146 offset1:147
    ds_read2_b32 v[108:109], v1 offset0:16 offset1:17
    ds_read2_b32 v[110:111], v1 offset0:18 offset1:19
    v_add_u32_e32 v46, 0x1ac00, v6
    ds_read_b128 v[112:115], v46 offset:2048
    s_lshl_b32 s68, s65, 10
    v_add_u32_e32 v47, s68, v46
    v_add_u32_e32 v3, 0x18c00, v13
    v_add_u32_e32 v4, 0x18c00, v20
    s_mul_i32 s68, s58, 32896
    s_add_u32 s7, s68, 0xe10000
    s_add_u32 s8, s68, 0xe12000
    s_add_u32 s9, s68, 0xe14000
    s_add_u32 s10, s68, 0xe16000
    s_add_u32 s11, s68, 0xf11000
    s_add_u32 s12, s68, 0xf13000
    s_add_u32 s13, s68, 0xf15000
    s_add_u32 s14, s68, 0xf17000
    s_lshl_b32 s26, s56, 11
    s_add_u32 s23, s23, 0x700000
    s_cmp_lg_u32 s66, 0
    s_cbranch_scc1 arm_33
    s_add_u32 s27, s74, 0x210000
    s_add_u32 s28, s74, 0x2d0c00
    s_add_u32 s29, s74, 0x311000
    s_add_u32 s30, s74, 0x3d1c00
    buffer_load_dwordx4 v[120:123], v13, s[36:39], s15 offen sc1
    buffer_load_dwordx4 v[124:127], v13, s[36:39], s16 offen sc1
    buffer_load_dwordx4 v[128:131], v13, s[36:39], s17 offen sc1
    buffer_load_dwordx4 v[132:135], v13, s[36:39], s18 offen sc1
    buffer_load_dwordx4 v[152:155], v13, s[36:39], s19 offen sc1
    s_waitcnt vmcnt(4) lgkmcnt(0)
    v_mfma_f32_16x16x32_bf16 v[160:163], v[112:115], v[120:123], 0
    v_max_u32_e32 v1, v120, v121
    v_max3_u32 v1, v1, v122, v123
    s_waitcnt vmcnt(3)
    v_mfma_f32_16x16x32_bf16 v[160:163], v[112:115], v[124:127], v[160:163]
    v_max3_u32 v1, v1, v124, v125
    v_max3_u32 v1, v1, v126, v127
    s_waitcnt vmcnt(2)
    v_mfma_f32_16x16x32_bf16 v[160:163], v[112:115], v[128:131], v[160:163]
    v_max3_u32 v1, v1, v128, v129
    v_max3_u32 v1, v1, v130, v131
    s_waitcnt vmcnt(1)
    v_mfma_f32_16x16x32_bf16 v[160:163], v[112:115], v[132:135], v[160:163]
    v_max3_u32 v1, v1, v132, v133
    v_max3_u32 v1, v1, v134, v135
    s_waitcnt vmcnt(0)
    v_max3_u32 v1, v1, v152, v153
    v_max3_u32 v1, v1, v154, v155
    v_cmp_eq_u32_e32 vcc, -1, v1
    s_cbranch_vccnz retry_35
ok_36:
    v_dot2_f32_bf16 v116, v120, v120, s6
    v_dot2_f32_bf16 v117, v121, v121, s6
    v_dot2_f32_bf16 v118, v122, v122, s6
    v_dot2_f32_bf16 v119, v123, v123, s6
    v_dot2_f32_bf16 v116, v124, v124, v116
    v_dot2_f32_bf16 v117, v125, v125, v117
    v_dot2_f32_bf16 v118, v126, v126, v118
    v_dot2_f32_bf16 v119, v127, v127, v119
    v_dot2_f32_bf16 v116, v128, v128, v116
    v_dot2_f32_bf16 v117, v129, v129, v117
    v_dot2_f32_bf16 v118, v130, v130, v118
    v_dot2_f32_bf16 v119, v131, v131, v119
    v_dot2_f32_bf16 v116, v132, v132, v116
    v_dot2_f32_bf16 v117, v133, v133, v117
    v_dot2_f32_bf16 v118, v134, v134, v118
    v_dot2_f32_bf16 v119, v135, v135, v119
    ds_write_b128 v3, v[152:155]
    v_pk_mul_f32 v[160:161], v[160:161], 0.5 op_sel_hi:[1,0]
    v_pk_mul_f32 v[162:163], v[162:163], 0.5 op_sel_hi:[1,0]
    v_lshlrev_b32_e32 v164, 16, v152
    v_pk_fma_f32 v[116:117], v[160:161], v[160:161], v[116:117] neg_lo:[1,0,0] neg_hi:[1,0,0]
    v_pk_fma_f32 v[118:119], v[162:163], v[162:163], v[118:119] neg_lo:[1,0,0] neg_hi:[1,0,0]
    v_rsq_f32_e32 v116, v116
    v_rsq_f32_e32 v117, v117
    v_rsq_f32_e32 v118, v118
    v_rsq_f32_e32 v119, v119
    v_lshlrev_b32_e32 v165, 16, v153
    v_lshlrev_b32_e32 v166, 16, v154
    v_lshlrev_b32_e32 v167, 16, v155
    v_and_b32_e32 v168, s5, v152
    v_and_b32_e32 v169, s5, v153
    v_and_b32_e32 v170, s5, v154
    v_and_b32_e64 v171, s5, v155
    v_pk_mul_f32 v[160:161], v[160:161], v[116:117] neg_lo:[1,0] neg_hi:[1,0]
    v_pk_mul_f32 v[162:163], v[162:163], v[118:119] neg_lo:[1,0] neg_hi:[1,0]
    v_pk_fma_f32 v[164:165], v[164:165], v[116:117], v[160:161]
    v_pk_fma_f32 v[166:167], v[166:167], v[118:119], v[162:163]
    v_pk_fma_f32 v[168:169], v[168:169], v[116:117], v[160:161]
    v_pk_fma_f32 v[170:171], v[170:171], v[118:119], v[162:163]
    v_cvt_pk_bf16_f32 v152, v164, v165
    v_cvt_pk_bf16_f32 v153, v166, v167
    v_cvt_pk_bf16_f32 v154, v168, v169
    v_cvt_pk_bf16_f32 v155, v170, v171
    ds_write2st64_b64 v16, v[152:153], v[154:155] offset0:0 offset1:10
    buffer_load_dwordx4 v[136:139], v13, s[36:39], s20 offen sc1
    buffer_load_dwordx4 v[140:143], v13, s[36:39], s21 offen sc1
    buffer_load_dwordx4 v[144:147], v13, s[36:39], s22 offen sc1
    buffer_load_dwordx4 v[148:151], v13, s[36:39], s24 offen sc1
    buffer_load_dwordx4 v[156:159], v13, s[36:39], s25 offen sc1
    s_waitcnt lgkmcnt(0)
    s_barrier
    ds_read_b128 v[132:135], v15 offset:448
    ds_read_b128 v[152:155], v15 offset:960
    ds_read_b128 v[160:163], v15 offset:1472
    ds_read_b128 v[164:167], v15 offset:384
    s_waitcnt lgkmcnt(3)
    v_mfma_f32_16x16x32_bf16 v[120:123], v[52:55], v[132:135], 0
    ds_read_b128 v[168:171], v15 offset:896
    v_mfma_f32_16x16x32_bf16 v[124:127], v[56:59], v[132:135], 0
    ds_read_b128 v[172:175], v15 offset:1408
    s_waitcnt lgkmcnt(4)
    v_mfma_f32_16x16x32_bf16 v[120:123], v[48:51], v[152:155], v[120:123]
    ds_read_b128 v[176:179], v15 offset:320
    v_mfma_f32_16x16x32_bf16 v[124:127], v[52:55], v[152:155], v[124:127]
    ds_read_b128 v[180:183], v15 offset:832
    s_waitcnt lgkmcnt(5)
    v_mfma_f32_16x16x32_bf16 v[124:127], v[48:51], v[160:163], v[124:127]
    ds_read_b128 v[184:187], v15 offset:1344
    s_waitcnt lgkmcnt(5)
    v_mfma_f32_16x16x32_bf16 v[120:123], v[68:71], v[164:167], v[120:123]
    ds_read_b128 v[132:135], v15 offset:256
    v_mfma_f32_16x16x32_bf16 v[124:127], v[72:75], v[164:167], v[124:127]
    ds_read_b128 v[152:155], v15 offset:768
    s_waitcnt lgkmcnt(6)
    v_mfma_f32_16x16x32_bf16 v[120:123], v[64:67], v[168:171], v[120:123]
    ds_read_b128 v[160:163], v15 offset:1280
    v_mfma_f32_16x16x32_bf16 v[124:127], v[68:71], v[168:171], v[124:127]
    s_waitcnt lgkmcnt(5)
    v_mfma_f32_16x16x32_bf16 v[124:127], v[64:67], v[172:175], v[124:127]
    v_mfma_f32_16x16x32_bf16 v[120:123], v[84:87], v[176:179], v[120:123]
    ds_read_b128 v[164:167], v15 offset:1792
    v_mfma_f32_16x16x32_bf16 v[124:127], v[88:91], v[176:179], v[124:127]
    ds_read_b128 v[168:171], v15 offset:320
    s_waitcnt lgkmcnt(4)
    v_mfma_f32_16x16x32_bf16 v[120:123], v[80:83], v[180:183], v[120:123]
    v_mfma_f32_16x16x32_bf16 v[124:127], v[84:87], v[180:183], v[124:127]
    ds_read_b128 v[172:175], v15 offset:832
    v_mfma_f32_16x16x32_bf16 v[124:127], v[80:83], v[184:187], v[124:127]
    ds_read_b128 v[176:179], v15 offset:1344
    v_mfma_f32_16x16x32_bf16 v[120:123], v[100:103], v[132:135], v[120:123]
    ds_read_b128 v[180:183], v15 offset:1856
    v_mfma_f32_16x16x32_bf16 v[124:127], v[104:107], v[132:135], v[124:127]
    ds_read_b128 v[184:187], v15 offset:384
    s_waitcnt lgkmcnt(5)
    v_mfma_f32_16x16x32_bf16 v[120:123], v[96:99], v[152:155], v[120:123]
    v_mfma_f32_16x16x32_bf16 v[124:127], v[100:103], v[152:155], v[124:127]
    v_mfma_f32_16x16x32_bf16 v[124:127], v[96:99], v[160:163], v[124:127]
    v_mfma_f32_16x16x32_bf16 v[116:119], v[96:99], v[132:135], 0
    v_mfma_f32_16x16x32_bf16 v[128:131], v[108:111], v[132:135], 0
    ds_read_b128 v[132:135], v15 offset:896
    v_mfma_f32_16x16x32_bf16 v[128:131], v[104:107], v[152:155], v[128:131]
    s_nop 1
    ds_write_b128 v17, v[120:123] offset:1024
    v_mfma_f32_16x16x32_bf16 v[128:131], v[100:103], v[160:163], v[128:131]
    v_mfma_f32_16x16x32_bf16 v[128:131], v[96:99], v[164:167], v[128:131]
    s_waitcnt lgkmcnt(2)
    v_mfma_f32_16x16x32_bf16 v[116:119], v[80:83], v[168:171], v[116:119]
    ds_write_b128 v17, v[124:127] offset:2048
    v_mfma_f32_16x16x32_bf16 v[128:131], v[92:95], v[168:171], v[128:131]
    v_mfma_f32_16x16x32_bf16 v[128:131], v[88:91], v[172:175], v[128:131]
    v_mfma_f32_16x16x32_bf16 v[128:131], v[84:87], v[176:179], v[128:131]
    ds_read_b128 v[152:155], v15 offset:1408
    v_mfma_f32_16x16x32_bf16 v[128:131], v[80:83], v[180:183], v[128:131]
    ds_read_b128 v[160:163], v15 offset:1920
    v_mfma_f32_16x16x32_bf16 v[116:119], v[64:67], v[184:187], v[116:119]
    ds_read_b128 v[164:167], v15 offset:448
    v_mfma_f32_16x16x32_bf16 v[128:131], v[76:79], v[184:187], v[128:131]
    ds_read_b128 v[168:171], v15 offset:960
    s_waitcnt lgkmcnt(4)
    v_mfma_f32_16x16x32_bf16 v[128:131], v[72:75], v[132:135], v[128:131]
    ds_read_b128 v[172:175], v15 offset:1472
    s_waitcnt lgkmcnt(4)
    v_mfma_f32_16x16x32_bf16 v[128:131], v[68:71], v[152:155], v[128:131]
    ds_read_b128 v[176:179], v15 offset:1984
    s_waitcnt lgkmcnt(4)
    v_mfma_f32_16x16x32_bf16 v[128:131], v[64:67], v[160:163], v[128:131]
    ds_read_b128 v[180:183], v47 offset:2048
    s_waitcnt lgkmcnt(4)
    v_mfma_f32_16x16x32_bf16 v[116:119], v[48:51], v[164:167], v[116:119]
    ds_read_b128 v[184:187], v4
    s_barrier
    v_mfma_f32_16x16x32_bf16 v[128:131], v[60:63], v[164:167], v[128:131]
    ds_read_b128 v[120:123], v17
    s_waitcnt lgkmcnt(5)
    v_mfma_f32_16x16x32_bf16 v[128:131], v[56:59], v[168:171], v[128:131]
    ds_read_b128 v[132:135], v4 offset:3072
    s_waitcnt lgkmcnt(5)
    v_mfma_f32_16x16x32_bf16 v[128:131], v[52:55], v[172:175], v[128:131]
    ds_read_b128 v[124:127], v17 offset:3072
    s_waitcnt lgkmcnt(5)
    v_mfma_f32_16x16x32_bf16 v[128:131], v[48:51], v[176:179], v[128:131]
    s_waitcnt lgkmcnt(3)
    v_mfma_f32_16x16x32_bf16 v[116:119], v[180:183], v[184:187], v[116:119]
    s_waitcnt lgkmcnt(1)
    v_mfma_f32_16x16x32_bf16 v[128:131], v[180:183], v[132:135], v[128:131]
    s_nop 5
    v_pk_add_f32 v[116:117], v[116:117], v[120:121]
    v_pk_add_f32 v[118:119], v[118:119], v[122:123]
    v_cvt_pk_bf16_f32 v120, v116, v117
    v_cvt_pk_bf16_f32 v121, v118, v119
    buffer_store_dwordx2 v[120:121], v12, s[36:39], s27 offen sc1
    s_waitcnt lgkmcnt(0)
    v_pk_add_f32 v[128:129], v[128:129], v[124:125]
    v_pk_add_f32 v[130:131], v[130:131], v[126:127]
    v_cvt_pk_bf16_f32 v124, v128, v129
    v_cvt_pk_bf16_f32 v125, v130, v131
    buffer_store_dwordx2 v[124:125], v12, s[36:39], s28 offen sc1
    s_waitcnt vmcnt(6)
    v_max_u32_e32 v1, v136, v137
    v_max3_u32 v1, v1, v138, v139
    s_waitcnt vmcnt(5)
    v_max3_u32 v1, v1, v140, v141
    v_max3_u32 v1, v1, v142, v143
    s_waitcnt vmcnt(4)
    v_max3_u32 v1, v1, v144, v145
    v_max3_u32 v1, v1, v146, v147
    s_waitcnt vmcnt(3)
    v_max3_u32 v1, v1, v148, v149
    v_max3_u32 v1, v1, v150, v151
    s_waitcnt vmcnt(2)
    v_max3_u32 v1, v1, v156, v157
    v_max3_u32 v1, v1, v158, v159
    v_cmp_eq_u32_e32 vcc, -1, v1
    s_cbranch_vccnz retry_37
ok_38:
    ds_write_b128 v3, v[156:159] offset:4096
    ds_read_b128 v[168:171], v15 offset:1984
    ds_read_b128 v[172:175], v15 offset:1472
    ds_read_b128 v[176:179], v15 offset:960
    ds_read_b64 v[180:181], v15 offset:440
    ds_read_b64 v[182:183], v15 offset:448
    ds_read_b128 v[184:187], v46
    ds_read_b128 v[188:191], v46 offset:1024
    v_mfma_f32_16x16x32_bf16 v[152:155], v[112:115], v[136:139], 0
    v_lshlrev_b32_e32 v160, 16, v156
    v_lshlrev_b32_e32 v161, 16, v157
    v_mfma_f32_16x16x32_bf16 v[152:155], v[112:115], v[140:143], v[152:155]
    v_lshlrev_b32_e32 v162, 16, v158
    v_lshlrev_b32_e32 v163, 16, v159
    v_mfma_f32_16x16x32_bf16 v[152:155], v[112:115], v[144:147], v[152:155]
    v_and_b32_e32 v164, s5, v156
    v_and_b32_e32 v165, s5, v157
    v_mfma_f32_16x16x32_bf16 v[152:155], v[112:115], v[148:151], v[152:155]
    v_and_b32_e32 v166, s5, v158
    v_and_b32_e32 v167, s5, v159
    v_dot2_f32_bf16 v132, v136, v136, s6
    v_dot2_f32_bf16 v133, v137, v137, s6
    v_dot2_f32_bf16 v134, v138, v138, s6
    v_dot2_f32_bf16 v135, v139, v139, s6
    v_dot2_f32_bf16 v132, v140, v140, v132
    v_dot2_f32_bf16 v133, v141, v141, v133
    v_dot2_f32_bf16 v134, v142, v142, v134
    v_dot2_f32_bf16 v135, v143, v143, v135
    v_dot2_f32_bf16 v132, v144, v144, v132
    v_dot2_f32_bf16 v133, v145, v145, v133
    v_dot2_f32_bf16 v134, v146, v146, v134
    v_dot2_f32_bf16 v135, v147, v147, v135
    v_dot2_f32_bf16 v132, v148, v148, v132
    v_dot2_f32_bf16 v133, v149, v149, v133
    v_dot2_f32_bf16 v134, v150, v150, v134
    v_dot2_f32_bf16 v135, v151, v151, v135
    v_pk_mul_f32 v[152:153], v[152:153], 0.5 op_sel_hi:[1,0]
    v_pk_mul_f32 v[154:155], v[154:155], 0.5 op_sel_hi:[1,0]
    v_pk_fma_f32 v[132:133], v[152:153], v[152:153], v[132:133] neg_lo:[1,0,0] neg_hi:[1,0,0]
    v_pk_fma_f32 v[134:135], v[154:155], v[154:155], v[134:135] neg_lo:[1,0,0] neg_hi:[1,0,0]
    v_rsq_f32_e32 v132, v132
    v_rsq_f32_e32 v133, v133
    v_rsq_f32_e32 v134, v134
    v_rsq_f32_e32 v135, v135
    v_pk_mul_f32 v[152:153], v[152:153], v[132:133] neg_lo:[1,0] neg_hi:[1,0]
    v_pk_mul_f32 v[154:155], v[154:155], v[134:135] neg_lo:[1,0] neg_hi:[1,0]
    v_pk_fma_f32 v[160:161], v[160:161], v[132:133], v[152:153]
    v_pk_fma_f32 v[162:163], v[162:163], v[134:135], v[154:155]
    v_pk_fma_f32 v[164:165], v[164:165], v[132:133], v[152:153]
    v_pk_fma_f32 v[166:167], v[166:167], v[134:135], v[154:155]
    v_cvt_pk_bf16_f32 v156, v160, v161
    v_cvt_pk_bf16_f32 v157, v162, v163
    v_cvt_pk_bf16_f32 v158, v164, v165
    v_cvt_pk_bf16_f32 v159, v166, v167
    ds_write2st64_b64 v16, v[156:157], v[158:159] offset0:4 offset1:14
    s_waitcnt lgkmcnt(7)
    v_mfma_f32_16x16x32_bf16 v[116:119], v[52:55], v[168:171], 0
    ds_read_b64 v[112:113], v15 offset:1976
    buffer_store_dwordx2 v[22:23], v19, s[36:39], s23 offen sc1
    v_mfma_f32_16x16x32_bf16 v[120:123], v[56:59], v[168:171], 0
    ds_read_b64 v[114:115], v15 offset:1984
    v_mfma_f32_16x16x32_bf16 v[124:127], v[60:63], v[168:171], 0
    ds_read_b128 v[136:139], v15 offset:1920
    s_waitcnt lgkmcnt(4)
    v_mfma_f32_16x16x32_bf16 v[116:119], v[56:59], v[172:175], v[116:119]
    buffer_store_dwordx2 v[22:23], v32, s[36:39], s23 offen offset:512 sc1
    ds_read_b128 v[140:143], v15 offset:1408
    v_mfma_f32_16x16x32_bf16 v[120:123], v[60:63], v[172:175], v[120:123]
    ds_read_b128 v[144:147], v15 offset:896
    v_mfma_f32_16x16x32_bf16 v[116:119], v[60:63], v[176:179], v[116:119]
    ds_read_b128 v[148:151], v15 offset:1856
    v_mfma_f32_16x16x32_bf16 v[132:135], v[180:183], v[184:187], 0
    ds_read_b128 v[156:159], v15 offset:1344
    v_mfma_f32_16x16x32_bf16 v[152:155], v[180:183], v[188:191], 0
    ds_read_b128 v[168:171], v15 offset:832
    s_waitcnt lgkmcnt(6)
    v_mfma_f32_16x16x32_bf16 v[160:163], v[112:115], v[184:187], 0
    ds_read_b128 v[172:175], v15 offset:1792
    v_mfma_f32_16x16x32_bf16 v[164:167], v[112:115], v[188:191], 0
    ds_read_b128 v[176:179], v15 offset:1280
    s_waitcnt lgkmcnt(6)
    v_mfma_f32_16x16x32_bf16 v[116:119], v[68:71], v[136:139], v[116:119]
    s_barrier
    v_mfma_f32_16x16x32_bf16 v[120:123], v[72:75], v[136:139], v[120:123]
    v_cvt_pk_bf16_f32 v132, v132, v152
    v_cvt_pk_bf16_f32 v133, v133, v153
    v_mfma_f32_16x16x32_bf16 v[124:127], v[76:79], v[136:139], v[124:127]
    v_cvt_pk_bf16_f32 v134, v134, v154
    v_cvt_pk_bf16_f32 v135, v135, v155
    v_mfma_f32_16x16x32_bf16 v[116:119], v[72:75], v[140:143], v[116:119]
    v_cvt_pk_bf16_f32 v160, v160, v164
    v_cvt_pk_bf16_f32 v161, v161, v165
    v_mfma_f32_16x16x32_bf16 v[120:123], v[76:79], v[140:143], v[120:123]
    v_cvt_pk_bf16_f32 v162, v162, v166
    s_waitcnt lgkmcnt(1)
    v_mfma_f32_16x16x32_bf16 v[116:119], v[76:79], v[144:147], v[116:119]
    v_cvt_pk_bf16_f32 v163, v163, v167
    ds_read_b128 v[180:183], v15 offset:768
    v_mfma_f32_16x16x32_bf16 v[116:119], v[84:87], v[148:151], v[116:119]
    ds_read2_b32 v[184:185], v14 offset0:0 offset1:1
    v_mfma_f32_16x16x32_bf16 v[120:123], v[88:91], v[148:151], v[120:123]
    ds_read2_b32 v[186:187], v14 offset0:2 offset1:3
    v_mfma_f32_16x16x32_bf16 v[124:127], v[92:95], v[148:151], v[124:127]
    ds_read_b128 v[112:115], v15 offset:448
    v_mfma_f32_16x16x32_bf16 v[116:119], v[88:91], v[156:159], v[116:119]
    ds_read_b128 v[188:191], v15 offset:1984
    v_mfma_f32_16x16x32_bf16 v[120:123], v[92:95], v[156:159], v[120:123]
    ds_read2_b32 v[136:137], v18 offset0:32 offset1:33
    v_mfma_f32_16x16x32_bf16 v[116:119], v[92:95], v[168:171], v[116:119]
    ds_read2_b32 v[138:139], v18 offset0:34 offset1:35
    v_mfma_f32_16x16x32_bf16 v[116:119], v[100:103], v[172:175], v[116:119]
    ds_read2_b32 v[140:141], v18 offset0:16 offset1:17
    v_mfma_f32_16x16x32_bf16 v[120:123], v[104:107], v[172:175], v[120:123]
    ds_read2_b32 v[142:143], v18 offset0:18 offset1:19
    v_mfma_f32_16x16x32_bf16 v[124:127], v[108:111], v[172:175], v[124:127]
    ds_read_b128 v[144:147], v15 offset:2496
    s_waitcnt lgkmcnt(6)
    v_mfma_f32_16x16x32_bf16 v[116:119], v[104:107], v[176:179], v[116:119]
    ds_read_b128 v[152:155], v15 offset:3008
    v_mfma_f32_16x16x32_bf16 v[120:123], v[108:111], v[176:179], v[120:123]
    ds_read_b128 v[164:167], v15 offset:3520
    v_mfma_f32_16x16x32_bf16 v[116:119], v[108:111], v[180:183], v[116:119]
    ds_read_b128 v[148:151], v15 offset:4032
    v_mfma_f32_16x16x32_bf16 v[116:119], v[184:187], v[112:115], v[116:119]
    ds_read_b128 v[156:159], v15 offset:2432
    s_waitcnt lgkmcnt(6)
    v_mfma_f32_16x16x32_bf16 v[128:131], v[184:187], v[188:191], 0
    ds_read_b128 v[168:171], v15 offset:2944
    v_mfma_f32_16x16x32_bf16 v[120:123], v[132:135], v[136:139], v[120:123]
    ds_read_b128 v[172:175], v15 offset:3456
    s_waitcnt lgkmcnt(6)
    v_mfma_f32_16x16x32_bf16 v[124:127], v[132:135], v[140:143], v[124:127]
    ds_read_b128 v[176:179], v15 offset:2368
    v_mfma_f32_16x16x32_bf16 v[116:119], v[48:51], v[144:147], v[116:119]
    v_mfma_f32_16x16x32_bf16 v[120:123], v[52:55], v[144:147], v[120:123]
    ds_read_b128 v[180:183], v15 offset:2880
    v_mfma_f32_16x16x32_bf16 v[124:127], v[56:59], v[144:147], v[124:127]
    v_mfma_f32_16x16x32_bf16 v[128:131], v[60:63], v[144:147], v[128:131]
    ds_read_b128 v[112:115], v15 offset:3392
    s_waitcnt lgkmcnt(4)
    v_mfma_f32_16x16x32_bf16 v[120:123], v[48:51], v[152:155], v[120:123]
    ds_read_b128 v[184:187], v15 offset:2304
    v_mfma_f32_16x16x32_bf16 v[124:127], v[52:55], v[152:155], v[124:127]
    v_mfma_f32_16x16x32_bf16 v[128:131], v[56:59], v[152:155], v[128:131]
    ds_read_b128 v[188:191], v15 offset:2816
    v_mfma_f32_16x16x32_bf16 v[124:127], v[48:51], v[164:167], v[124:127]
    v_mfma_f32_16x16x32_bf16 v[128:131], v[52:55], v[164:167], v[128:131]
    s_waitcnt vmcnt(2)
    s_add_u32 m0, s26, 0x0
    v_mfma_f32_16x16x32_bf16 v[128:131], v[48:51], v[148:151], v[128:131]
    buffer_load_dwordx4 v29, s[36:39], s7 offen sc1 lds
    ds_read_b128 v[136:139], v15 offset:3328
    v_mfma_f32_16x16x32_bf16 v[120:123], v[68:71], v[156:159], v[120:123]
    v_mfma_f32_16x16x32_bf16 v[124:127], v[72:75], v[156:159], v[124:127]
    v_mfma_f32_16x16x32_bf16 v[120:123], v[64:67], v[168:171], v[120:123]
    v_mfma_f32_16x16x32_bf16 v[124:127], v[68:71], v[168:171], v[124:127]
    buffer_load_dwordx4 v29, s[36:39], s7 offen offset:1024 sc1 lds
    s_waitcnt lgkmcnt(1)
    v_mfma_f32_16x16x32_bf16 v[124:127], v[64:67], v[172:175], v[124:127]
    s_add_u32 m0, s26, 0x2000
    ds_read_b128 v[140:143], v15 offset:3968
    v_mfma_f32_16x16x32_bf16 v[120:123], v[84:87], v[176:179], v[120:123]
    v_mfma_f32_16x16x32_bf16 v[124:127], v[88:91], v[176:179], v[124:127]
    v_mfma_f32_16x16x32_bf16 v[120:123], v[80:83], v[180:183], v[120:123]
    v_mfma_f32_16x16x32_bf16 v[124:127], v[84:87], v[180:183], v[124:127]
    buffer_load_dwordx4 v29, s[36:39], s8 offen sc1 lds
    ds_read_b128 v[60:63], v15 offset:3904
    v_mfma_f32_16x16x32_bf16 v[124:127], v[80:83], v[112:115], v[124:127]
    v_mfma_f32_16x16x32_bf16 v[120:123], v[100:103], v[184:187], v[120:123]
    v_mfma_f32_16x16x32_bf16 v[124:127], v[104:107], v[184:187], v[124:127]
    v_mfma_f32_16x16x32_bf16 v[120:123], v[96:99], v[188:191], v[120:123]
    buffer_load_dwordx4 v29, s[36:39], s8 offen offset:1024 sc1 lds
    s_add_u32 m0, s26, 0x4000
    v_mfma_f32_16x16x32_bf16 v[124:127], v[100:103], v[188:191], v[124:127]
    ds_read_b128 v[144:147], v15 offset:3840
    s_waitcnt lgkmcnt(2)
    v_mfma_f32_16x16x32_bf16 v[124:127], v[96:99], v[136:139], v[124:127]
    ds_read2_b32 v[56:57], v18 offset0:48 offset1:49
    v_mfma_f32_16x16x32_bf16 v[116:119], v[64:67], v[156:159], v[116:119]
    ds_read2_b32 v[58:59], v18 offset0:50 offset1:51
    v_mfma_f32_16x16x32_bf16 v[128:131], v[76:79], v[156:159], v[128:131]
    buffer_load_dwordx4 v29, s[36:39], s9 offen sc1 lds
    ds_read2_b32 v[152:153], v18 offset0:0 offset1:1
    v_mfma_f32_16x16x32_bf16 v[128:131], v[72:75], v[168:171], v[128:131]
    ds_write_b128 v17, v[120:123] offset:5120
    v_mfma_f32_16x16x32_bf16 v[128:131], v[68:71], v[172:175], v[128:131]
    v_mfma_f32_16x16x32_bf16 v[128:131], v[64:67], v[140:143], v[128:131]
    v_mfma_f32_16x16x32_bf16 v[116:119], v[80:83], v[176:179], v[116:119]
    ds_write_b128 v17, v[124:127] offset:6144
    buffer_load_dwordx4 v29, s[36:39], s9 offen offset:1024 sc1 lds
    v_mfma_f32_16x16x32_bf16 v[128:131], v[92:95], v[176:179], v[128:131]
    s_add_u32 m0, s26, 0x6000
    v_mfma_f32_16x16x32_bf16 v[128:131], v[88:91], v[180:183], v[128:131]
    v_mfma_f32_16x16x32_bf16 v[128:131], v[84:87], v[112:115], v[128:131]
    ds_read2_b32 v[154:155], v18 offset0:2 offset1:3
    s_waitcnt lgkmcnt(2)
    v_mfma_f32_16x16x32_bf16 v[128:131], v[80:83], v[60:63], v[128:131]
    ds_read_b128 v[52:55], v47 offset:2048
    v_mfma_f32_16x16x32_bf16 v[116:119], v[96:99], v[184:187], v[116:119]
    ds_read_b128 v[164:167], v4 offset:4096
    buffer_load_dwordx4 v29, s[36:39], s10 offen sc1 lds
    v_mfma_f32_16x16x32_bf16 v[128:131], v[108:111], v[184:187], v[128:131]
    ds_read_b128 v[48:51], v4 offset:7168
    v_mfma_f32_16x16x32_bf16 v[128:131], v[104:107], v[188:191], v[128:131]
    v_mfma_f32_16x16x32_bf16 v[128:131], v[100:103], v[136:139], v[128:131]
    v_mfma_f32_16x16x32_bf16 v[128:131], v[96:99], v[144:147], v[128:131]
    s_waitcnt vmcnt(7) lgkmcnt(3)
    s_barrier
    v_mfma_f32_16x16x32_bf16 v[116:119], v[132:135], v[56:59], v[116:119]
    ds_read_b128 v[120:123], v17 offset:4096
    buffer_load_dwordx4 v29, s[36:39], s10 offen offset:1024 sc1 lds
    v_mfma_f32_16x16x32_bf16 v[128:131], v[160:163], v[56:59], v[128:131]
    ds_read_b128 v[124:127], v17 offset:7168
    v_mfma_f32_16x16x32_bf16 v[128:131], v[132:135], v[152:155], v[128:131]
    s_waitcnt lgkmcnt(2)
    v_mfma_f32_16x16x32_bf16 v[116:119], v[52:55], v[164:167], v[116:119]
    v_mfma_f32_16x16x32_bf16 v[128:131], v[52:55], v[48:51], v[128:131]
    s_waitcnt lgkmcnt(1)
    s_nop 5
    v_pk_add_f32 v[116:117], v[116:117], v[120:121]
    v_pk_add_f32 v[118:119], v[118:119], v[122:123]
    v_cvt_pk_bf16_f32 v120, v116, v117
    v_cvt_pk_bf16_f32 v121, v118, v119
    buffer_store_dwordx2 v[120:121], v12, s[36:39], s29 offen sc1
    s_waitcnt lgkmcnt(0)
    v_pk_add_f32 v[128:129], v[128:129], v[124:125]
    v_pk_add_f32 v[130:131], v[130:131], v[126:127]
    v_cvt_pk_bf16_f32 v124, v128, v129
    v_cvt_pk_bf16_f32 v125, v130, v131
    buffer_store_dwordx2 v[124:125], v12, s[36:39], s30 offen sc1
    s_branch join_34
arm_33:
W3_1:
    s_cbranch_execz W3_5
    s_add_u32 s27, s74, 0x210000
    s_add_u32 s28, s74, 0x250400
    s_add_u32 s29, s74, 0x311000
    s_add_u32 s30, s74, 0x351400
    buffer_load_dwordx4 v[120:123], v13, s[36:39], s15 offen sc1
    buffer_load_dwordx4 v[124:127], v13, s[36:39], s16 offen sc1
    buffer_load_dwordx4 v[128:131], v13, s[36:39], s17 offen sc1
    buffer_load_dwordx4 v[132:135], v13, s[36:39], s18 offen sc1
    buffer_load_dwordx4 v[152:155], v13, s[36:39], s19 offen sc1
    s_waitcnt vmcnt(4) lgkmcnt(0)
    v_mfma_f32_16x16x32_bf16 v[160:163], v[112:115], v[120:123], 0
    v_max_u32_e32 v1, v120, v121
    v_max3_u32 v1, v1, v122, v123
    s_waitcnt vmcnt(3)
    v_mfma_f32_16x16x32_bf16 v[160:163], v[112:115], v[124:127], v[160:163]
    v_max3_u32 v1, v1, v124, v125
    v_max3_u32 v1, v1, v126, v127
    s_waitcnt vmcnt(2)
    v_mfma_f32_16x16x32_bf16 v[160:163], v[112:115], v[128:131], v[160:163]
    v_max3_u32 v1, v1, v128, v129
    v_max3_u32 v1, v1, v130, v131
    s_waitcnt vmcnt(1)
    v_mfma_f32_16x16x32_bf16 v[160:163], v[112:115], v[132:135], v[160:163]
    v_max3_u32 v1, v1, v132, v133
W3_2:
    s_cbranch_execz W3_ret
    v_max3_u32 v1, v1, v134, v135
    s_waitcnt vmcnt(0)
    v_max3_u32 v1, v1, v152, v153
    v_max3_u32 v1, v1, v154, v155
    v_cmp_eq_u32_e32 vcc, -1, v1
    s_cbranch_vccnz retry_39
ok_40:
    v_dot2_f32_bf16 v116, v120, v120, s6
    v_dot2_f32_bf16 v117, v121, v121, s6
    v_dot2_f32_bf16 v118, v122, v122, s6
    v_dot2_f32_bf16 v119, v123, v123, s6
    v_dot2_f32_bf16 v116, v124, v124, v116
    v_dot2_f32_bf16 v117, v125, v125, v117
    v_dot2_f32_bf16 v118, v126, v126, v118
    v_dot2_f32_bf16 v119, v127, v127, v119
    v_dot2_f32_bf16 v116, v128, v128, v116
    v_dot2_f32_bf16 v117, v129, v129, v117
    v_dot2_f32_bf16 v118, v130, v130, v118
    v_dot2_f32_bf16 v119, v131, v131, v119
    v_dot2_f32_bf16 v116, v132, v132, v116
    v_dot2_f32_bf16 v117, v133, v133, v117
    v_dot2_f32_bf16 v118, v134, v134, v118
    v_dot2_f32_bf16 v119, v135, v135, v119
    ds_write_b128 v3, v[152:155]
    v_pk_mul_f32 v[160:161], v[160:161], 0.5 op_sel_hi:[1,0]
    v_pk_mul_f32 v[162:163], v[162:163], 0.5 op_sel_hi:[1,0]
    v_lshlrev_b32_e32 v164, 16, v152
    v_pk_fma_f32 v[116:117], v[160:161], v[160:161], v[116:117] neg_lo:[1,0,0] neg_hi:[1,0,0]
    v_pk_fma_f32 v[118:119], v[162:163], v[162:163], v[118:119] neg_lo:[1,0,0] neg_hi:[1,0,0]
    v_rsq_f32_e32 v116, v116
    v_rsq_f32_e32 v117, v117
    v_rsq_f32_e32 v118, v118
    v_rsq_f32_e32 v119, v119
    v_lshlrev_b32_e32 v165, 16, v153
    v_lshlrev_b32_e32 v166, 16, v154
    v_lshlrev_b32_e32 v167, 16, v155
    v_and_b32_e32 v168, s5, v152
    v_and_b32_e32 v169, s5, v153
    v_and_b32_e32 v170, s5, v154
    v_and_b32_e32 v171, s5, v155
    v_pk_mul_f32 v[160:161], v[160:161], v[116:117] neg_lo:[1,0] neg_hi:[1,0]
    v_pk_mul_f32 v[162:163], v[162:163], v[118:119] neg_lo:[1,0] neg_hi:[1,0]
    v_pk_fma_f32 v[164:165], v[164:165], v[116:117], v[160:161]
    v_pk_fma_f32 v[166:167], v[166:167], v[118:119], v[162:163]
    v_pk_fma_f32 v[168:169], v[168:169], v[116:117], v[160:161]
    v_pk_fma_f32 v[170:171], v[170:171], v[118:119], v[162:163]
    v_cvt_pk_bf16_f32 v152, v164, v165
    v_cvt_pk_bf16_f32 v153, v166, v167
    v_cvt_pk_bf16_f32 v154, v168, v169
    v_cvt_pk_bf16_f32 v155, v170, v171
    ds_write2st64_b64 v16, v[152:153], v[154:155] offset0:0 offset1:10
    buffer_load_dwordx4 v[136:139], v13, s[36:39], s20 offen sc1
    buffer_load_dwordx4 v[140:143], v13, s[36:39], s21 offen sc1
    buffer_load_dwordx4 v[144:147], v13, s[36:39], s22 offen sc1
    buffer_load_dwordx4 v[148:151], v13, s[36:39], s24 offen sc1
    buffer_load_dwordx4 v[156:159], v13, s[36:39], s25 offen sc1
    s_waitcnt lgkmcnt(0)
    s_barrier
    ds_read_b128 v[132:135], v15 offset:192
    ds_read_b128 v[152:155], v15 offset:704
    ds_read_b128 v[160:163], v15 offset:1216
    ds_read_b128 v[164:167], v15 offset:1728
    ds_read_b128 v[168:171], v15 offset:128
    s_waitcnt lgkmcnt(4)
    v_mfma_f32_16x16x32_bf16 v[116:119], v[48:51], v[132:135], 0
    ds_read_b128 v[172:175], v15 offset:640
    v_mfma_f32_16x16x32_bf16 v[128:131], v[60:63], v[132:135], 0
    ds_read_b128 v[176:179], v15 offset:1152
    s_waitcnt lgkmcnt(5)
    v_mfma_f32_16x16x32_bf16 v[128:131], v[56:59], v[152:155], v[128:131]
    ds_read_b128 v[180:183], v15 offset:1664
    s_waitcnt lgkmcnt(5)
    v_mfma_f32_16x16x32_bf16 v[128:131], v[52:55], v[160:163], v[128:131]
    ds_read_b128 v[184:187], v15 offset:64
    s_waitcnt lgkmcnt(5)
    v_mfma_f32_16x16x32_bf16 v[128:131], v[48:51], v[164:167], v[128:131]
    ds_read_b128 v[132:135], v15 offset:576
    s_waitcnt lgkmcnt(5)
    v_mfma_f32_16x16x32_bf16 v[116:119], v[64:67], v[168:171], v[116:119]
    ds_read_b128 v[152:155], v15 offset:1088
    v_mfma_f32_16x16x32_bf16 v[128:131], v[76:79], v[168:171], v[128:131]
    ds_read_b128 v[160:163], v15 offset:1600
    s_waitcnt lgkmcnt(6)
    v_mfma_f32_16x16x32_bf16 v[128:131], v[72:75], v[172:175], v[128:131]
    ds_read_b128 v[164:167], v15
    s_waitcnt lgkmcnt(6)
    v_mfma_f32_16x16x32_bf16 v[128:131], v[68:71], v[176:179], v[128:131]
    ds_read_b128 v[168:171], v15 offset:512
    s_waitcnt lgkmcnt(6)
    v_mfma_f32_16x16x32_bf16 v[128:131], v[64:67], v[180:183], v[128:131]
    ds_read_b128 v[172:175], v15 offset:1024
    s_waitcnt lgkmcnt(6)
    v_mfma_f32_16x16x32_bf16 v[116:119], v[80:83], v[184:187], v[116:119]
    ds_read_b128 v[176:179], v15 offset:1536
    v_mfma_f32_16x16x32_bf16 v[128:131], v[92:95], v[184:187], v[128:131]
    ds_read_b128 v[180:183], v15 offset:64
    s_waitcnt lgkmcnt(6)
    v_mfma_f32_16x16x32_bf16 v[128:131], v[88:91], v[132:135], v[128:131]
    v_mfma_f32_16x16x32_bf16 v[128:131], v[84:87], v[152:155], v[128:131]
    ds_read_b128 v[184:187], v15 offset:576
    s_waitcnt lgkmcnt(5)
    v_mfma_f32_16x16x32_bf16 v[128:131], v[80:83], v[160:163], v[128:131]
    v_mfma_f32_16x16x32_bf16 v[116:119], v[96:99], v[164:167], v[116:119]
    ds_read_b128 v[132:135], v15 offset:1088
    v_mfma_f32_16x16x32_bf16 v[128:131], v[108:111], v[164:167], v[128:131]
    ds_read_b128 v[152:155], v15 offset:128
    s_waitcnt lgkmcnt(4)
    v_mfma_f32_16x16x32_bf16 v[128:131], v[104:107], v[168:171], v[128:131]
    v_mfma_f32_16x16x32_bf16 v[128:131], v[100:103], v[172:175], v[128:131]
    ds_read_b128 v[160:163], v15 offset:640
    v_mfma_f32_16x16x32_bf16 v[128:131], v[96:99], v[176:179], v[128:131]
    v_mfma_f32_16x16x32_bf16 v[120:123], v[100:103], v[164:167], 0
    ds_read_b128 v[176:179], v15 offset:1152
    v_mfma_f32_16x16x32_bf16 v[124:127], v[104:107], v[164:167], 0
    ds_read_b128 v[164:167], v15 offset:192
    v_mfma_f32_16x16x32_bf16 v[120:123], v[96:99], v[168:171], v[120:123]
    ds_write_b128 v17, v[116:119]
    v_mfma_f32_16x16x32_bf16 v[124:127], v[100:103], v[168:171], v[124:127]
    v_mfma_f32_16x16x32_bf16 v[124:127], v[96:99], v[172:175], v[124:127]
    s_waitcnt lgkmcnt(3)
    v_mfma_f32_16x16x32_bf16 v[120:123], v[84:87], v[180:183], v[120:123]
    ds_write_b128 v17, v[128:131] offset:3072
    v_mfma_f32_16x16x32_bf16 v[124:127], v[88:91], v[180:183], v[124:127]
    v_mfma_f32_16x16x32_bf16 v[120:123], v[80:83], v[184:187], v[120:123]
    v_mfma_f32_16x16x32_bf16 v[124:127], v[84:87], v[184:187], v[124:127]
    ds_read_b128 v[168:171], v15 offset:704
    v_mfma_f32_16x16x32_bf16 v[124:127], v[80:83], v[132:135], v[124:127]
    ds_read_b128 v[172:175], v15 offset:1216
    v_mfma_f32_16x16x32_bf16 v[120:123], v[68:71], v[152:155], v[120:123]
    ds_read_b128 v[180:183], v47 offset:2048
    v_mfma_f32_16x16x32_bf16 v[124:127], v[72:75], v[152:155], v[124:127]
    ds_read_b128 v[184:187], v4 offset:1024
    v_mfma_f32_16x16x32_bf16 v[120:123], v[64:67], v[160:163], v[120:123]
    ds_read_b128 v[132:135], v4 offset:2048
    v_mfma_f32_16x16x32_bf16 v[124:127], v[68:71], v[160:163], v[124:127]
    s_waitcnt lgkmcnt(5)
    v_mfma_f32_16x16x32_bf16 v[124:127], v[64:67], v[176:179], v[124:127]
    s_barrier
    ds_read_b128 v[116:119], v17 offset:1024
    v_mfma_f32_16x16x32_bf16 v[120:123], v[52:55], v[164:167], v[120:123]
    ds_read_b128 v[128:131], v17 offset:2048
    v_mfma_f32_16x16x32_bf16 v[124:127], v[56:59], v[164:167], v[124:127]
    s_waitcnt lgkmcnt(4)
    v_mfma_f32_16x16x32_bf16 v[120:123], v[48:51], v[168:171], v[120:123]
    v_mfma_f32_16x16x32_bf16 v[124:127], v[52:55], v[168:171], v[124:127]
    v_mfma_f32_16x16x32_bf16 v[124:127], v[48:51], v[172:175], v[124:127]
    s_waitcnt lgkmcnt(2)
    v_mfma_f32_16x16x32_bf16 v[120:123], v[180:183], v[184:187], v[120:123]
    v_mfma_f32_16x16x32_bf16 v[124:127], v[180:183], v[132:135], v[124:127]
    s_waitcnt lgkmcnt(0)
    s_nop 5
    v_pk_add_f32 v[120:121], v[120:121], v[116:117]
    v_pk_add_f32 v[122:123], v[122:123], v[118:119]
    v_cvt_pk_bf16_f32 v116, v120, v121
    v_cvt_pk_bf16_f32 v117, v122, v123
    buffer_store_dwordx2 v[116:117], v12, s[36:39], s27 offen sc1
    v_pk_add_f32 v[124:125], v[124:125], v[128:129]
    v_pk_add_f32 v[126:127], v[126:127], v[130:131]
    v_cvt_pk_bf16_f32 v128, v124, v125
    v_cvt_pk_bf16_f32 v129, v126, v127
    buffer_store_dwordx2 v[128:129], v12, s[36:39], s28 offen sc1
    s_waitcnt vmcnt(6)
    v_max_u32_e32 v1, v136, v137
    v_max3_u32 v1, v1, v138, v139
    s_waitcnt vmcnt(5)
    v_max3_u32 v1, v1, v140, v141
    v_max3_u32 v1, v1, v142, v143
    s_waitcnt vmcnt(4)
    v_max3_u32 v1, v1, v144, v145
    v_max3_u32 v1, v1, v146, v147
    s_waitcnt vmcnt(3)
    v_max3_u32 v1, v1, v148, v149
    v_max3_u32 v1, v1, v150, v151
    s_waitcnt vmcnt(2)
    v_max3_u32 v1, v1, v156, v157
    v_max3_u32 v1, v1, v158, v159
    v_cmp_eq_u32_e32 vcc, -1, v1
    s_cbranch_vccnz retry_41
ok_42:
    ds_write_b128 v3, v[156:159] offset:4096
    ds_read_b128 v[168:171], v15 offset:1728
    ds_read_b128 v[172:175], v15 offset:1216
    ds_read_b128 v[176:179], v15 offset:704
    ds_read_b64 v[180:181], v15 offset:952
    ds_read_b64 v[182:183], v15 offset:960
    ds_read_b128 v[184:187], v46
    ds_read_b128 v[188:191], v46 offset:1024
    v_mfma_f32_16x16x32_bf16 v[152:155], v[112:115], v[136:139], 0
    v_lshlrev_b32_e32 v160, 16, v156
    v_lshlrev_b32_e32 v161, 16, v157
    v_mfma_f32_16x16x32_bf16 v[152:155], v[112:115], v[140:143], v[152:155]
    v_lshlrev_b32_e32 v162, 16, v158
    v_lshlrev_b32_e32 v163, 16, v159
    v_mfma_f32_16x16x32_bf16 v[152:155], v[112:115], v[144:147], v[152:155]
    v_and_b32_e32 v164, s5, v156
    v_and_b32_e32 v165, s5, v157
    v_mfma_f32_16x16x32_bf16 v[152:155], v[112:115], v[148:151], v[152:155]
    v_and_b32_e32 v166, s5, v158
    v_and_b32_e64 v167, s5, v159
    v_dot2_f32_bf16 v132, v136, v136, s6
    v_dot2_f32_bf16 v133, v137, v137, s6
    v_dot2_f32_bf16 v134, v138, v138, s6
    v_dot2_f32_bf16 v135, v139, v139, s6
    v_dot2_f32_bf16 v132, v140, v140, v132
    v_dot2_f32_bf16 v133, v141, v141, v133
    v_dot2_f32_bf16 v134, v142, v142, v134
    v_dot2_f32_bf16 v135, v143, v143, v135
    v_dot2_f32_bf16 v132, v144, v144, v132
    v_dot2_f32_bf16 v133, v145, v145, v133
    v_dot2_f32_bf16 v134, v146, v146, v134
    v_dot2_f32_bf16 v135, v147, v147, v135
    v_dot2_f32_bf16 v132, v148, v148, v132
    v_dot2_f32_bf16 v133, v149, v149, v133
    v_dot2_f32_bf16 v134, v150, v150, v134
    v_dot2_f32_bf16 v135, v151, v151, v135
    v_pk_mul_f32 v[152:153], v[152:153], 0.5 op_sel_hi:[1,0]
    v_pk_mul_f32 v[154:155], v[154:155], 0.5 op_sel_hi:[1,0]
    v_pk_fma_f32 v[132:133], v[152:153], v[152:153], v[132:133] neg_lo:[1,0,0] neg_hi:[1,0,0]
    v_pk_fma_f32 v[134:135], v[154:155], v[154:155], v[134:135] neg_lo:[1,0,0] neg_hi:[1,0,0]
    v_rsq_f32_e32 v132, v132
    v_rsq_f32_e32 v133, v133
    v_rsq_f32_e32 v134, v134
    v_rsq_f32_e32 v135, v135
    v_pk_mul_f32 v[152:153], v[152:153], v[132:133] neg_lo:[1,0] neg_hi:[1,0]
    v_pk_mul_f32 v[154:155], v[154:155], v[134:135] neg_lo:[1,0] neg_hi:[1,0]
    v_pk_fma_f32 v[160:161], v[160:161], v[132:133], v[152:153]
    v_pk_fma_f32 v[162:163], v[162:163], v[134:135], v[154:155]
    v_pk_fma_f32 v[164:165], v[164:165], v[132:133], v[152:153]
    v_pk_fma_f32 v[166:167], v[166:167], v[134:135], v[154:155]
    v_cvt_pk_bf16_f32 v156, v160, v161
    v_cvt_pk_bf16_f32 v157, v162, v163
    v_cvt_pk_bf16_f32 v158, v164, v165
    v_cvt_pk_bf16_f32 v159, v166, v167
    ds_write2st64_b64 v16, v[156:157], v[158:159] offset0:4 offset1:14
    s_waitcnt lgkmcnt(7)
    v_mfma_f32_16x16x32_bf16 v[116:119], v[52:55], v[168:171], 0
    ds_read_b64 v[112:113], v15 offset:1464
    buffer_store_dwordx2 v[22:23], v19, s[36:39], s23 offen sc1
    v_mfma_f32_16x16x32_bf16 v[120:123], v[56:59], v[168:171], 0
    ds_read_b64 v[114:115], v15 offset:1472
    v_mfma_f32_16x16x32_bf16 v[124:127], v[60:63], v[168:171], 0
    ds_read_b128 v[136:139], v15 offset:1664
    s_waitcnt lgkmcnt(4)
    v_mfma_f32_16x16x32_bf16 v[116:119], v[56:59], v[172:175], v[116:119]
    buffer_store_dwordx2 v[22:23], v32, s[36:39], s23 offen offset:512 sc1
    ds_read_b128 v[140:143], v15 offset:1152
    v_mfma_f32_16x16x32_bf16 v[120:123], v[60:63], v[172:175], v[120:123]
    ds_read_b128 v[144:147], v15 offset:640
    v_mfma_f32_16x16x32_bf16 v[116:119], v[60:63], v[176:179], v[116:119]
    ds_read_b128 v[148:151], v15 offset:1600
    v_mfma_f32_16x16x32_bf16 v[132:135], v[180:183], v[184:187], 0
    ds_read_b128 v[156:159], v15 offset:1088
    v_mfma_f32_16x16x32_bf16 v[152:155], v[180:183], v[188:191], 0
    ds_read_b128 v[168:171], v15 offset:576
    s_waitcnt lgkmcnt(6)
    v_mfma_f32_16x16x32_bf16 v[160:163], v[112:115], v[184:187], 0
    ds_read_b128 v[172:175], v15 offset:1536
    v_mfma_f32_16x16x32_bf16 v[164:167], v[112:115], v[188:191], 0
    ds_read_b128 v[176:179], v15 offset:1024
    s_waitcnt lgkmcnt(6)
    v_mfma_f32_16x16x32_bf16 v[116:119], v[68:71], v[136:139], v[116:119]
    s_barrier
    v_mfma_f32_16x16x32_bf16 v[120:123], v[72:75], v[136:139], v[120:123]
    v_cvt_pk_bf16_f32 v132, v132, v152
    v_cvt_pk_bf16_f32 v133, v133, v153
    v_mfma_f32_16x16x32_bf16 v[124:127], v[76:79], v[136:139], v[124:127]
    v_cvt_pk_bf16_f32 v134, v134, v154
    v_cvt_pk_bf16_f32 v135, v135, v155
    v_mfma_f32_16x16x32_bf16 v[116:119], v[72:75], v[140:143], v[116:119]
    v_cvt_pk_bf16_f32 v160, v160, v164
    v_cvt_pk_bf16_f32 v161, v161, v165
    v_mfma_f32_16x16x32_bf16 v[120:123], v[76:79], v[140:143], v[120:123]
    v_cvt_pk_bf16_f32 v162, v162, v166
    s_waitcnt lgkmcnt(1)
    v_mfma_f32_16x16x32_bf16 v[116:119], v[76:79], v[144:147], v[116:119]
    v_cvt_pk_bf16_f32 v163, v163, v167
    ds_read_b128 v[180:183], v15 offset:512
    v_mfma_f32_16x16x32_bf16 v[116:119], v[84:87], v[148:151], v[116:119]
    ds_read2_b32 v[184:185], v14 offset0:0 offset1:1
    v_mfma_f32_16x16x32_bf16 v[120:123], v[88:91], v[148:151], v[120:123]
    ds_read2_b32 v[186:187], v14 offset0:2 offset1:3
    v_mfma_f32_16x16x32_bf16 v[124:127], v[92:95], v[148:151], v[124:127]
    ds_read_b128 v[112:115], v15 offset:960
    v_mfma_f32_16x16x32_bf16 v[116:119], v[88:91], v[156:159], v[116:119]
    ds_read_b128 v[188:191], v15 offset:1472
    v_mfma_f32_16x16x32_bf16 v[120:123], v[92:95], v[156:159], v[120:123]
    ds_read2_b32 v[136:137], v18 offset0:32 offset1:33
    v_mfma_f32_16x16x32_bf16 v[116:119], v[92:95], v[168:171], v[116:119]
    ds_read2_b32 v[138:139], v18 offset0:34 offset1:35
    v_mfma_f32_16x16x32_bf16 v[116:119], v[100:103], v[172:175], v[116:119]
    ds_read2_b32 v[140:141], v18 offset0:16 offset1:17
    v_mfma_f32_16x16x32_bf16 v[120:123], v[104:107], v[172:175], v[120:123]
    ds_read2_b32 v[142:143], v18 offset0:18 offset1:19
    v_mfma_f32_16x16x32_bf16 v[124:127], v[108:111], v[172:175], v[124:127]
    ds_read_b128 v[144:147], v15 offset:2240
    s_waitcnt lgkmcnt(6)
    v_mfma_f32_16x16x32_bf16 v[116:119], v[104:107], v[176:179], v[116:119]
    ds_read_b128 v[152:155], v15 offset:2752
    v_mfma_f32_16x16x32_bf16 v[120:123], v[108:111], v[176:179], v[120:123]
    ds_read_b128 v[164:167], v15 offset:3264
    v_mfma_f32_16x16x32_bf16 v[116:119], v[108:111], v[180:183], v[116:119]
    ds_read_b128 v[148:151], v15 offset:3776
    v_mfma_f32_16x16x32_bf16 v[120:123], v[184:187], v[112:115], v[120:123]
    ds_read_b128 v[156:159], v15 offset:2176
    s_waitcnt lgkmcnt(6)
    v_mfma_f32_16x16x32_bf16 v[124:127], v[184:187], v[188:191], v[124:127]
    ds_read_b128 v[168:171], v15 offset:2688
    v_mfma_f32_16x16x32_bf16 v[128:131], v[160:163], v[136:139], 0
    ds_read_b128 v[172:175], v15 offset:3200
    s_waitcnt lgkmcnt(6)
    v_mfma_f32_16x16x32_bf16 v[128:131], v[132:135], v[140:143], v[128:131]
    ds_read_b128 v[176:179], v15 offset:3712
    v_mfma_f32_16x16x32_bf16 v[116:119], v[48:51], v[144:147], v[116:119]
    ds_read_b128 v[180:183], v15 offset:2112
    v_mfma_f32_16x16x32_bf16 v[120:123], v[52:55], v[144:147], v[120:123]
    ds_read_b128 v[112:115], v15 offset:2624
    v_mfma_f32_16x16x32_bf16 v[124:127], v[56:59], v[144:147], v[124:127]
    ds_read_b128 v[184:187], v15 offset:3136
    v_mfma_f32_16x16x32_bf16 v[128:131], v[60:63], v[144:147], v[128:131]
    ds_read_b128 v[188:191], v15 offset:3648
    s_waitcnt lgkmcnt(6)
    v_mfma_f32_16x16x32_bf16 v[120:123], v[48:51], v[152:155], v[120:123]
    ds_read_b128 v[140:143], v15 offset:2048
    v_mfma_f32_16x16x32_bf16 v[124:127], v[52:55], v[152:155], v[124:127]
    v_mfma_f32_16x16x32_bf16 v[128:131], v[56:59], v[152:155], v[128:131]
    ds_read_b128 v[60:63], v15 offset:2560
    v_mfma_f32_16x16x32_bf16 v[124:127], v[48:51], v[164:167], v[124:127]
    ds_read_b128 v[144:147], v15 offset:3072
    v_mfma_f32_16x16x32_bf16 v[128:131], v[52:55], v[164:167], v[128:131]
    s_waitcnt vmcnt(2)
    s_add_u32 m0, s26, 0x0
    v_mfma_f32_16x16x32_bf16 v[128:131], v[48:51], v[148:151], v[128:131]
    buffer_load_dwordx4 v29, s[36:39], s7 offen sc1 lds
    ds_read_b128 v[56:59], v15 offset:3584
    v_mfma_f32_16x16x32_bf16 v[116:119], v[64:67], v[156:159], v[116:119]
    v_mfma_f32_16x16x32_bf16 v[128:131], v[76:79], v[156:159], v[128:131]
    v_mfma_f32_16x16x32_bf16 v[128:131], v[72:75], v[168:171], v[128:131]
    s_waitcnt lgkmcnt(2)
    v_mfma_f32_16x16x32_bf16 v[128:131], v[68:71], v[172:175], v[128:131]
    buffer_load_dwordx4 v29, s[36:39], s7 offen offset:1024 sc1 lds
    s_add_u32 m0, s26, 0x2000
    v_mfma_f32_16x16x32_bf16 v[128:131], v[64:67], v[176:179], v[128:131]
    v_mfma_f32_16x16x32_bf16 v[116:119], v[80:83], v[180:183], v[116:119]
    v_mfma_f32_16x16x32_bf16 v[128:131], v[92:95], v[180:183], v[128:131]
    v_mfma_f32_16x16x32_bf16 v[128:131], v[88:91], v[112:115], v[128:131]
    buffer_load_dwordx4 v29, s[36:39], s8 offen sc1 lds
    v_mfma_f32_16x16x32_bf16 v[128:131], v[84:87], v[184:187], v[128:131]
    v_mfma_f32_16x16x32_bf16 v[128:131], v[80:83], v[188:191], v[128:131]
    v_mfma_f32_16x16x32_bf16 v[116:119], v[96:99], v[140:143], v[116:119]
    v_mfma_f32_16x16x32_bf16 v[128:131], v[108:111], v[140:143], v[128:131]
    buffer_load_dwordx4 v29, s[36:39], s8 offen offset:1024 sc1 lds
    s_add_u32 m0, s26, 0x4000
    v_mfma_f32_16x16x32_bf16 v[128:131], v[104:107], v[60:63], v[128:131]
    s_waitcnt lgkmcnt(0)
    v_mfma_f32_16x16x32_bf16 v[128:131], v[100:103], v[144:147], v[128:131]
    v_mfma_f32_16x16x32_bf16 v[128:131], v[96:99], v[56:59], v[128:131]
    ds_read2_b32 v[152:153], v18 offset0:48 offset1:49
    v_mfma_f32_16x16x32_bf16 v[120:123], v[68:71], v[156:159], v[120:123]
    buffer_load_dwordx4 v29, s[36:39], s9 offen sc1 lds
    ds_read2_b32 v[154:155], v18 offset0:50 offset1:51
    v_mfma_f32_16x16x32_bf16 v[124:127], v[72:75], v[156:159], v[124:127]
    v_mfma_f32_16x16x32_bf16 v[120:123], v[64:67], v[168:171], v[120:123]
    ds_write_b128 v17, v[116:119] offset:4096
    v_mfma_f32_16x16x32_bf16 v[124:127], v[68:71], v[168:171], v[124:127]
    v_mfma_f32_16x16x32_bf16 v[124:127], v[64:67], v[172:175], v[124:127]
    buffer_load_dwordx4 v29, s[36:39], s9 offen offset:1024 sc1 lds
    s_add_u32 m0, s26, 0x6000
    v_mfma_f32_16x16x32_bf16 v[120:123], v[84:87], v[180:183], v[120:123]
    ds_write_b128 v17, v[128:131] offset:7168
    v_mfma_f32_16x16x32_bf16 v[124:127], v[88:91], v[180:183], v[124:127]
    v_mfma_f32_16x16x32_bf16 v[120:123], v[80:83], v[112:115], v[120:123]
    v_mfma_f32_16x16x32_bf16 v[124:127], v[84:87], v[112:115], v[124:127]
    buffer_load_dwordx4 v29, s[36:39], s10 offen sc1 lds
    ds_read_b128 v[52:55], v47 offset:2048
    v_mfma_f32_16x16x32_bf16 v[124:127], v[80:83], v[184:187], v[124:127]
    ds_read_b128 v[164:167], v4 offset:5120
    v_mfma_f32_16x16x32_bf16 v[120:123], v[100:103], v[140:143], v[120:123]
    ds_read_b128 v[48:51], v4 offset:6144
    v_mfma_f32_16x16x32_bf16 v[124:127], v[104:107], v[140:143], v[124:127]
    v_mfma_f32_16x16x32_bf16 v[120:123], v[96:99], v[60:63], v[120:123]
    buffer_load_dwordx4 v29, s[36:39], s10 offen offset:1024 sc1 lds
    v_mfma_f32_16x16x32_bf16 v[124:127], v[100:103], v[60:63], v[124:127]
    v_mfma_f32_16x16x32_bf16 v[124:127], v[96:99], v[144:147], v[124:127]
    s_waitcnt vmcnt(8) lgkmcnt(2)
    s_barrier
    v_mfma_f32_16x16x32_bf16 v[120:123], v[132:135], v[152:155], v[120:123]
    ds_read_b128 v[116:119], v17 offset:5120
    v_mfma_f32_16x16x32_bf16 v[124:127], v[160:163], v[152:155], v[124:127]
    ds_read_b128 v[128:131], v17 offset:6144
    v_mfma_f32_16x16x32_bf16 v[124:127], v[132:135], v[136:139], v[124:127]
    s_waitcnt lgkmcnt(2)
    v_mfma_f32_16x16x32_bf16 v[120:123], v[52:55], v[164:167], v[120:123]
    v_mfma_f32_16x16x32_bf16 v[124:127], v[52:55], v[48:51], v[124:127]
    s_waitcnt lgkmcnt(1)
    s_nop 5
    v_pk_add_f32 v[120:121], v[120:121], v[116:117]
    v_pk_add_f32 v[122:123], v[122:123], v[118:119]
    v_cvt_pk_bf16_f32 v116, v120, v121
    v_cvt_pk_bf16_f32 v117, v122, v123
    buffer_store_dwordx2 v[116:117], v12, s[36:39], s29 offen sc1
    s_waitcnt lgkmcnt(0)
    v_pk_add_f32 v[124:125], v[124:125], v[128:129]
    v_pk_add_f32 v[126:127], v[126:127], v[130:131]
    v_cvt_pk_bf16_f32 v128, v124, v125
    v_cvt_pk_bf16_f32 v129, v126, v127
    buffer_store_dwordx2 v[128:129], v12, s[36:39], s30 offen sc1
join_34:
W3_3:
    s_cbranch_execz W3_ret
    v_mov_b32_e32 v48, s4
    v_mov_b32_e32 v49, s4
    v_mov_b32_e32 v50, s4
    v_mov_b32_e32 v51, s4
    v_and_b32_e32 v1, 15, v0
    s_lshl_b32 s68, s56, 7
    s_add_u32 s68, s68, 0x1bc00
    v_lshl_add_u32 v2, v1, 3, s68
    v_mov_b32_e32 v3, 0x1be00
    v_cndmask_b32_e64 v54, v3, v2, s[32:33]
    v_bfe_u32 v2, v0, 4, 1
    v_xor_b32_e32 v3, s66, v2
    v_lshlrev_b32_e32 v3, 7, v3
    v_lshl_add_u32 v3, v1, 3, v3
    v_add_u32_e32 v55, 0x1bc00, v3
    s_lshl_b32 s68, s56, 8
    s_add_u32 s68, s68, 0x1c000
    v_lshl_add_u32 v58, v1, 2, s68
    v_lshl_add_u32 v56, v2, 6, v58
    v_and_b32_e32 v1, 48, v0
    v_add_u32_e32 v57, s68, v1
    v_mov_b32_e32 v59, 0x3727c5ac
    v_mov_b32_e32 v46, 0x358637bd
    v_mov_b32_e32 v47, 0x3fb8aa3b
    s_mov_b32 s81, 0
    s_waitcnt vmcnt(4)
    ds_read_b128 v[60:63], v30
    ds_read_b128 v[64:67], v30 offset:1024
    ds_read_b128 v[68:71], v30 offset:8192
    ds_read_b128 v[72:75], v30 offset:9216
    ds_read_b128 v[76:79], v30 offset:16384
    ds_read_b128 v[80:83], v30 offset:17408
    s_waitcnt lgkmcnt(5)
    v_max_u32_e32 v4, v60, v62
    s_waitcnt lgkmcnt(4)
    v_max3_u32 v4, v4, v64, v66
    s_waitcnt lgkmcnt(3)
    v_max3_u32 v4, v4, v68, v70
    s_waitcnt lgkmcnt(2)
    v_max3_u32 v4, v4, v72, v74
    s_waitcnt lgkmcnt(1)
    v_max3_u32 v4, v4, v76, v78
    s_waitcnt lgkmcnt(0)
    v_max3_u32 v4, v4, v80, v82
    s_waitcnt vmcnt(2)
    ds_read_b128 v[84:87], v30 offset:24576
    ds_read_b128 v[88:91], v30 offset:25600
    s_waitcnt lgkmcnt(1)
    v_max3_u32 v4, v4, v84, v86
    s_waitcnt lgkmcnt(0)
    v_max3_u32 v4, v4, v88, v90
    v_cmp_eq_u32_e32 vcc, -1, v4
    s_cbranch_vccnz retry_43
ok_44:
    s_barrier
pass_45:
    ds_read_b64_tr_b16 v[136:137], v21
    ds_read_b64_tr_b16 v[138:139], v21 offset:1024
    ds_read_b64_tr_b16 v[140:141], v21 offset:2048
    ds_read_b64_tr_b16 v[142:143], v21 offset:3072
    s_waitcnt lgkmcnt(2)
    v_mfma_f32_16x16x32_bf16 v[124:127], v[48:51], v[136:139], 0
    ds_read_b64_tr_b16 v[144:145], v21 offset:4096
    v_mfma_f32_16x16x32_bf16 v[128:131], v[136:139], v[136:139], 0
    ds_read_b64_tr_b16 v[146:147], v21 offset:5120
    v_mfma_f32_16x16x32_bf16 v[60:63], v[136:139], a[0:3], 0
    ds_read_b64_tr_b16 v[148:149], v21 offset:6144
    v_mfma_f32_16x16x32_bf16 v[68:71], v[136:139], a[64:67], 0
    ds_read_b64_tr_b16 v[150:151], v21 offset:7168
    s_waitcnt lgkmcnt(4)
    v_mfma_f32_16x16x32_bf16 v[124:127], v[48:51], v[140:143], v[124:127]
    ds_read_b64_tr_b16 v[152:153], v21 offset:16384
    v_mfma_f32_16x16x32_bf16 v[128:131], v[140:143], v[140:143], v[128:131]
    ds_read_b64_tr_b16 v[154:155], v21 offset:17408
    v_mfma_f32_16x16x32_bf16 v[60:63], v[140:143], a[4:7], v[60:63]
    ds_read_b64_tr_b16 v[156:157], v21 offset:18432
    v_mfma_f32_16x16x32_bf16 v[68:71], v[140:143], a[68:71], v[68:71]
    ds_read_b64_tr_b16 v[158:159], v21 offset:19456
    s_waitcnt lgkmcnt(6)
    v_mfma_f32_16x16x32_bf16 v[124:127], v[48:51], v[144:147], v[124:127]
    ds_read_b64_tr_b16 v[160:161], v21 offset:20480
    v_mfma_f32_16x16x32_bf16 v[128:131], v[144:147], v[144:147], v[128:131]
    ds_read_b64_tr_b16 v[162:163], v21 offset:21504
    v_mfma_f32_16x16x32_bf16 v[60:63], v[144:147], a[8:11], v[60:63]
    ds_read_b64_tr_b16 v[164:165], v21 offset:22528
    v_mfma_f32_16x16x32_bf16 v[68:71], v[144:147], a[72:75], v[68:71]
    ds_read_b64_tr_b16 v[166:167], v21 offset:23552
    s_waitcnt lgkmcnt(6)
    v_mfma_f32_16x16x32_bf16 v[124:127], v[48:51], v[148:151], v[124:127]
    ds_read_b64_tr_b16 v[168:169], v27
    v_mfma_f32_16x16x32_bf16 v[128:131], v[148:151], v[148:151], v[128:131]
    ds_read_b64_tr_b16 v[170:171], v27 offset:1024
    v_mfma_f32_16x16x32_bf16 v[60:63], v[148:151], a[12:15], v[60:63]
    ds_read_b64_tr_b16 v[172:173], v27 offset:2048
    v_mfma_f32_16x16x32_bf16 v[68:71], v[148:151], a[76:79], v[68:71]
    ds_read_b64_tr_b16 v[174:175], v27 offset:3072
    v_mfma_f32_16x16x32_bf16 v[124:127], v[48:51], v[152:155], v[124:127]
    ds_read_b64_tr_b16 v[176:177], v27 offset:4096
    v_mfma_f32_16x16x32_bf16 v[128:131], v[152:155], v[152:155], v[128:131]
    ds_read_b64_tr_b16 v[178:179], v27 offset:5120
    v_mfma_f32_16x16x32_bf16 v[60:63], v[152:155], a[32:35], v[60:63]
    ds_read_b64_tr_b16 v[136:137], v27 offset:6144
    v_mfma_f32_16x16x32_bf16 v[68:71], v[152:155], a[96:99], v[68:71]
    ds_read_b64_tr_b16 v[138:139], v27 offset:7168
    s_waitcnt lgkmcnt(6)
    v_mfma_f32_16x16x32_bf16 v[124:127], v[48:51], v[156:159], v[124:127]
    ds_read_b64_tr_b16 v[140:141], v27 offset:16384
    v_mfma_f32_16x16x32_bf16 v[128:131], v[156:159], v[156:159], v[128:131]
    ds_read_b64_tr_b16 v[142:143], v27 offset:17408
    v_mfma_f32_16x16x32_bf16 v[60:63], v[156:159], a[36:39], v[60:63]
    ds_read_b64_tr_b16 v[144:145], v27 offset:18432
    v_mfma_f32_16x16x32_bf16 v[68:71], v[156:159], a[100:103], v[68:71]
    ds_read_b64_tr_b16 v[146:147], v27 offset:19456
    v_mfma_f32_16x16x32_bf16 v[124:127], v[48:51], v[160:163], v[124:127]
    ds_read_b64_tr_b16 v[148:149], v27 offset:20480
    v_mfma_f32_16x16x32_bf16 v[128:131], v[160:163], v[160:163], v[128:131]
    ds_read_b64_tr_b16 v[150:151], v27 offset:21504
    v_mfma_f32_16x16x32_bf16 v[60:63], v[160:163], a[40:43], v[60:63]
    ds_read_b64_tr_b16 v[152:153], v27 offset:22528
    v_mfma_f32_16x16x32_bf16 v[68:71], v[160:163], a[104:107], v[68:71]
    ds_read_b64_tr_b16 v[154:155], v27 offset:23552
    v_mfma_f32_16x16x32_bf16 v[124:127], v[48:51], v[164:167], v[124:127]
    ds_read_b64_tr_b16 v[156:157], v26
    v_mfma_f32_16x16x32_bf16 v[128:131], v[164:167], v[164:167], v[128:131]
    ds_read_b64_tr_b16 v[158:159], v26 offset:1024
    v_mfma_f32_16x16x32_bf16 v[60:63], v[164:167], a[44:47], v[60:63]
    ds_read_b64_tr_b16 v[160:161], v28
    v_mfma_f32_16x16x32_bf16 v[68:71], v[164:167], a[108:111], v[68:71]
    ds_read_b64_tr_b16 v[162:163], v28 offset:1024
    v_mfma_f32_16x16x32_bf16 v[64:67], v[168:171], a[0:3], 0
    s_nop 1
    v_cndmask_b32_e64 v128, v128, v129, s[46:47]
    v_cndmask_b32_e64 v130, v130, v131, s[46:47]
    v_mfma_f32_16x16x32_bf16 v[72:75], v[168:171], a[64:67], 0
    v_cndmask_b32_e64 v125, v128, v130, s[78:79]
    s_waitcnt lgkmcnt(4)
    v_mfma_f32_16x16x32_bf16 v[64:67], v[172:175], a[4:7], v[64:67]
    ds_write_b64 v54, v[124:125]
    v_mfma_f32_16x16x32_bf16 v[72:75], v[172:175], a[68:71], v[72:75]
    ds_read_b64_tr_b16 v[164:165], v26 offset:2048
    v_mfma_f32_16x16x32_bf16 v[64:67], v[176:179], a[8:11], v[64:67]
    ds_read_b64_tr_b16 v[166:167], v26 offset:3072
    v_mfma_f32_16x16x32_bf16 v[72:75], v[176:179], a[72:75], v[72:75]
    ds_read_b64_tr_b16 v[168:169], v28 offset:2048
    v_mfma_f32_16x16x32_bf16 v[64:67], v[136:139], a[12:15], v[64:67]
    ds_read_b64_tr_b16 v[170:171], v28 offset:3072
    v_mfma_f32_16x16x32_bf16 v[72:75], v[136:139], a[76:79], v[72:75]
    ds_read_b64_tr_b16 v[172:173], v26 offset:4096
    v_mfma_f32_16x16x32_bf16 v[64:67], v[140:143], a[32:35], v[64:67]
    ds_read_b64_tr_b16 v[174:175], v26 offset:5120
    v_mfma_f32_16x16x32_bf16 v[72:75], v[140:143], a[96:99], v[72:75]
    ds_read_b64_tr_b16 v[176:177], v28 offset:4096
    v_mfma_f32_16x16x32_bf16 v[64:67], v[144:147], a[36:39], v[64:67]
    ds_read_b64_tr_b16 v[178:179], v28 offset:5120
    v_mfma_f32_16x16x32_bf16 v[72:75], v[144:147], a[100:103], v[72:75]
    ds_read_b64_tr_b16 v[136:137], v26 offset:6144
    v_mfma_f32_16x16x32_bf16 v[64:67], v[148:151], a[40:43], v[64:67]
    s_waitcnt lgkmcnt(5)
    s_barrier
    v_mfma_f32_16x16x32_bf16 v[72:75], v[148:151], a[104:107], v[72:75]
    ds_read2_b64 v[132:135], v55 offset0:0 offset1:32
    v_mfma_f32_16x16x32_bf16 v[64:67], v[152:155], a[44:47], v[64:67]
    ds_read_b64_tr_b16 v[138:139], v26 offset:7168
    v_mfma_f32_16x16x32_bf16 v[72:75], v[152:155], a[108:111], v[72:75]
W3_4:
    s_cbranch_execz W3_ret
    ds_read_b64_tr_b16 v[140:141], v28 offset:6144
    v_mfma_f32_16x16x32_bf16 v[60:63], v[156:159], a[16:19], v[60:63]
    ds_read_b64_tr_b16 v[142:143], v28 offset:7168
    v_mfma_f32_16x16x32_bf16 v[68:71], v[156:159], a[80:83], v[68:71]
    ds_read_b64_tr_b16 v[144:145], v26 offset:16384
    v_mfma_f32_16x16x32_bf16 v[64:67], v[160:163], a[16:19], v[64:67]
    ds_read_b64_tr_b16 v[146:147], v26 offset:17408
    v_mfma_f32_16x16x32_bf16 v[72:75], v[160:163], a[80:83], v[72:75]
    s_waitcnt lgkmcnt(5)
    v_add_f32_e32 v132, v132, v134
    v_mfma_f32_16x16x32_bf16 v[60:63], v[164:167], a[20:23], v[60:63]
    v_add_f32_e32 v133, v133, v135
    v_mul_f32_e32 v132, 0x3b000000, v132
    v_mfma_f32_16x16x32_bf16 v[68:71], v[164:167], a[84:87], v[68:71]
    v_fmamk_f32 v133, v133, 0x3b000000, v59
    v_fma_f32 v133, -v132, v132, v133
    v_mfma_f32_16x16x32_bf16 v[64:67], v[168:171], a[20:23], v[64:67]
    v_rsq_f32_e64 v133, v133
    ds_read_b64_tr_b16 v[148:149], v28 offset:16384
    v_mfma_f32_16x16x32_bf16 v[72:75], v[168:171], a[84:87], v[72:75]
    ds_write2_b32 v56, v132, v133 offset0:0 offset1:32
    v_mfma_f32_16x16x32_bf16 v[60:63], v[172:175], a[24:27], v[60:63]
    ds_read_b128 v[92:95], v57
    v_mfma_f32_16x16x32_bf16 v[68:71], v[172:175], a[88:91], v[68:71]
    ds_read_b128 v[100:103], v57 offset:128
    v_mfma_f32_16x16x32_bf16 v[64:67], v[176:179], a[24:27], v[64:67]
    ds_read_b64_tr_b16 v[150:151], v28 offset:17408
    s_waitcnt vmcnt(0)
    v_mfma_f32_16x16x32_bf16 v[72:75], v[176:179], a[88:91], v[72:75]
    ds_read_b128 v[96:99], v57 offset:64
    s_waitcnt lgkmcnt(6)
    v_mfma_f32_16x16x32_bf16 v[60:63], v[136:139], a[28:31], v[60:63]
    ds_read_b64_tr_b16 v[152:153], v26 offset:18432
    s_add_u32 m0, s26, 0x8000
    v_mfma_f32_16x16x32_bf16 v[68:71], v[136:139], a[92:95], v[68:71]
    ds_read_b64_tr_b16 v[154:155], v26 offset:19456
    buffer_load_dwordx4 v29, s[36:39], s11 offen sc1 lds
    v_mfma_f32_16x16x32_bf16 v[64:67], v[140:143], a[28:31], v[64:67]
    ds_read_b64_tr_b16 v[156:157], v28 offset:18432
    v_mfma_f32_16x16x32_bf16 v[72:75], v[140:143], a[92:95], v[72:75]
    ds_read_b64_tr_b16 v[158:159], v28 offset:19456
    v_mfma_f32_16x16x32_bf16 v[60:63], v[144:147], a[48:51], v[60:63]
    ds_read_b64_tr_b16 v[160:161], v26 offset:20480
    v_mfma_f32_16x16x32_bf16 v[68:71], v[144:147], a[112:115], v[68:71]
    ds_read_b64_tr_b16 v[162:163], v26 offset:21504
    s_waitcnt lgkmcnt(6)
    v_mfma_f32_16x16x32_bf16 v[64:67], v[148:151], a[48:51], v[64:67]
    ds_read_b64_tr_b16 v[164:165], v28 offset:20480
    buffer_load_dwordx4 v29, s[36:39], s11 offen offset:1024 sc1 lds
    v_mfma_f32_16x16x32_bf16 v[72:75], v[148:151], a[112:115], v[72:75]
    ds_read_b64_tr_b16 v[166:167], v28 offset:21504
    s_waitcnt lgkmcnt(6)
    v_mfma_f32_16x16x32_bf16 v[60:63], v[152:155], a[52:55], v[60:63]
    ds_read_b64_tr_b16 v[168:169], v26 offset:22528
    s_add_u32 m0, s26, 0xa000
    v_mfma_f32_16x16x32_bf16 v[68:71], v[152:155], a[116:119], v[68:71]
    ds_read_b64_tr_b16 v[170:171], v26 offset:23552
    s_waitcnt lgkmcnt(6)
    v_mfma_f32_16x16x32_bf16 v[64:67], v[156:159], a[52:55], v[64:67]
    ds_read_b64_tr_b16 v[172:173], v28 offset:22528
    v_mfma_f32_16x16x32_bf16 v[72:75], v[156:159], a[116:119], v[72:75]
    ds_read_b64_tr_b16 v[174:175], v28 offset:23552
    s_waitcnt lgkmcnt(6)
    v_mfma_f32_16x16x32_bf16 v[60:63], v[160:163], a[56:59], v[60:63]
    ds_read_b128 v[104:107], v57 offset:192
    buffer_load_dwordx4 v29, s[36:39], s12 offen sc1 lds
    v_mfma_f32_16x16x32_bf16 v[68:71], v[160:163], a[120:123], v[68:71]
    ds_read2_b32 v[108:109], v58 offset0:0 offset1:32
    s_waitcnt lgkmcnt(6)
    v_mfma_f32_16x16x32_bf16 v[64:67], v[164:167], a[56:59], v[64:67]
    ds_read2_b32 v[110:111], v58 offset0:16 offset1:48
    v_mfma_f32_16x16x32_bf16 v[72:75], v[164:167], a[120:123], v[72:75]
    s_waitcnt lgkmcnt(5)
    v_mfma_f32_16x16x32_bf16 v[60:63], v[168:171], a[60:63], v[60:63]
    buffer_load_dwordx4 v29, s[36:39], s12 offen offset:1024 sc1 lds
    s_add_u32 m0, s26, 0xc000
    v_mfma_f32_16x16x32_bf16 v[68:71], v[168:171], a[124:127], v[68:71]
    s_waitcnt lgkmcnt(3)
    v_mfma_f32_16x16x32_bf16 v[64:67], v[172:175], a[60:63], v[64:67]
    v_mfma_f32_16x16x32_bf16 v[72:75], v[172:175], a[124:127], v[72:75]
    buffer_load_dwordx4 v29, s[36:39], s13 offen sc1 lds
    buffer_load_dwordx4 v29, s[36:39], s13 offen offset:1024 sc1 lds
    s_add_u32 m0, s26, 0xe000
    s_nop 0
    buffer_load_dwordx4 v29, s[36:39], s14 offen sc1 lds
    buffer_load_dwordx4 v29, s[36:39], s14 offen offset:1024 sc1 lds
    v_pk_fma_f32 v[60:61], v[92:93], v[38:39], v[60:61] op_sel_hi:[1,0,1] neg_lo:[1,0,0] neg_hi:[1,0,0]
    v_pk_fma_f32 v[68:69], v[92:93], v[38:39], v[68:69] op_sel:[0,1,0] op_sel_hi:[1,1,1] neg_lo:[1,0,0] neg_hi:[1,0,0]
    v_pk_fma_f32 v[60:61], v[60:61], v[100:101], v[46:47] op_sel_hi:[1,1,0]
    v_pk_mul_f32 v[68:69], v[68:69], v[100:101]
    v_pk_mul_f32 v[52:53], v[60:61], v[46:47] op_sel:[0,1] op_sel_hi:[1,1]
    v_exp_f32_e64 v52, v52 clamp
    v_exp_f32_e64 v53, v53 clamp
    v_max_f32_e32 v60, v46, v60
    v_max_f32_e32 v61, v46, v61
    v_pk_add_f32 v[60:61], v[60:61], v[52:53]
    v_cvt_pk_bf16_f32 v128, v68, v69
    v_cvt_pk_bf16_f32 v124, v60, v61
    v_pk_fma_f32 v[62:63], v[94:95], v[38:39], v[62:63] op_sel_hi:[1,0,1] neg_lo:[1,0,0] neg_hi:[1,0,0]
    v_pk_fma_f32 v[70:71], v[94:95], v[38:39], v[70:71] op_sel:[0,1,0] op_sel_hi:[1,1,1] neg_lo:[1,0,0] neg_hi:[1,0,0]
    v_pk_fma_f32 v[62:63], v[62:63], v[102:103], v[46:47] op_sel_hi:[1,1,0]
    v_pk_mul_f32 v[70:71], v[70:71], v[102:103]
    v_pk_mul_f32 v[52:53], v[62:63], v[46:47] op_sel:[0,1] op_sel_hi:[1,1]
    v_exp_f32_e64 v52, v52 clamp
    v_exp_f32_e64 v53, v53 clamp
    v_max_f32_e32 v62, v46, v62
    v_max_f32_e32 v63, v46, v63
    v_pk_add_f32 v[62:63], v[62:63], v[52:53]
    v_cvt_pk_bf16_f32 v129, v70, v71
    v_cvt_pk_bf16_f32 v125, v62, v63
    v_pk_fma_f32 v[64:65], v[96:97], v[38:39], v[64:65] op_sel_hi:[1,0,1] neg_lo:[1,0,0] neg_hi:[1,0,0]
    v_pk_fma_f32 v[72:73], v[96:97], v[38:39], v[72:73] op_sel:[0,1,0] op_sel_hi:[1,1,1] neg_lo:[1,0,0] neg_hi:[1,0,0]
    s_waitcnt lgkmcnt(1)
    v_pk_fma_f32 v[64:65], v[64:65], v[104:105], v[46:47] op_sel_hi:[1,1,0]
    v_pk_mul_f32 v[72:73], v[72:73], v[104:105]
    v_pk_mul_f32 v[52:53], v[64:65], v[46:47] op_sel:[0,1] op_sel_hi:[1,1]
    v_exp_f32_e64 v52, v52 clamp
    v_exp_f32_e64 v53, v53 clamp
    v_max_f32_e32 v64, v46, v64
    v_max_f32_e64 v65, v46, v65
    v_pk_add_f32 v[64:65], v[64:65], v[52:53]
    v_cvt_pk_bf16_f32 v130, v72, v73
    v_cvt_pk_bf16_f32 v126, v64, v65
    v_pk_fma_f32 v[66:67], v[98:99], v[38:39], v[66:67] op_sel_hi:[1,0,1] neg_lo:[1,0,0] neg_hi:[1,0,0]
    v_pk_fma_f32 v[74:75], v[98:99], v[38:39], v[74:75] op_sel:[0,1,0] op_sel_hi:[1,1,1] neg_lo:[1,0,0] neg_hi:[1,0,0]
    v_pk_fma_f32 v[66:67], v[66:67], v[106:107], v[46:47] op_sel_hi:[1,1,0]
    v_pk_mul_f32 v[74:75], v[74:75], v[106:107]
    v_pk_mul_f32 v[52:53], v[66:67], v[46:47] op_sel:[0,1] op_sel_hi:[1,1]
    v_exp_f32_e64 v52, v52 clamp
    v_exp_f32_e64 v53, v53 clamp
    v_max_f32_e32 v66, v46, v66
    v_max_f32_e32 v67, v46, v67
    v_pk_add_f32 v[66:67], v[66:67], v[52:53]
    v_cvt_pk_bf16_f32 v131, v74, v75
    v_cvt_pk_bf16_f32 v127, v66, v67
    s_nop 1
    v_mfma_f32_16x16x32_bf16 v[116:119], v[124:127], v[128:131], 0
    v_mfma_f32_16x16x32_bf16 v[120:123], v[124:127], v[48:51], 0
    s_mov_b32 s81, 0
    s_waitcnt vmcnt(0)
    s_barrier
pass_46:
    ds_read_b64_tr_b16 v[136:137], v21 offset:32768
    ds_read_b64_tr_b16 v[138:139], v21 offset:33792
    ds_read_b64_tr_b16 v[140:141], v21 offset:34816
    ds_read_b64_tr_b16 v[142:143], v21 offset:35840
    s_waitcnt lgkmcnt(2)
    v_mfma_f32_16x16x32_bf16 v[124:127], v[48:51], v[136:139], 0
    ds_read_b64_tr_b16 v[144:145], v21 offset:36864
    v_mfma_f32_16x16x32_bf16 v[128:131], v[136:139], v[136:139], 0
    ds_read_b64_tr_b16 v[146:147], v21 offset:37888
    v_mfma_f32_16x16x32_bf16 v[60:63], v[136:139], a[0:3], 0
    ds_read_b64_tr_b16 v[148:149], v21 offset:38912
    v_mfma_f32_16x16x32_bf16 v[68:71], v[136:139], a[64:67], 0
    ds_read_b64_tr_b16 v[150:151], v21 offset:39936
    s_waitcnt lgkmcnt(4)
    v_mfma_f32_16x16x32_bf16 v[124:127], v[48:51], v[140:143], v[124:127]
    ds_read_b64_tr_b16 v[152:153], v21 offset:49152
    v_mfma_f32_16x16x32_bf16 v[128:131], v[140:143], v[140:143], v[128:131]
    ds_read_b64_tr_b16 v[154:155], v21 offset:50176
    v_mfma_f32_16x16x32_bf16 v[60:63], v[140:143], a[4:7], v[60:63]
    ds_read_b64_tr_b16 v[156:157], v21 offset:51200
    v_mfma_f32_16x16x32_bf16 v[68:71], v[140:143], a[68:71], v[68:71]
    ds_read_b64_tr_b16 v[158:159], v21 offset:52224
    s_waitcnt lgkmcnt(6)
    v_mfma_f32_16x16x32_bf16 v[124:127], v[48:51], v[144:147], v[124:127]
    ds_read_b64_tr_b16 v[160:161], v21 offset:53248
    v_mfma_f32_16x16x32_bf16 v[128:131], v[144:147], v[144:147], v[128:131]
    ds_read_b64_tr_b16 v[162:163], v21 offset:54272
    v_mfma_f32_16x16x32_bf16 v[60:63], v[144:147], a[8:11], v[60:63]
    ds_read_b64_tr_b16 v[164:165], v21 offset:55296
    v_mfma_f32_16x16x32_bf16 v[68:71], v[144:147], a[72:75], v[68:71]
    ds_read_b64_tr_b16 v[166:167], v21 offset:56320
    s_waitcnt lgkmcnt(6)
    v_mfma_f32_16x16x32_bf16 v[124:127], v[48:51], v[148:151], v[124:127]
    ds_read_b64_tr_b16 v[168:169], v27 offset:32768
    v_mfma_f32_16x16x32_bf16 v[128:131], v[148:151], v[148:151], v[128:131]
    ds_read_b64_tr_b16 v[170:171], v27 offset:33792
    v_mfma_f32_16x16x32_bf16 v[60:63], v[148:151], a[12:15], v[60:63]
    ds_read_b64_tr_b16 v[172:173], v27 offset:34816
    v_mfma_f32_16x16x32_bf16 v[68:71], v[148:151], a[76:79], v[68:71]
    ds_read_b64_tr_b16 v[174:175], v27 offset:35840
    v_mfma_f32_16x16x32_bf16 v[124:127], v[48:51], v[152:155], v[124:127]
    ds_read_b64_tr_b16 v[176:177], v27 offset:36864
    v_mfma_f32_16x16x32_bf16 v[128:131], v[152:155], v[152:155], v[128:131]
    ds_read_b64_tr_b16 v[178:179], v27 offset:37888
    v_mfma_f32_16x16x32_bf16 v[60:63], v[152:155], a[32:35], v[60:63]
    ds_read_b64_tr_b16 v[136:137], v27 offset:38912
    v_mfma_f32_16x16x32_bf16 v[68:71], v[152:155], a[96:99], v[68:71]
    ds_read_b64_tr_b16 v[138:139], v27 offset:39936
    s_waitcnt lgkmcnt(6)
    v_mfma_f32_16x16x32_bf16 v[124:127], v[48:51], v[156:159], v[124:127]
    ds_read_b64_tr_b16 v[140:141], v27 offset:49152
    v_mfma_f32_16x16x32_bf16 v[128:131], v[156:159], v[156:159], v[128:131]
    ds_read_b64_tr_b16 v[142:143], v27 offset:50176
    v_mfma_f32_16x16x32_bf16 v[60:63], v[156:159], a[36:39], v[60:63]
    ds_read_b64_tr_b16 v[144:145], v27 offset:51200
    v_mfma_f32_16x16x32_bf16 v[68:71], v[156:159], a[100:103], v[68:71]
    ds_read_b64_tr_b16 v[146:147], v27 offset:52224
    v_mfma_f32_16x16x32_bf16 v[124:127], v[48:51], v[160:163], v[124:127]
    ds_read_b64_tr_b16 v[148:149], v27 offset:53248
    v_mfma_f32_16x16x32_bf16 v[128:131], v[160:163], v[160:163], v[128:131]
    ds_read_b64_tr_b16 v[150:151], v27 offset:54272
    v_mfma_f32_16x16x32_bf16 v[60:63], v[160:163], a[40:43], v[60:63]
    ds_read_b64_tr_b16 v[152:153], v27 offset:55296
    v_mfma_f32_16x16x32_bf16 v[68:71], v[160:163], a[104:107], v[68:71]
    ds_read_b64_tr_b16 v[154:155], v27 offset:56320
    v_mfma_f32_16x16x32_bf16 v[124:127], v[48:51], v[164:167], v[124:127]
    ds_read_b64_tr_b16 v[156:157], v26 offset:32768
    v_mfma_f32_16x16x32_bf16 v[128:131], v[164:167], v[164:167], v[128:131]
    ds_read_b64_tr_b16 v[158:159], v26 offset:33792
    v_mfma_f32_16x16x32_bf16 v[60:63], v[164:167], a[44:47], v[60:63]
    ds_read_b64_tr_b16 v[160:161], v28 offset:32768
    v_mfma_f32_16x16x32_bf16 v[68:71], v[164:167], a[108:111], v[68:71]
    ds_read_b64_tr_b16 v[162:163], v28 offset:33792
    v_mfma_f32_16x16x32_bf16 v[64:67], v[168:171], a[0:3], 0
    s_nop 1
    v_cndmask_b32_e64 v128, v128, v129, s[46:47]
    v_cndmask_b32_e64 v130, v130, v131, s[46:47]
    v_mfma_f32_16x16x32_bf16 v[72:75], v[168:171], a[64:67], 0
    v_cndmask_b32_e64 v125, v128, v130, s[78:79]
    s_waitcnt lgkmcnt(4)
    v_mfma_f32_16x16x32_bf16 v[64:67], v[172:175], a[4:7], v[64:67]
    ds_write_b64 v54, v[124:125]
    v_mfma_f32_16x16x32_bf16 v[72:75], v[172:175], a[68:71], v[72:75]
    ds_read_b64_tr_b16 v[164:165], v26 offset:34816
    v_mfma_f32_16x16x32_bf16 v[64:67], v[176:179], a[8:11], v[64:67]
    ds_read_b64_tr_b16 v[166:167], v26 offset:35840
    v_mfma_f32_16x16x32_bf16 v[72:75], v[176:179], a[72:75], v[72:75]
    ds_read_b64_tr_b16 v[168:169], v28 offset:34816
    v_mfma_f32_16x16x32_bf16 v[64:67], v[136:139], a[12:15], v[64:67]
    ds_read_b64_tr_b16 v[170:171], v28 offset:35840
    v_mfma_f32_16x16x32_bf16 v[72:75], v[136:139], a[76:79], v[72:75]
    ds_read_b64_tr_b16 v[172:173], v26 offset:36864
    v_mfma_f32_16x16x32_bf16 v[64:67], v[140:143], a[32:35], v[64:67]
    ds_read_b64_tr_b16 v[174:175], v26 offset:37888
    v_mfma_f32_16x16x32_bf16 v[72:75], v[140:143], a[96:99], v[72:75]
    ds_read_b64_tr_b16 v[176:177], v28 offset:36864
    v_mfma_f32_16x16x32_bf16 v[64:67], v[144:147], a[36:39], v[64:67]
    ds_read_b64_tr_b16 v[178:179], v28 offset:37888
    v_mfma_f32_16x16x32_bf16 v[72:75], v[144:147], a[100:103], v[72:75]
    ds_read_b64_tr_b16 v[136:137], v26 offset:38912
    v_mfma_f32_16x16x32_bf16 v[64:67], v[148:151], a[40:43], v[64:67]
    s_waitcnt lgkmcnt(5)
    s_barrier
    v_mfma_f32_16x16x32_bf16 v[72:75], v[148:151], a[104:107], v[72:75]
    ds_read2_b64 v[132:135], v55 offset0:0 offset1:32
    v_mfma_f32_16x16x32_bf16 v[64:67], v[152:155], a[44:47], v[64:67]
    ds_read_b64_tr_b16 v[138:139], v26 offset:39936
    v_mfma_f32_16x16x32_bf16 v[72:75], v[152:155], a[108:111], v[72:75]
    ds_read_b64_tr_b16 v[140:141], v28 offset:38912
    v_mfma_f32_16x16x32_bf16 v[60:63], v[156:159], a[16:19], v[60:63]
    ds_read_b64_tr_b16 v[142:143], v28 offset:39936
    v_mfma_f32_16x16x32_bf16 v[68:71], v[156:159], a[80:83], v[68:71]
    ds_read_b64_tr_b16 v[144:145], v26 offset:49152
    v_mfma_f32_16x16x32_bf16 v[64:67], v[160:163], a[16:19], v[64:67]
    ds_read_b64_tr_b16 v[146:147], v26 offset:50176
    v_mfma_f32_16x16x32_bf16 v[72:75], v[160:163], a[80:83], v[72:75]
    s_waitcnt lgkmcnt(5)
    v_add_f32_e32 v132, v132, v134
    v_mfma_f32_16x16x32_bf16 v[60:63], v[164:167], a[20:23], v[60:63]
    v_add_f32_e32 v133, v133, v135
    v_cmp_u_f32_e64 vcc, v132, v132
    v_mfma_f32_16x16x32_bf16 v[68:71], v[164:167], a[84:87], v[68:71]
    v_mul_f32_e32 v132, 0x3b000000, v132
    v_fmamk_f32 v133, v133, 0x3b000000, v59
    v_mfma_f32_16x16x32_bf16 v[64:67], v[168:171], a[20:23], v[64:67]
    v_fma_f32 v133, -v132, v132, v133
    v_rsq_f32_e32 v133, v133
    v_mfma_f32_16x16x32_bf16 v[72:75], v[168:171], a[84:87], v[72:75]
    s_cbranch_vccnz redo_47
back_48:
    v_mfma_f32_16x16x32_bf16 v[60:63], v[172:175], a[24:27], v[60:63]
    ds_write2_b32 v56, v132, v133 offset0:0 offset1:32
    v_mfma_f32_16x16x32_bf16 v[68:71], v[172:175], a[88:91], v[68:71]
    ds_read_b128 v[92:95], v57
    v_mfma_f32_16x16x32_bf16 v[64:67], v[176:179], a[24:27], v[64:67]
    ds_read_b64_tr_b16 v[148:149], v28 offset:49152
    v_mfma_f32_16x16x32_bf16 v[72:75], v[176:179], a[88:91], v[72:75]
    ds_read_b64_tr_b16 v[150:151], v28 offset:50176
    s_waitcnt lgkmcnt(4)
    v_mfma_f32_16x16x32_bf16 v[60:63], v[136:139], a[28:31], v[60:63]
    ds_read_b64_tr_b16 v[152:153], v26 offset:51200
    v_mfma_f32_16x16x32_bf16 v[68:71], v[136:139], a[92:95], v[68:71]
    ds_read_b64_tr_b16 v[154:155], v26 offset:52224
    v_mfma_f32_16x16x32_bf16 v[64:67], v[140:143], a[28:31], v[64:67]
    ds_read_b64_tr_b16 v[156:157], v28 offset:51200
    v_mfma_f32_16x16x32_bf16 v[72:75], v[140:143], a[92:95], v[72:75]
    ds_read_b64_tr_b16 v[158:159], v28 offset:52224
    v_mfma_f32_16x16x32_bf16 v[60:63], v[144:147], a[48:51], v[60:63]
    ds_read_b64_tr_b16 v[160:161], v26 offset:53248
    v_mfma_f32_16x16x32_bf16 v[68:71], v[144:147], a[112:115], v[68:71]
    ds_read_b64_tr_b16 v[162:163], v26 offset:54272
    s_waitcnt lgkmcnt(6)
    v_mfma_f32_16x16x32_bf16 v[64:67], v[148:151], a[48:51], v[64:67]
    ds_read_b64_tr_b16 v[164:165], v28 offset:53248
    v_mfma_f32_16x16x32_bf16 v[72:75], v[148:151], a[112:115], v[72:75]
    ds_read_b64_tr_b16 v[166:167], v28 offset:54272
    s_waitcnt lgkmcnt(6)
    v_mfma_f32_16x16x32_bf16 v[60:63], v[152:155], a[52:55], v[60:63]
    ds_read_b64_tr_b16 v[168:169], v26 offset:55296
    v_mfma_f32_16x16x32_bf16 v[68:71], v[152:155], a[116:119], v[68:71]
    ds_read_b64_tr_b16 v[170:171], v26 offset:56320
    s_waitcnt lgkmcnt(6)
    v_mfma_f32_16x16x32_bf16 v[64:67], v[156:159], a[52:55], v[64:67]
    ds_read_b64_tr_b16 v[172:173], v28 offset:55296
    v_mfma_f32_16x16x32_bf16 v[72:75], v[156:159], a[116:119], v[72:75]
    ds_read_b64_tr_b16 v[174:175], v28 offset:56320
    s_waitcnt lgkmcnt(6)
    v_mfma_f32_16x16x32_bf16 v[60:63], v[160:163], a[56:59], v[60:63]
    ds_read_b128 v[100:103], v57 offset:128
    v_mfma_f32_16x16x32_bf16 v[68:71], v[160:163], a[120:123], v[68:71]
    ds_read_b128 v[96:99], v57 offset:64
    s_waitcnt lgkmcnt(6)
    v_mfma_f32_16x16x32_bf16 v[64:67], v[164:167], a[56:59], v[64:67]
    ds_read_b128 v[104:107], v57 offset:192
    v_mfma_f32_16x16x32_bf16 v[72:75], v[164:167], a[120:123], v[72:75]
    ds_read2_b32 v[112:113], v58 offset0:0 offset1:32
    s_waitcnt lgkmcnt(6)
    v_mfma_f32_16x16x32_bf16 v[60:63], v[168:171], a[60:63], v[60:63]
    ds_read2_b32 v[114:115], v58 offset0:16 offset1:48
    v_mfma_f32_16x16x32_bf16 v[68:71], v[168:171], a[124:127], v[68:71]
    s_waitcnt lgkmcnt(5)
    v_mfma_f32_16x16x32_bf16 v[64:67], v[172:175], a[60:63], v[64:67]
    v_mfma_f32_16x16x32_bf16 v[72:75], v[172:175], a[124:127], v[72:75]
    s_nop 2
    v_pk_fma_f32 v[60:61], v[92:93], v[38:39], v[60:61] op_sel_hi:[1,0,1] neg_lo:[1,0,0] neg_hi:[1,0,0]
    s_nop 0
    v_pk_fma_f32 v[68:69], v[92:93], v[38:39], v[68:69] op_sel:[0,1,0] op_sel_hi:[1,1,1] neg_lo:[1,0,0] neg_hi:[1,0,0]
    s_waitcnt lgkmcnt(3)
    v_pk_fma_f32 v[60:61], v[60:61], v[100:101], v[46:47] op_sel_hi:[1,1,0]
    v_pk_mul_f32 v[68:69], v[68:69], v[100:101]
    v_pk_mul_f32 v[52:53], v[60:61], v[46:47] op_sel:[0,1] op_sel_hi:[1,1]
    v_exp_f32_e64 v52, v52 clamp
    v_exp_f32_e64 v53, v53 clamp
    v_max_f32_e32 v60, v46, v60
    v_max_f32_e64 v61, v46, v61
    v_pk_add_f32 v[60:61], v[60:61], v[52:53]
    v_cvt_pk_bf16_f32 v128, v68, v69
    v_cvt_pk_bf16_f32 v124, v60, v61
    v_pk_fma_f32 v[62:63], v[94:95], v[38:39], v[62:63] op_sel_hi:[1,0,1] neg_lo:[1,0,0] neg_hi:[1,0,0]
    v_pk_fma_f32 v[70:71], v[94:95], v[38:39], v[70:71] op_sel:[0,1,0] op_sel_hi:[1,1,1] neg_lo:[1,0,0] neg_hi:[1,0,0]
    v_pk_fma_f32 v[62:63], v[62:63], v[102:103], v[46:47] op_sel_hi:[1,1,0]
    v_pk_mul_f32 v[70:71], v[70:71], v[102:103]
    v_pk_mul_f32 v[52:53], v[62:63], v[46:47] op_sel:[0,1] op_sel_hi:[1,1]
    v_exp_f32_e64 v52, v52 clamp
    v_exp_f32_e64 v53, v53 clamp
    v_max_f32_e32 v62, v46, v62
    v_max_f32_e32 v63, v46, v63
    v_pk_add_f32 v[62:63], v[62:63], v[52:53]
    v_cvt_pk_bf16_f32 v129, v70, v71
    v_cvt_pk_bf16_f32 v125, v62, v63
    v_pk_fma_f32 v[64:65], v[96:97], v[38:39], v[64:65] op_sel_hi:[1,0,1] neg_lo:[1,0,0] neg_hi:[1,0,0]
    v_pk_fma_f32 v[72:73], v[96:97], v[38:39], v[72:73] op_sel:[0,1,0] op_sel_hi:[1,1,1] neg_lo:[1,0,0] neg_hi:[1,0,0]
    s_waitcnt lgkmcnt(2)
    v_pk_fma_f32 v[64:65], v[64:65], v[104:105], v[46:47] op_sel_hi:[1,1,0]
    v_pk_mul_f32 v[72:73], v[72:73], v[104:105]
    v_pk_mul_f32 v[52:53], v[64:65], v[46:47] op_sel:[0,1] op_sel_hi:[1,1]
    v_exp_f32_e64 v52, v52 clamp
    v_exp_f32_e64 v53, v53 clamp
    v_max_f32_e32 v64, v46, v64
    v_max_f32_e64 v65, v46, v65
    v_pk_add_f32 v[64:65], v[64:65], v[52:53]
    v_cvt_pk_bf16_f32 v130, v72, v73
    v_cvt_pk_bf16_f32 v126, v64, v65
    v_pk_fma_f32 v[66:67], v[98:99], v[38:39], v[66:67] op_sel_hi:[1,0,1] neg_lo:[1,0,0] neg_hi:[1,0,0]
    v_pk_fma_f32 v[74:75], v[98:99], v[38:39], v[74:75] op_sel:[0,1,0] op_sel_hi:[1,1,1] neg_lo:[1,0,0] neg_hi:[1,0,0]
    v_pk_fma_f32 v[66:67], v[66:67], v[106:107], v[46:47] op_sel_hi:[1,1,0]
    v_pk_mul_f32 v[74:75], v[74:75], v[106:107]
    v_pk_mul_f32 v[52:53], v[66:67], v[46:47] op_sel:[0,1] op_sel_hi:[1,1]
    v_exp_f32_e64 v52, v52 clamp
    v_exp_f32_e64 v53, v53 clamp
    v_max_f32_e32 v66, v46, v66
    v_max_f32_e32 v67, v46, v67
    v_pk_add_f32 v[66:67], v[66:67], v[52:53]
    v_cvt_pk_bf16_f32 v131, v74, v75
    v_cvt_pk_bf16_f32 v127, v66, v67
    s_nop 1
    v_mfma_f32_16x16x32_bf16 v[116:119], v[124:127], v[128:131], v[116:119]
    v_mfma_f32_16x16x32_bf16 v[120:123], v[124:127], v[48:51], v[120:123]
    v_xor_b32_e32 v1, 32, v31
    ds_read_b64_tr_b16 v[56:57], v31
    ds_read_b64_tr_b16 v[58:59], v1 offset:256
    ds_read_b64_tr_b16 v[60:61], v31 offset:512
    ds_read_b64_tr_b16 v[62:63], v1 offset:768
    s_nop 1
    v_cvt_pk_bf16_f32 v116, v116, v117
    v_cvt_pk_bf16_f32 v117, v118, v119
    buffer_store_dwordx2 v[116:117], v19, s[36:39], s23 offen sc1
    v_cvt_pk_bf16_f32 v120, v120, v121
    v_cvt_pk_bf16_f32 v121, v122, v123
    buffer_store_dwordx2 v[120:121], v32, s[36:39], s23 offen offset:512 sc1
    ds_read_b64_tr_b16 v[64:65], v21
    ds_read_b64_tr_b16 v[66:67], v21 offset:1024
    ds_read_b64_tr_b16 v[68:69], v27
    ds_read_b64_tr_b16 v[70:71], v27 offset:1024
    ds_read_b64_tr_b16 v[72:73], v21 offset:2048
    ds_read_b64_tr_b16 v[74:75], v21 offset:3072
    ds_read_b64_tr_b16 v[124:125], v27 offset:2048
    ds_read_b64_tr_b16 v[126:127], v27 offset:3072
    ds_read_b64_tr_b16 v[128:129], v21 offset:4096
    ds_read_b64_tr_b16 v[130:131], v21 offset:5120
    s_waitcnt lgkmcnt(8)
    v_mfma_f32_16x16x32_bf16 v[76:79], v[192:195], v[64:67], 0
    ds_read_b64_tr_b16 v[132:133], v27 offset:4096
    ds_read_b64_tr_b16 v[134:135], v27 offset:5120
    s_waitcnt lgkmcnt(8)
    v_mfma_f32_16x16x32_bf16 v[80:83], v[192:195], v[68:71], 0
    ds_read_b64_tr_b16 v[136:137], v21 offset:6144
    ds_read_b64_tr_b16 v[138:139], v21 offset:7168
    s_waitcnt lgkmcnt(8)
    v_mfma_f32_16x16x32_bf16 v[76:79], v[196:199], v[72:75], v[76:79]
    ds_read_b64_tr_b16 v[140:141], v27 offset:6144
    ds_read_b64_tr_b16 v[142:143], v27 offset:7168
    s_waitcnt lgkmcnt(8)
    v_mfma_f32_16x16x32_bf16 v[80:83], v[196:199], v[124:127], v[80:83]
    ds_read_b64_tr_b16 v[64:65], v26
    ds_read_b64_tr_b16 v[66:67], v26 offset:1024
    s_waitcnt lgkmcnt(8)
    v_mfma_f32_16x16x32_bf16 v[76:79], v[200:203], v[128:131], v[76:79]
    ds_read_b64_tr_b16 v[68:69], v28
    ds_read_b64_tr_b16 v[70:71], v28 offset:1024
    s_waitcnt lgkmcnt(8)
    v_mfma_f32_16x16x32_bf16 v[80:83], v[200:203], v[132:135], v[80:83]
    ds_read_b64_tr_b16 v[72:73], v26 offset:2048
    ds_read_b64_tr_b16 v[74:75], v26 offset:3072
    s_waitcnt lgkmcnt(8)
    v_mfma_f32_16x16x32_bf16 v[76:79], v[204:207], v[136:139], v[76:79]
    ds_read_b64_tr_b16 v[124:125], v28 offset:2048
    ds_read_b64_tr_b16 v[126:127], v28 offset:3072
    s_waitcnt lgkmcnt(8)
    v_mfma_f32_16x16x32_bf16 v[80:83], v[204:207], v[140:143], v[80:83]
    ds_read_b64_tr_b16 v[128:129], v26 offset:4096
    ds_read_b64_tr_b16 v[130:131], v26 offset:5120
    s_waitcnt lgkmcnt(8)
    v_mfma_f32_16x16x32_bf16 v[76:79], v[208:211], v[64:67], v[76:79]
    ds_read_b64_tr_b16 v[132:133], v28 offset:4096
    ds_read_b64_tr_b16 v[134:135], v28 offset:5120
    s_waitcnt lgkmcnt(8)
    v_mfma_f32_16x16x32_bf16 v[80:83], v[208:211], v[68:71], v[80:83]
    ds_read_b64_tr_b16 v[136:137], v26 offset:6144
    ds_read_b64_tr_b16 v[138:139], v26 offset:7168
    s_waitcnt lgkmcnt(8)
    v_mfma_f32_16x16x32_bf16 v[76:79], v[212:215], v[72:75], v[76:79]
    ds_read_b64_tr_b16 v[140:141], v28 offset:6144
    ds_read_b64_tr_b16 v[142:143], v28 offset:7168
    s_waitcnt lgkmcnt(8)
    v_mfma_f32_16x16x32_bf16 v[80:83], v[212:215], v[124:127], v[80:83]
    ds_read_b64_tr_b16 v[64:65], v21 offset:16384
    ds_read_b64_tr_b16 v[66:67], v21 offset:17408
    s_waitcnt lgkmcnt(8)
    v_mfma_f32_16x16x32_bf16 v[76:79], v[216:219], v[128:131], v[76:79]
    ds_read_b64_tr_b16 v[68:69], v27 offset:16384
    ds_read_b64_tr_b16 v[70:71], v27 offset:17408
    s_waitcnt lgkmcnt(8)
    v_mfma_f32_16x16x32_bf16 v[80:83], v[216:219], v[132:135], v[80:83]
    ds_read_b64_tr_b16 v[72:73], v21 offset:18432
    ds_read_b64_tr_b16 v[74:75], v21 offset:19456
    s_waitcnt lgkmcnt(8)
    v_mfma_f32_16x16x32_bf16 v[76:79], v[220:223], v[136:139], v[76:79]
    ds_read_b64_tr_b16 v[124:125], v27 offset:18432
    ds_read_b64_tr_b16 v[126:127], v27 offset:19456
    s_waitcnt lgkmcnt(8)
    v_mfma_f32_16x16x32_bf16 v[80:83], v[220:223], v[140:143], v[80:83]
    ds_read_b64_tr_b16 v[128:129], v21 offset:20480
    ds_read_b64_tr_b16 v[130:131], v21 offset:21504
    s_waitcnt lgkmcnt(8)
    v_mfma_f32_16x16x32_bf16 v[76:79], v[224:227], v[64:67], v[76:79]
    ds_read_b64_tr_b16 v[132:133], v27 offset:20480
    ds_read_b64_tr_b16 v[134:135], v27 offset:21504
    s_waitcnt lgkmcnt(8)
    v_mfma_f32_16x16x32_bf16 v[80:83], v[224:227], v[68:71], v[80:83]
    ds_read_b64_tr_b16 v[136:137], v21 offset:22528
    ds_read_b64_tr_b16 v[138:139], v21 offset:23552
    s_waitcnt lgkmcnt(8)
    v_mfma_f32_16x16x32_bf16 v[76:79], v[228:231], v[72:75], v[76:79]
    ds_read_b64_tr_b16 v[140:141], v27 offset:22528
    ds_read_b64_tr_b16 v[142:143], v27 offset:23552
    s_waitcnt lgkmcnt(8)
    v_mfma_f32_16x16x32_bf16 v[80:83], v[228:231], v[124:127], v[80:83]
    ds_read_b64_tr_b16 v[64:65], v26 offset:16384
    ds_read_b64_tr_b16 v[66:67], v26 offset:17408
    s_waitcnt lgkmcnt(8)
    v_mfma_f32_16x16x32_bf16 v[76:79], v[232:235], v[128:131], v[76:79]
    ds_read_b64_tr_b16 v[68:69], v28 offset:16384
    ds_read_b64_tr_b16 v[70:71], v28 offset:17408
    s_waitcnt lgkmcnt(8)
    v_mfma_f32_16x16x32_bf16 v[80:83], v[232:235], v[132:135], v[80:83]
    ds_read_b64_tr_b16 v[72:73], v26 offset:18432
    ds_read_b64_tr_b16 v[74:75], v26 offset:19456
    s_waitcnt lgkmcnt(8)
    v_mfma_f32_16x16x32_bf16 v[76:79], v[236:239], v[136:139], v[76:79]
    ds_read_b64_tr_b16 v[124:125], v28 offset:18432
    ds_read_b64_tr_b16 v[126:127], v28 offset:19456
    s_waitcnt lgkmcnt(8)
    v_mfma_f32_16x16x32_bf16 v[80:83], v[236:239], v[140:143], v[80:83]
    ds_read_b64_tr_b16 v[128:129], v26 offset:20480
    ds_read_b64_tr_b16 v[130:131], v26 offset:21504
    s_waitcnt lgkmcnt(8)
    v_mfma_f32_16x16x32_bf16 v[76:79], v[240:243], v[64:67], v[76:79]
    ds_read_b64_tr_b16 v[132:133], v28 offset:20480
    ds_read_b64_tr_b16 v[134:135], v28 offset:21504
    s_waitcnt lgkmcnt(8)
    v_mfma_f32_16x16x32_bf16 v[80:83], v[240:243], v[68:71], v[80:83]
    ds_read_b64_tr_b16 v[136:137], v26 offset:22528
    ds_read_b64_tr_b16 v[138:139], v26 offset:23552
    s_waitcnt lgkmcnt(8)
    v_mfma_f32_16x16x32_bf16 v[76:79], v[244:247], v[72:75], v[76:79]
    ds_read_b64_tr_b16 v[140:141], v28 offset:22528
    ds_read_b64_tr_b16 v[142:143], v28 offset:23552
    s_waitcnt lgkmcnt(8)
    v_mfma_f32_16x16x32_bf16 v[80:83], v[244:247], v[124:127], v[80:83]
    s_add_u32 s7, s35, 0x700000
    s_add_u32 s8, s35, 0x701400
    s_waitcnt lgkmcnt(6)
    v_mfma_f32_16x16x32_bf16 v[76:79], v[248:251], v[128:131], v[76:79]
    s_add_u32 s9, s35, 0x702800
    s_add_u32 s10, s35, 0x703c00
    s_waitcnt lgkmcnt(4)
    v_mfma_f32_16x16x32_bf16 v[80:83], v[248:251], v[132:135], v[80:83]
    s_add_u32 s11, s44, 0x8000
    s_waitcnt lgkmcnt(2)
    v_mfma_f32_16x16x32_bf16 v[76:79], v[252:255], v[136:139], v[76:79]
    s_waitcnt lgkmcnt(0)
    v_mfma_f32_16x16x32_bf16 v[80:83], v[252:255], v[140:143], v[80:83]
    s_nop 5
    v_pk_fma_f32 v[76:77], v[40:41], v[108:109], v[76:77] op_sel_hi:[1,0,1] neg_lo:[1,0,0] neg_hi:[1,0,0]
    v_pk_fma_f32 v[76:77], v[76:77], v[108:109], v[46:47] op_sel:[0,1,0] op_sel_hi:[1,1,0]
    v_pk_mul_f32 v[52:53], v[76:77], v[46:47] op_sel:[0,1] op_sel_hi:[1,1]
    v_exp_f32_e64 v52, v52 clamp
    v_exp_f32_e64 v53, v53 clamp
    v_max_f32_e32 v76, v46, v76
    v_max_f32_e32 v77, v46, v77
    v_pk_add_f32 v[76:77], v[76:77], v[52:53] neg_lo:[1,1] neg_hi:[1,1]
    v_cvt_pk_bf16_f32 v64, v76, v77
    v_pk_fma_f32 v[78:79], v[42:43], v[108:109], v[78:79] op_sel_hi:[1,0,1] neg_lo:[1,0,0] neg_hi:[1,0,0]
    v_pk_fma_f32 v[78:79], v[78:79], v[108:109], v[46:47] op_sel:[0,1,0] op_sel_hi:[1,1,0]
    v_pk_mul_f32 v[52:53], v[78:79], v[46:47] op_sel:[0,1] op_sel_hi:[1,1]
    v_exp_f32_e64 v52, v52 clamp
    v_exp_f32_e64 v53, v53 clamp
    v_max_f32_e32 v78, v46, v78
    v_max_f32_e32 v79, v46, v79
    v_pk_add_f32 v[78:79], v[78:79], v[52:53] neg_lo:[1,1] neg_hi:[1,1]
    v_cvt_pk_bf16_f32 v65, v78, v79
    v_pk_fma_f32 v[80:81], v[40:41], v[110:111], v[80:81] op_sel_hi:[1,0,1] neg_lo:[1,0,0] neg_hi:[1,0,0]
    v_pk_fma_f32 v[80:81], v[80:81], v[110:111], v[46:47] op_sel:[0,1,0] op_sel_hi:[1,1,0]
    v_pk_mul_f32 v[52:53], v[80:81], v[46:47] op_sel:[0,1] op_sel_hi:[1,1]
    v_exp_f32_e64 v52, v52 clamp
    v_exp_f32_e64 v53, v53 clamp
    v_max_f32_e32 v80, v46, v80
    v_max_f32_e32 v81, v46, v81
    v_pk_add_f32 v[80:81], v[80:81], v[52:53] neg_lo:[1,1] neg_hi:[1,1]
    v_cvt_pk_bf16_f32 v66, v80, v81
    v_pk_fma_f32 v[82:83], v[42:43], v[110:111], v[82:83] op_sel_hi:[1,0,1] neg_lo:[1,0,0] neg_hi:[1,0,0]
    v_pk_fma_f32 v[82:83], v[82:83], v[110:111], v[46:47] op_sel:[0,1,0] op_sel_hi:[1,1,0]
    v_pk_mul_f32 v[52:53], v[82:83], v[46:47] op_sel:[0,1] op_sel_hi:[1,1]
    v_exp_f32_e64 v52, v52 clamp
    v_exp_f32_e64 v53, v53 clamp
    v_max_f32_e32 v82, v46, v82
    v_max_f32_e32 v83, v46, v83
    v_pk_add_f32 v[82:83], v[82:83], v[52:53] neg_lo:[1,1] neg_hi:[1,1]
    v_cvt_pk_bf16_f32 v67, v82, v83
    s_cmp_lg_u32 s56, 3
    s_cbranch_scc1 nw_51
    s_waitcnt vmcnt(0)
    buffer_load_dwordx4 v[92:95], v33, s[36:39], s7 offen sc1
W3_5:
    s_cbranch_execz W3_ret
    buffer_load_dwordx4 v[96:99], v33, s[36:39], s8 offen sc1
    buffer_load_dwordx4 v[100:103], v33, s[36:39], s9 offen sc1
    buffer_load_dwordx4 v[104:107], v33, s[36:39], s10 offen sc1
    v_bfe_u32 v1, v0, 1, 2
    v_mov_b32_e32 v2, 0x3f80
    v_cndmask_b32_e64 v2, v2, 1.0, s[46:47]
    v_cmp_eq_u32_e32 vcc, 0, v1
    s_nop 1
    v_cndmask_b32_e32 v120, 0, v2, vcc
    v_cmp_eq_u32_e32 vcc, 1, v1
    s_nop 1
    v_cndmask_b32_e32 v121, 0, v2, vcc
    v_cmp_eq_u32_e32 vcc, 2, v1
    s_nop 1
    v_cndmask_b32_e32 v122, 0, v2, vcc
    v_cmp_eq_u32_e32 vcc, 3, v1
    s_nop 1
    v_cndmask_b32_e32 v123, 0, v2, vcc
    s_branch chk_53
retry_52:
    s_cmp_eq_u32 s63, 0
    s_cbranch_scc1 ok_54
    s_sub_u32 s63, s63, 1
    s_mov_b64 exec, vcc
    buffer_load_dwordx4 v[92:95], v33, s[36:39], s7 offen sc1
    buffer_load_dwordx4 v[96:99], v33, s[36:39], s8 offen sc1
    buffer_load_dwordx4 v[100:103], v33, s[36:39], s9 offen sc1
    buffer_load_dwordx4 v[104:107], v33, s[36:39], s10 offen sc1
    s_mov_b64 exec, -1
    s_waitcnt vmcnt(0)
chk_53:
    s_waitcnt vmcnt(3)
    v_max_u32_e32 v1, v92, v94
    s_waitcnt vmcnt(2)
    v_max3_u32 v1, v1, v96, v98
    s_waitcnt vmcnt(1)
    v_max3_u32 v1, v1, v100, v102
    s_waitcnt vmcnt(0)
    v_max3_u32 v1, v1, v104, v106
    v_cmp_eq_u32_e32 vcc, -1, v1
    s_cbranch_vccnz retry_52
ok_54:
    v_mfma_f32_16x16x32_bf16 v[116:119], v[120:123], v[92:95], 0
    v_mfma_f32_16x16x32_bf16 v[116:119], v[120:123], v[96:99], v[116:119]
    v_mfma_f32_16x16x32_bf16 v[116:119], v[120:123], v[100:103], v[116:119]
    v_mfma_f32_16x16x32_bf16 v[116:119], v[120:123], v[104:107], v[116:119]
    s_nop 7
    v_add_f32_dpp v92, v116, v116 row_ror:8 row_mask:0xf bank_mask:0xf
    v_add_f32_dpp v93, v117, v117 row_ror:8 row_mask:0xf bank_mask:0xf
    v_add_f32_dpp v94, v118, v118 row_ror:8 row_mask:0xf bank_mask:0xf
    v_add_f32_dpp v95, v119, v119 row_ror:8 row_mask:0xf bank_mask:0xf
    v_cvt_pk_bf16_f32 v92, v92, v93
    v_cvt_pk_bf16_f32 v93, v94, v95
    buffer_store_dwordx2 v[92:93], v34, s[36:39], s11 offen sc1
nw_51:
    buffer_store_dwordx2 v[64:65], v19, s[36:39], s34 offen sc1
    buffer_store_dwordx2 v[66:67], v19, s[36:39], s45 offen sc1
    ds_read_b64_tr_b16 v[64:65], v21 offset:32768
    ds_read_b64_tr_b16 v[66:67], v21 offset:33792
    ds_read_b64_tr_b16 v[68:69], v27 offset:32768
    ds_read_b64_tr_b16 v[70:71], v27 offset:33792
    ds_read_b64_tr_b16 v[72:73], v21 offset:34816
    ds_read_b64_tr_b16 v[74:75], v21 offset:35840
    ds_read_b64_tr_b16 v[92:93], v27 offset:34816
    ds_read_b64_tr_b16 v[94:95], v27 offset:35840
    ds_read_b64_tr_b16 v[96:97], v21 offset:36864
    ds_read_b64_tr_b16 v[98:99], v21 offset:37888
    s_waitcnt lgkmcnt(8)
    v_mfma_f32_16x16x32_bf16 v[84:87], v[192:195], v[64:67], 0
    ds_read_b64_tr_b16 v[100:101], v27 offset:36864
    ds_read_b64_tr_b16 v[102:103], v27 offset:37888
    s_waitcnt lgkmcnt(8)
    v_mfma_f32_16x16x32_bf16 v[88:91], v[192:195], v[68:71], 0
    ds_read_b64_tr_b16 v[104:105], v21 offset:38912
    ds_read_b64_tr_b16 v[106:107], v21 offset:39936
    s_waitcnt lgkmcnt(8)
    v_mfma_f32_16x16x32_bf16 v[84:87], v[196:199], v[72:75], v[84:87]
    ds_read_b64_tr_b16 v[116:117], v27 offset:38912
    ds_read_b64_tr_b16 v[118:119], v27 offset:39936
    s_waitcnt lgkmcnt(8)
    v_mfma_f32_16x16x32_bf16 v[88:91], v[196:199], v[92:95], v[88:91]
    ds_read_b64_tr_b16 v[64:65], v26 offset:32768
    ds_read_b64_tr_b16 v[66:67], v26 offset:33792
    s_waitcnt lgkmcnt(8)
    v_mfma_f32_16x16x32_bf16 v[84:87], v[200:203], v[96:99], v[84:87]
    ds_read_b64_tr_b16 v[68:69], v28 offset:32768
    ds_read_b64_tr_b16 v[70:71], v28 offset:33792
    s_waitcnt lgkmcnt(8)
    v_mfma_f32_16x16x32_bf16 v[88:91], v[200:203], v[100:103], v[88:91]
    ds_read_b64_tr_b16 v[72:73], v26 offset:34816
    ds_read_b64_tr_b16 v[74:75], v26 offset:35840
    s_waitcnt lgkmcnt(8)
    v_mfma_f32_16x16x32_bf16 v[84:87], v[204:207], v[104:107], v[84:87]
    ds_read_b64_tr_b16 v[92:93], v28 offset:34816
    ds_read_b64_tr_b16 v[94:95], v28 offset:35840
    s_waitcnt lgkmcnt(8)
    v_mfma_f32_16x16x32_bf16 v[88:91], v[204:207], v[116:119], v[88:91]
    ds_read_b64_tr_b16 v[96:97], v26 offset:36864
    ds_read_b64_tr_b16 v[98:99], v26 offset:37888
    s_waitcnt lgkmcnt(8)
    v_mfma_f32_16x16x32_bf16 v[84:87], v[208:211], v[64:67], v[84:87]
    ds_read_b64_tr_b16 v[100:101], v28 offset:36864
    ds_read_b64_tr_b16 v[102:103], v28 offset:37888
    s_waitcnt lgkmcnt(8)
    v_mfma_f32_16x16x32_bf16 v[88:91], v[208:211], v[68:71], v[88:91]
    ds_read_b64_tr_b16 v[104:105], v26 offset:38912
    ds_read_b64_tr_b16 v[106:107], v26 offset:39936
    s_waitcnt lgkmcnt(8)
    v_mfma_f32_16x16x32_bf16 v[84:87], v[212:215], v[72:75], v[84:87]
    ds_read_b64_tr_b16 v[116:117], v28 offset:38912
    ds_read_b64_tr_b16 v[118:119], v28 offset:39936
    s_waitcnt lgkmcnt(8)
    v_mfma_f32_16x16x32_bf16 v[88:91], v[212:215], v[92:95], v[88:91]
    ds_read_b64_tr_b16 v[64:65], v21 offset:49152
    ds_read_b64_tr_b16 v[66:67], v21 offset:50176
    s_waitcnt lgkmcnt(8)
    v_mfma_f32_16x16x32_bf16 v[84:87], v[216:219], v[96:99], v[84:87]
    ds_read_b64_tr_b16 v[68:69], v27 offset:49152
    ds_read_b64_tr_b16 v[70:71], v27 offset:50176
    s_waitcnt lgkmcnt(8)
    v_mfma_f32_16x16x32_bf16 v[88:91], v[216:219], v[100:103], v[88:91]
    ds_read_b64_tr_b16 v[72:73], v21 offset:51200
    ds_read_b64_tr_b16 v[74:75], v21 offset:52224
    s_waitcnt lgkmcnt(8)
    v_mfma_f32_16x16x32_bf16 v[84:87], v[220:223], v[104:107], v[84:87]
    ds_read_b64_tr_b16 v[92:93], v27 offset:51200
    ds_read_b64_tr_b16 v[94:95], v27 offset:52224
    s_waitcnt lgkmcnt(8)
    v_mfma_f32_16x16x32_bf16 v[88:91], v[220:223], v[116:119], v[88:91]
    ds_read_b64_tr_b16 v[96:97], v21 offset:53248
    ds_read_b64_tr_b16 v[98:99], v21 offset:54272
    s_waitcnt lgkmcnt(8)
    v_mfma_f32_16x16x32_bf16 v[84:87], v[224:227], v[64:67], v[84:87]
    ds_read_b64_tr_b16 v[100:101], v27 offset:53248
    ds_read_b64_tr_b16 v[102:103], v27 offset:54272
    s_waitcnt lgkmcnt(8)
    v_mfma_f32_16x16x32_bf16 v[88:91], v[224:227], v[68:71], v[88:91]
    ds_read_b64_tr_b16 v[104:105], v21 offset:55296
    ds_read_b64_tr_b16 v[106:107], v21 offset:56320
    s_waitcnt lgkmcnt(8)
    v_mfma_f32_16x16x32_bf16 v[84:87], v[228:231], v[72:75], v[84:87]
    ds_read_b64_tr_b16 v[116:117], v27 offset:55296
    ds_read_b64_tr_b16 v[118:119], v27 offset:56320
    s_waitcnt lgkmcnt(8)
    v_mfma_f32_16x16x32_bf16 v[88:91], v[228:231], v[92:95], v[88:91]
    ds_read_b64_tr_b16 v[64:65], v26 offset:49152
    ds_read_b64_tr_b16 v[66:67], v26 offset:50176
    s_waitcnt lgkmcnt(8)
    v_mfma_f32_16x16x32_bf16 v[84:87], v[232:235], v[96:99], v[84:87]
    ds_read_b64_tr_b16 v[68:69], v28 offset:49152
    ds_read_b64_tr_b16 v[70:71], v28 offset:50176
    s_waitcnt lgkmcnt(8)
    v_mfma_f32_16x16x32_bf16 v[88:91], v[232:235], v[100:103], v[88:91]
    ds_read_b64_tr_b16 v[72:73], v26 offset:51200
    ds_read_b64_tr_b16 v[74:75], v26 offset:52224
    s_waitcnt lgkmcnt(8)
    v_mfma_f32_16x16x32_bf16 v[84:87], v[236:239], v[104:107], v[84:87]
    ds_read_b64_tr_b16 v[92:93], v28 offset:51200
    ds_read_b64_tr_b16 v[94:95], v28 offset:52224
    s_waitcnt lgkmcnt(8)
    v_mfma_f32_16x16x32_bf16 v[88:91], v[236:239], v[116:119], v[88:91]
    ds_read_b64_tr_b16 v[96:97], v26 offset:53248
    ds_read_b64_tr_b16 v[98:99], v26 offset:54272
    s_waitcnt lgkmcnt(8)
    v_mfma_f32_16x16x32_bf16 v[84:87], v[240:243], v[64:67], v[84:87]
    ds_read_b64_tr_b16 v[100:101], v28 offset:53248
    ds_read_b64_tr_b16 v[102:103], v28 offset:54272
    s_waitcnt lgkmcnt(8)
    v_mfma_f32_16x16x32_bf16 v[88:91], v[240:243], v[68:71], v[88:91]
    ds_read_b64_tr_b16 v[104:105], v26 offset:55296
    ds_read_b64_tr_b16 v[106:107], v26 offset:56320
    s_waitcnt lgkmcnt(8)
    v_mfma_f32_16x16x32_bf16 v[84:87], v[244:247], v[72:75], v[84:87]
    ds_read_b64_tr_b16 v[116:117], v28 offset:55296
    ds_read_b64_tr_b16 v[118:119], v28 offset:56320
    s_waitcnt lgkmcnt(8)
    v_mfma_f32_16x16x32_bf16 v[88:91], v[244:247], v[92:95], v[88:91]
    s_waitcnt lgkmcnt(6)
    v_mfma_f32_16x16x32_bf16 v[84:87], v[248:251], v[96:99], v[84:87]
    s_waitcnt lgkmcnt(4)
    v_mfma_f32_16x16x32_bf16 v[88:91], v[248:251], v[100:103], v[88:91]
    s_waitcnt lgkmcnt(2)
    v_mfma_f32_16x16x32_bf16 v[84:87], v[252:255], v[104:107], v[84:87]
    s_waitcnt lgkmcnt(0)
    v_mfma_f32_16x16x32_bf16 v[88:91], v[252:255], v[116:119], v[88:91]
    s_nop 5
    v_pk_fma_f32 v[84:85], v[40:41], v[112:113], v[84:85] op_sel_hi:[1,0,1] neg_lo:[1,0,0] neg_hi:[1,0,0]
    v_pk_fma_f32 v[84:85], v[84:85], v[112:113], v[46:47] op_sel:[0,1,0] op_sel_hi:[1,1,0]
    v_pk_mul_f32 v[52:53], v[84:85], v[46:47] op_sel:[0,1] op_sel_hi:[1,1]
    v_exp_f32_e64 v52, v52 clamp
    v_exp_f32_e64 v53, v53 clamp
    v_max_f32_e32 v84, v46, v84
    v_max_f32_e32 v85, v46, v85
    v_pk_add_f32 v[84:85], v[84:85], v[52:53] neg_lo:[1,1] neg_hi:[1,1]
    v_cvt_pk_bf16_f32 v64, v84, v85
    v_pk_fma_f32 v[86:87], v[42:43], v[112:113], v[86:87] op_sel_hi:[1,0,1] neg_lo:[1,0,0] neg_hi:[1,0,0]
    v_pk_fma_f32 v[86:87], v[86:87], v[112:113], v[46:47] op_sel:[0,1,0] op_sel_hi:[1,1,0]
    v_pk_mul_f32 v[52:53], v[86:87], v[46:47] op_sel:[0,1] op_sel_hi:[1,1]
    v_exp_f32_e64 v52, v52 clamp
    v_exp_f32_e64 v53, v53 clamp
    v_max_f32_e32 v86, v46, v86
    v_max_f32_e32 v87, v46, v87
    v_pk_add_f32 v[86:87], v[86:87], v[52:53] neg_lo:[1,1] neg_hi:[1,1]
    v_cvt_pk_bf16_f32 v65, v86, v87
    v_pk_fma_f32 v[88:89], v[40:41], v[114:115], v[88:89] op_sel_hi:[1,0,1] neg_lo:[1,0,0] neg_hi:[1,0,0]
    v_pk_fma_f32 v[88:89], v[88:89], v[114:115], v[46:47] op_sel:[0,1,0] op_sel_hi:[1,1,0]
    v_pk_mul_f32 v[52:53], v[88:89], v[46:47] op_sel:[0,1] op_sel_hi:[1,1]
    v_exp_f32_e64 v52, v52 clamp
    v_exp_f32_e64 v53, v53 clamp
    v_max_f32_e32 v88, v46, v88
    v_max_f32_e32 v89, v46, v89
    v_pk_add_f32 v[88:89], v[88:89], v[52:53] neg_lo:[1,1] neg_hi:[1,1]
    v_cvt_pk_bf16_f32 v66, v88, v89
    v_pk_fma_f32 v[90:91], v[42:43], v[114:115], v[90:91] op_sel_hi:[1,0,1] neg_lo:[1,0,0] neg_hi:[1,0,0]
    v_pk_fma_f32 v[90:91], v[90:91], v[114:115], v[46:47] op_sel:[0,1,0] op_sel_hi:[1,1,0]
    v_pk_mul_f32 v[52:53], v[90:91], v[46:47] op_sel:[0,1] op_sel_hi:[1,1]
    v_exp_f32_e64 v52, v52 clamp
    v_exp_f32_e64 v53, v53 clamp
    v_max_f32_e32 v90, v46, v90
    v_max_f32_e32 v91, v46, v91
    v_pk_add_f32 v[90:91], v[90:91], v[52:53] neg_lo:[1,1] neg_hi:[1,1]
    v_cvt_pk_bf16_f32 v67, v90, v91
    buffer_store_dwordx2 v[64:65], v19, s[36:39], s77 offen sc1
    buffer_store_dwordx2 v[66:67], v19, s[36:39], s80 offen sc1
    v_lshlrev_b32_e32 v64, 16, v56
    v_and_b32_e32 v65, s5, v56
    v_lshlrev_b32_e32 v66, 16, v57
    v_and_b32_e32 v67, s5, v57
    v_lshlrev_b32_e32 v68, 16, v58
    v_and_b32_e32 v69, s5, v58
    v_lshlrev_b32_e32 v70, 16, v59
    v_and_b32_e32 v71, s5, v59
    v_lshlrev_b32_e32 v72, 16, v60
    v_and_b32_e32 v73, s5, v60
    v_lshlrev_b32_e32 v74, 16, v61
    v_and_b32_e32 v75, s5, v61
    v_lshlrev_b32_e32 v76, 16, v62
    v_and_b32_e32 v77, s5, v62
    v_lshlrev_b32_e32 v78, 16, v63
    v_and_b32_e32 v79, s5, v63
    s_lshl_b32 s68, s67, 10
    s_lshl3_add_u32 s68, s75, s68
    s_add_u32 s7, s68, 0x800000
    s_add_u32 s8, s68, 0x801000
    s_mul_i32 s68, s56, 5120
    s_add_u32 s9, s68, 0xaa8000
    s_add_u32 s10, s68, 0xaa8a00
    s_lshl3_add_u32 s68, s75, 0x20000
    v_add_u32_e32 v3, s68, v6
    s_barrier
    buffer_load_dwordx4 v[80:83], v35, s[36:39], s7 offen sc1
    buffer_load_dwordx4 v[84:87], v35, s[36:39], s7 offen offset:1024 sc1
    buffer_load_dwordx4 v[88:91], v35, s[36:39], s7 offen offset:2048 sc1
    buffer_load_dwordx4 v[96:99], v35, s[36:39], s8 offen sc1
    buffer_load_dwordx4 v[100:103], v35, s[36:39], s8 offen offset:1024 sc1
    buffer_load_dwordx4 v[104:107], v35, s[36:39], s8 offen offset:2048 sc1
    buffer_load_dwordx4 v[112:115], v36, s[36:39], s9 offen sc1
    buffer_load_dwordx4 v[116:119], v36, s[36:39], s9 offen offset:640 sc1
    buffer_load_dwordx4 v[120:123], v36, s[36:39], s9 offen offset:1280 sc1
    buffer_load_dwordx4 v[128:131], v36, s[36:39], s10 offen sc1
    buffer_load_dwordx4 v[132:135], v36, s[36:39], s10 offen offset:640 sc1
    buffer_load_dwordx4 v[136:139], v36, s[36:39], s10 offen offset:1280 sc1
    buffer_load_dwordx4 v[124:127], v36, s[36:39], s9 offen offset:1920 sc1
    buffer_load_dwordx4 v[140:143], v36, s[36:39], s10 offen offset:1920 sc1
    s_waitcnt vmcnt(14)
    s_barrier
    buffer_load_dwordx4 v[92:95], v35, s[36:39], s7 offen offset:3072 sc1
    buffer_load_dwordx4 v[108:111], v35, s[36:39], s8 offen offset:3072 sc1
    s_branch chk_56
retry_55:
    s_cmp_eq_u32 s63, 0
    s_cbranch_scc1 ok_57
    s_sub_u32 s63, s63, 1
    s_mov_b64 exec, vcc
    buffer_load_dwordx4 v[80:83], v35, s[36:39], s7 offen sc1
    buffer_load_dwordx4 v[84:87], v35, s[36:39], s7 offen offset:1024 sc1
    buffer_load_dwordx4 v[88:91], v35, s[36:39], s7 offen offset:2048 sc1
    buffer_load_dwordx4 v[96:99], v35, s[36:39], s8 offen sc1
    buffer_load_dwordx4 v[100:103], v35, s[36:39], s8 offen offset:1024 sc1
    buffer_load_dwordx4 v[104:107], v35, s[36:39], s8 offen offset:2048 sc1
    s_mov_b64 exec, -1
    s_waitcnt vmcnt(0)
chk_56:
    s_waitcnt vmcnt(15)
    v_and_b32_e32 v1, v80, v82
    s_waitcnt vmcnt(14)
    v_bitop3_b32 v1, v1, v84, v86 bitop3:0x80
    s_waitcnt vmcnt(13)
    v_bitop3_b32 v1, v1, v88, v90 bitop3:0x80
    s_waitcnt vmcnt(12)
    v_bitop3_b32 v1, v1, v96, v98 bitop3:0x80
    s_waitcnt vmcnt(11)
    v_bitop3_b32 v1, v1, v100, v102 bitop3:0x80
    s_waitcnt vmcnt(10)
    v_bitop3_b32 v1, v1, v104, v106 bitop3:0x80
    v_cmp_le_i32_e32 vcc, 0, v1
    s_cbranch_vccnz retry_55
ok_57:
    s_waitcnt vmcnt(9)
    v_max_u32_e32 v1, v112, v114
    s_waitcnt vmcnt(8)
    v_max3_u32 v1, v1, v116, v118
    s_waitcnt vmcnt(7)
    v_max3_u32 v1, v1, v120, v122
    s_waitcnt vmcnt(6)
    v_max3_u32 v1, v1, v128, v130
    s_waitcnt vmcnt(5)
    v_max3_u32 v1, v1, v132, v134
    s_waitcnt vmcnt(4)
    v_max3_u32 v1, v1, v136, v138
    s_waitcnt vmcnt(3)
    v_max3_u32 v1, v1, v124, v126
    s_waitcnt vmcnt(2)
    v_max3_u32 v1, v1, v140, v142
    v_cmp_eq_u32_e32 vcc, -1, v1
    s_cbranch_vccnz retry_58
ok_59:
    v_mfma_f32_32x32x16_bf16 v[48:63], v[112:115], v[80:83], 0
    v_mfma_f32_32x32x16_bf16 v[144:159], v[116:119], v[84:87], 0
    v_mfma_f32_32x32x16_bf16 v[160:175], v[120:123], v[88:91], 0
    s_nop 9
    v_add_f32_e32 v46, 0xb58637bd, v56
    v_rcp_f32_e32 v46, v46
    s_nop 0
    v_pk_mul_f32 v[48:49], v[48:49], v[46:47] op_sel_hi:[1,0]
    v_pk_mul_f32 v[50:51], v[50:51], v[46:47] op_sel_hi:[1,0]
    v_pk_mul_f32 v[52:53], v[52:53], v[46:47] op_sel_hi:[1,0]
    v_pk_mul_f32 v[54:55], v[54:55], v[46:47] op_sel_hi:[1,0]
    v_cvt_pk_bf16_f32 v80, v48, v49
    v_cvt_pk_bf16_f32 v81, v50, v51
    v_cvt_pk_bf16_f32 v82, v52, v53
    v_cvt_pk_bf16_f32 v83, v54, v55
    v_mfma_f32_32x32x16_bf16 v[48:63], v[128:131], v[96:99], 0
    v_add_f32_e32 v46, 0xb58637bd, v152
    v_rcp_f32_e64 v46, v46
    ds_write_b128 v3, v[80:83]
    v_pk_mul_f32 v[144:145], v[144:145], v[46:47] op_sel_hi:[1,0]
    v_pk_mul_f32 v[146:147], v[146:147], v[46:47] op_sel_hi:[1,0]
    v_pk_mul_f32 v[148:149], v[148:149], v[46:47] op_sel_hi:[1,0]
    v_pk_mul_f32 v[150:151], v[150:151], v[46:47] op_sel_hi:[1,0]
    v_cvt_pk_bf16_f32 v84, v144, v145
    v_cvt_pk_bf16_f32 v85, v146, v147
    v_cvt_pk_bf16_f32 v86, v148, v149
    v_cvt_pk_bf16_f32 v87, v150, v151
    v_mfma_f32_32x32x16_bf16 v[144:159], v[132:135], v[100:103], 0
    v_add_f32_e32 v46, 0xb58637bd, v168
    v_rcp_f32_e64 v46, v46
    ds_write_b128 v3, v[84:87] offset:1024
    v_pk_mul_f32 v[160:161], v[160:161], v[46:47] op_sel_hi:[1,0]
    v_pk_mul_f32 v[162:163], v[162:163], v[46:47] op_sel_hi:[1,0]
    v_pk_mul_f32 v[164:165], v[164:165], v[46:47] op_sel_hi:[1,0]
    v_pk_mul_f32 v[166:167], v[166:167], v[46:47] op_sel_hi:[1,0]
    v_cvt_pk_bf16_f32 v88, v160, v161
    v_cvt_pk_bf16_f32 v89, v162, v163
    v_cvt_pk_bf16_f32 v90, v164, v165
    v_cvt_pk_bf16_f32 v91, v166, v167
    v_mfma_f32_32x32x16_bf16 v[160:175], v[136:139], v[104:107], 0
    v_add_f32_e32 v46, 0xb58637bd, v56
    v_rcp_f32_e64 v46, v46
    ds_write_b128 v3, v[88:91] offset:2048
    v_pk_mul_f32 v[48:49], v[48:49], v[46:47] op_sel_hi:[1,0]
    v_pk_mul_f32 v[50:51], v[50:51], v[46:47] op_sel_hi:[1,0]
    v_pk_mul_f32 v[52:53], v[52:53], v[46:47] op_sel_hi:[1,0]
    v_pk_mul_f32 v[54:55], v[54:55], v[46:47] op_sel_hi:[1,0]
    v_cvt_pk_bf16_f32 v96, v48, v49
    v_cvt_pk_bf16_f32 v97, v50, v51
    v_cvt_pk_bf16_f32 v98, v52, v53
    v_cvt_pk_bf16_f32 v99, v54, v55
    s_waitcnt vmcnt(1)
    v_and_b32_e32 v1, v92, v94
    s_waitcnt vmcnt(0)
    v_bitop3_b32 v1, v1, v108, v110 bitop3:0x80
    v_cmp_le_i32_e32 vcc, 0, v1
    s_cbranch_vccnz retry_60
ok_61:
    v_mfma_f32_32x32x16_bf16 v[48:63], v[124:127], v[92:95], 0
    v_add_f32_e32 v46, 0xb58637bd, v152
    v_rcp_f32_e32 v46, v46
    ds_write_b128 v3, v[96:99] offset:4096
    v_pk_mul_f32 v[144:145], v[144:145], v[46:47] op_sel_hi:[1,0]
    v_pk_mul_f32 v[146:147], v[146:147], v[46:47] op_sel_hi:[1,0]
    v_pk_mul_f32 v[148:149], v[148:149], v[46:47] op_sel_hi:[1,0]
    v_pk_mul_f32 v[150:151], v[150:151], v[46:47] op_sel_hi:[1,0]
    v_cvt_pk_bf16_f32 v100, v144, v145
    v_cvt_pk_bf16_f32 v101, v146, v147
    v_cvt_pk_bf16_f32 v102, v148, v149
    v_cvt_pk_bf16_f32 v103, v150, v151
    v_mfma_f32_32x32x16_bf16 v[144:159], v[140:143], v[108:111], 0
    v_add_f32_e32 v46, 0xb58637bd, v168
    v_rcp_f32_e64 v46, v46
    ds_write_b128 v3, v[100:103] offset:5120
    v_pk_mul_f32 v[160:161], v[160:161], v[46:47] op_sel_hi:[1,0]
    v_pk_mul_f32 v[162:163], v[162:163], v[46:47] op_sel_hi:[1,0]
    v_pk_mul_f32 v[164:165], v[164:165], v[46:47] op_sel_hi:[1,0]
    v_pk_mul_f32 v[166:167], v[166:167], v[46:47] op_sel_hi:[1,0]
    v_cvt_pk_bf16_f32 v104, v160, v161
    v_cvt_pk_bf16_f32 v105, v162, v163
    v_cvt_pk_bf16_f32 v106, v164, v165
    v_cvt_pk_bf16_f32 v107, v166, v167
    v_add_f32_e32 v46, 0xb58637bd, v56
    v_rcp_f32_e64 v46, v46
    ds_write_b128 v3, v[104:107] offset:6144
    v_pk_mul_f32 v[48:49], v[48:49], v[46:47] op_sel_hi:[1,0]
    v_pk_mul_f32 v[50:51], v[50:51], v[46:47] op_sel_hi:[1,0]
    v_pk_mul_f32 v[52:53], v[52:53], v[46:47] op_sel_hi:[1,0]
    v_pk_mul_f32 v[54:55], v[54:55], v[46:47] op_sel_hi:[1,0]
    v_cvt_pk_bf16_f32 v92, v48, v49
    v_cvt_pk_bf16_f32 v93, v50, v51
    v_cvt_pk_bf16_f32 v94, v52, v53
    v_cvt_pk_bf16_f32 v95, v54, v55
    v_add_f32_e32 v46, 0xb58637bd, v152
    v_rcp_f32_e64 v46, v46
    ds_write_b128 v3, v[92:95] offset:3072
    v_pk_mul_f32 v[144:145], v[144:145], v[46:47] op_sel_hi:[1,0]
    v_pk_mul_f32 v[146:147], v[146:147], v[46:47] op_sel_hi:[1,0]
    v_pk_mul_f32 v[148:149], v[148:149], v[46:47] op_sel_hi:[1,0]
    v_pk_mul_f32 v[150:151], v[150:151], v[46:47] op_sel_hi:[1,0]
    v_cvt_pk_bf16_f32 v108, v144, v145
    v_cvt_pk_bf16_f32 v109, v146, v147
    v_cvt_pk_bf16_f32 v110, v148, v149
    v_cvt_pk_bf16_f32 v111, v150, v151
    ds_write_b128 v3, v[108:111] offset:7168
    v_mfma_f32_32x32x16_bf16 v[64:79], a[128:131], v[80:83], v[64:79]
    v_xor_b32_e32 v1, 0x2000, v3
    v_mfma_f32_32x32x16_bf16 v[64:79], a[132:135], v[84:87], v[64:79]
    v_xor_b32_e32 v2, 0x4000, v3
    v_mfma_f32_32x32x16_bf16 v[64:79], a[136:139], v[88:91], v[64:79]
    v_xor_b32_e32 v4, 0x6000, v3
    v_mfma_f32_32x32x16_bf16 v[64:79], a[140:143], v[92:95], v[64:79]
    v_mfma_f32_32x32x16_bf16 v[64:79], a[144:147], v[96:99], v[64:79]
    s_waitcnt lgkmcnt(0)
    s_barrier
    ds_read_b128 v[56:59], v1
    ds_read_b128 v[60:63], v1 offset:1024
    v_mfma_f32_32x32x16_bf16 v[64:79], a[148:151], v[100:103], v[64:79]
    ds_read_b128 v[112:115], v1 offset:2048
    ds_read_b128 v[116:119], v1 offset:3072
    v_mfma_f32_32x32x16_bf16 v[64:79], a[152:155], v[104:107], v[64:79]
    ds_read_b128 v[48:51], v1 offset:4096
    v_mfma_f32_32x32x16_bf16 v[64:79], a[156:159], v[108:111], v[64:79]
    ds_read_b128 v[52:55], v1 offset:5120
    s_waitcnt lgkmcnt(4)
    v_mfma_f32_32x32x16_bf16 v[64:79], a[160:163], v[56:59], v[64:79]
    ds_read_b128 v[56:59], v1 offset:6144
    v_mfma_f32_32x32x16_bf16 v[64:79], a[164:167], v[60:63], v[64:79]
    ds_read_b128 v[60:63], v1 offset:7168
    s_waitcnt lgkmcnt(3)
    v_mfma_f32_32x32x16_bf16 v[64:79], a[168:171], v[112:115], v[64:79]
    ds_read_b128 v[112:115], v2
    s_add_u32 s70, s64, 0x4000
    v_mfma_f32_32x32x16_bf16 v[64:79], a[172:175], v[116:119], v[64:79]
    ds_read_b128 v[116:119], v2 offset:1024
    v_mfma_f32_32x32x16_bf16 v[64:79], a[176:179], v[48:51], v[64:79]
    ds_read_b128 v[48:51], v2 offset:2048
    s_waitcnt lgkmcnt(3)
    v_mfma_f32_32x32x16_bf16 v[64:79], a[180:183], v[52:55], v[64:79]
    ds_read_b128 v[52:55], v2 offset:3072
    v_mfma_f32_32x32x16_bf16 v[64:79], a[184:187], v[56:59], v[64:79]
    ds_read_b128 v[56:59], v2 offset:4096
    v_mfma_f32_32x32x16_bf16 v[64:79], a[188:191], v[60:63], v[64:79]
    ds_read_b128 v[60:63], v2 offset:5120
    s_waitcnt lgkmcnt(3)
    v_mfma_f32_32x32x16_bf16 v[64:79], a[192:195], v[112:115], v[64:79]
    ds_read_b128 v[112:115], v2 offset:6144
    v_mfma_f32_32x32x16_bf16 v[64:79], a[196:199], v[116:119], v[64:79]
    ds_read_b128 v[116:119], v2 offset:7168
    v_mfma_f32_32x32x16_bf16 v[64:79], a[200:203], v[48:51], v[64:79]
    ds_read_b128 v[48:51], v4
    s_waitcnt lgkmcnt(3)
    v_mfma_f32_32x32x16_bf16 v[64:79], a[204:207], v[52:55], v[64:79]
    ds_read_b128 v[52:55], v4 offset:1024
    v_mfma_f32_32x32x16_bf16 v[64:79], a[208:211], v[56:59], v[64:79]
    ds_read_b128 v[56:59], v4 offset:2048
    v_mfma_f32_32x32x16_bf16 v[64:79], a[212:215], v[60:63], v[64:79]
    ds_read_b128 v[60:63], v4 offset:3072
    s_waitcnt lgkmcnt(3)
    v_mfma_f32_32x32x16_bf16 v[64:79], a[216:219], v[112:115], v[64:79]
    ds_read_b128 v[112:115], v4 offset:4096
    v_mfma_f32_32x32x16_bf16 v[64:79], a[220:223], v[116:119], v[64:79]
    ds_read_b128 v[116:119], v4 offset:5120
    v_mfma_f32_32x32x16_bf16 v[64:79], a[224:227], v[48:51], v[64:79]
    ds_read_b128 v[48:51], v4 offset:6144
    s_waitcnt lgkmcnt(3)
    v_mfma_f32_32x32x16_bf16 v[64:79], a[228:231], v[52:55], v[64:79]
    ds_read_b128 v[52:55], v4 offset:7168
    v_mfma_f32_32x32x16_bf16 v[64:79], a[232:235], v[56:59], v[64:79]
    v_mfma_f32_32x32x16_bf16 v[64:79], a[236:239], v[60:63], v[64:79]
    s_waitcnt lgkmcnt(1)
    v_mfma_f32_32x32x16_bf16 v[64:79], a[240:243], v[112:115], v[64:79]
    v_mfma_f32_32x32x16_bf16 v[64:79], a[244:247], v[116:119], v[64:79]
    v_mfma_f32_32x32x16_bf16 v[64:79], a[248:251], v[48:51], v[64:79]
    s_waitcnt lgkmcnt(0)
    v_mfma_f32_32x32x16_bf16 v[64:79], a[252:255], v[52:55], v[64:79]
    s_nop 11
    v_cvt_pk_bf16_f32 v48, v64, v65
    v_cvt_pk_bf16_f32 v49, v66, v67
    v_cvt_pk_bf16_f32 v50, v68, v69
    v_cvt_pk_bf16_f32 v51, v70, v71
    v_cvt_pk_bf16_f32 v52, v72, v73
    v_cvt_pk_bf16_f32 v53, v74, v75
    v_cvt_pk_bf16_f32 v54, v76, v77
    v_cvt_pk_bf16_f32 v55, v78, v79
    v_permlane16_swap_b32 v48, v52
    v_permlane16_swap_b32 v49, v53
    v_permlane16_swap_b32 v50, v54
    v_permlane16_swap_b32 v51, v55
    buffer_store_dwordx4 v[48:51], v5, s[40:43], s64 offen sc1
    buffer_store_dwordx4 v[52:55], v5, s[40:43], s70 offen sc1
L_end:
    s_endpgm
retry_9:
    s_cmp_eq_u32 s63, 0
    s_cbranch_scc1 ok_10
    s_sub_u32 s63, s63, 1
    s_mov_b64 exec, vcc
    buffer_load_dword v1, v2, s[36:39], s69 offen sc1
    s_mov_b64 exec, -1
    s_waitcnt vmcnt(0)
    v_cmp_ne_u32_e32 vcc, s61, v1
    s_waitcnt lgkmcnt(0)
    s_cbranch_vccnz retry_9
    s_branch ok_10
retry_11:
    s_cmp_eq_u32 s63, 0
    s_cbranch_scc1 ok_12
    s_sub_u32 s63, s63, 1
    s_mov_b64 exec, vcc
    buffer_load_dword v1, v2, s[36:39], s69 offen sc1
    s_mov_b64 exec, -1
    s_waitcnt vmcnt(0)
    v_cmp_ne_u32_e32 vcc, s61, v1
    s_waitcnt lgkmcnt(0)
    s_cbranch_vccnz retry_11
    s_branch ok_12
retry_13:
    s_cmp_eq_u32 s63, 0
    s_cbranch_scc1 ok_14
    s_sub_u32 s63, s63, 1
    s_mov_b64 exec, vcc
    s_add_u32 m0, s90, 0x0
    s_nop 0
    buffer_load_dwordx4 v29, s[36:39], s82 offen sc1 lds
    buffer_load_dwordx4 v29, s[36:39], s82 offen offset:1024 sc1 lds
    s_add_u32 m0, s90, 0x2000
    s_nop 0
    buffer_load_dwordx4 v29, s[36:39], s83 offen sc1 lds
    buffer_load_dwordx4 v29, s[36:39], s83 offen offset:1024 sc1 lds
    s_add_u32 m0, s90, 0x4000
    s_nop 0
    buffer_load_dwordx4 v29, s[36:39], s84 offen sc1 lds
    buffer_load_dwordx4 v29, s[36:39], s84 offen offset:1024 sc1 lds
    s_add_u32 m0, s90, 0x6000
    s_nop 0
    buffer_load_dwordx4 v29, s[36:39], s85 offen sc1 lds
    buffer_load_dwordx4 v29, s[36:39], s85 offen offset:1024 sc1 lds
    s_mov_b64 exec, -1
    s_waitcnt vmcnt(0)
    ds_read_b128 v[68:71], v30
    ds_read_b128 v[72:75], v30 offset:1024
    ds_read_b128 v[76:79], v30 offset:8192
    ds_read_b128 v[80:83], v30 offset:9216
    ds_read_b128 v[84:87], v30 offset:16384
    ds_read_b128 v[88:91], v30 offset:17408
    ds_read_b128 v[92:95], v30 offset:24576
    ds_read_b128 v[96:99], v30 offset:25600
    s_waitcnt lgkmcnt(7)
    v_max_u32_e32 v4, v68, v70
    s_waitcnt lgkmcnt(6)
    v_max3_u32 v4, v4, v72, v74
    s_waitcnt lgkmcnt(5)
    v_max3_u32 v4, v4, v76, v78
    s_waitcnt lgkmcnt(4)
    v_max3_u32 v4, v4, v80, v82
    s_waitcnt lgkmcnt(3)
    v_max3_u32 v4, v4, v84, v86
    s_waitcnt lgkmcnt(2)
    v_max3_u32 v4, v4, v88, v90
    s_waitcnt lgkmcnt(1)
    v_max3_u32 v4, v4, v92, v94
    s_waitcnt lgkmcnt(0)
    v_max3_u32 v4, v4, v96, v98
    v_cmp_eq_u32_e32 vcc, -1, v4
    s_cbranch_vccnz retry_13
    s_branch ok_14
redo_17:
    s_cmp_lg_u32 s81, 0
    s_cbranch_scc1 back_18
    s_mov_b32 s81, 1
    s_waitcnt vmcnt(0) lgkmcnt(0)
    s_nop 15
again_19:
    ds_read_b128 v[140:143], v30 offset:32768
    ds_read_b128 v[144:147], v30 offset:33792
    ds_read_b128 v[148:151], v30 offset:40960
    ds_read_b128 v[152:155], v30 offset:41984
    ds_read_b128 v[156:159], v30 offset:49152
    ds_read_b128 v[160:163], v30 offset:50176
    ds_read_b128 v[164:167], v30 offset:57344
    ds_read_b128 v[168:171], v30 offset:58368
    s_waitcnt lgkmcnt(7)
    v_max_u32_e32 v4, v140, v142
    s_waitcnt lgkmcnt(6)
    v_max3_u32 v4, v4, v144, v146
    s_waitcnt lgkmcnt(5)
    v_max3_u32 v4, v4, v148, v150
    s_waitcnt lgkmcnt(4)
    v_max3_u32 v4, v4, v152, v154
    s_waitcnt lgkmcnt(3)
    v_max3_u32 v4, v4, v156, v158
    s_waitcnt lgkmcnt(2)
    v_max3_u32 v4, v4, v160, v162
    s_waitcnt lgkmcnt(1)
    v_max3_u32 v4, v4, v164, v166
    s_waitcnt lgkmcnt(0)
    v_max3_u32 v4, v4, v168, v170
    v_cmp_eq_u32_e32 vcc, -1, v4
    s_cbranch_vccz good_20
    s_cmp_eq_u32 s63, 0
    s_cbranch_scc1 good_20
    s_sub_u32 s63, s63, 1
    s_mov_b64 exec, vcc
    s_add_u32 m0, s90, 0x8000
    s_nop 0
    buffer_load_dwordx4 v29, s[36:39], s86 offen sc1 lds
    buffer_load_dwordx4 v29, s[36:39], s86 offen offset:1024 sc1 lds
    s_add_u32 m0, s90, 0xa000
    s_nop 0
    buffer_load_dwordx4 v29, s[36:39], s87 offen sc1 lds
    buffer_load_dwordx4 v29, s[36:39], s87 offen offset:1024 sc1 lds
    s_add_u32 m0, s90, 0xc000
    s_nop 0
    buffer_load_dwordx4 v29, s[36:39], s88 offen sc1 lds
    buffer_load_dwordx4 v29, s[36:39], s88 offen offset:1024 sc1 lds
    s_add_u32 m0, s90, 0xe000
    s_nop 0
    buffer_load_dwordx4 v29, s[36:39], s89 offen sc1 lds
    buffer_load_dwordx4 v29, s[36:39], s89 offen offset:1024 sc1 lds
    s_mov_b64 exec, -1
    s_waitcnt vmcnt(0)
    s_branch again_19
good_20:
    s_barrier
    s_branch pass_16
retry_28:
    s_cmp_eq_u32 s63, 0
    s_cbranch_scc1 ok_29
    s_sub_u32 s63, s63, 1
    s_mov_b64 exec, vcc
    buffer_load_dwordx4 v[116:119], v36, s[36:39], s26 offen sc1
    buffer_load_dwordx4 v[120:123], v36, s[36:39], s26 offen offset:640 sc1
    buffer_load_dwordx4 v[124:127], v36, s[36:39], s26 offen offset:1280 sc1
    buffer_load_dwordx4 v[128:131], v36, s[36:39], s26 offen offset:1920 sc1
    buffer_load_dwordx4 v[132:135], v36, s[36:39], s27 offen sc1
    buffer_load_dwordx4 v[136:139], v36, s[36:39], s27 offen offset:640 sc1
    buffer_load_dwordx4 v[140:143], v36, s[36:39], s27 offen offset:1280 sc1
    buffer_load_dwordx4 v[144:147], v36, s[36:39], s27 offen offset:1920 sc1
    s_mov_b64 exec, -1
    s_waitcnt vmcnt(0)
    v_max_u32_e32 v1, v116, v118
    v_max3_u32 v1, v1, v120, v122
    v_max3_u32 v1, v1, v124, v126
    v_max3_u32 v1, v1, v132, v134
    v_max3_u32 v1, v1, v136, v138
    v_max3_u32 v1, v1, v140, v142
    v_max3_u32 v1, v1, v128, v130
    v_max3_u32 v1, v1, v144, v146
    v_cmp_eq_u32_e32 vcc, -1, v1
    s_cbranch_vccnz retry_28
    s_branch ok_29
retry_30:
    s_cmp_eq_u32 s63, 0
    s_cbranch_scc1 ok_31
    s_sub_u32 s63, s63, 1
    s_mov_b64 exec, vcc
    buffer_load_dwordx4 v[96:99], v35, s[36:39], s24 offen offset:3072 sc1
    buffer_load_dwordx4 v[112:115], v35, s[36:39], s25 offen offset:3072 sc1
    s_mov_b64 exec, -1
    s_waitcnt vmcnt(0)
    v_or_b32_e32 v1, v96, v98
    v_or3_b32 v1, v1, v112, v114
    v_cmp_gt_i32_e32 vcc, 0, v1
    s_waitcnt lgkmcnt(0)
    s_cbranch_vccnz retry_30
    s_branch ok_31
retry_35:
    s_cmp_eq_u32 s63, 0
    s_cbranch_scc1 ok_36
    s_sub_u32 s63, s63, 1
    s_mov_b64 exec, vcc
    buffer_load_dwordx4 v[120:123], v13, s[36:39], s15 offen sc1
    buffer_load_dwordx4 v[124:127], v13, s[36:39], s16 offen sc1
    buffer_load_dwordx4 v[128:131], v13, s[36:39], s17 offen sc1
    buffer_load_dwordx4 v[132:135], v13, s[36:39], s18 offen sc1
    buffer_load_dwordx4 v[152:155], v13, s[36:39], s19 offen sc1
    s_mov_b64 exec, -1
    s_waitcnt vmcnt(0)
    v_mfma_f32_16x16x32_bf16 v[160:163], v[112:115], v[120:123], 0
    v_max_u32_e64 v1, v120, v121
    v_max3_u32 v1, v1, v122, v123
    v_mfma_f32_16x16x32_bf16 v[160:163], v[112:115], v[124:127], v[160:163]
    v_max3_u32 v1, v1, v124, v125
    v_max3_u32 v1, v1, v126, v127
    v_mfma_f32_16x16x32_bf16 v[160:163], v[112:115], v[128:131], v[160:163]
    v_max3_u32 v1, v1, v128, v129
    v_max3_u32 v1, v1, v130, v131
    v_mfma_f32_16x16x32_bf16 v[160:163], v[112:115], v[132:135], v[160:163]
    v_max3_u32 v1, v1, v132, v133
    v_max3_u32 v1, v1, v134, v135
    v_max3_u32 v1, v1, v152, v153
    v_max3_u32 v1, v1, v154, v155
    v_cmp_eq_u32_e32 vcc, -1, v1
    s_cbranch_vccnz retry_35
    s_branch ok_36
retry_37:
    s_cmp_eq_u32 s63, 0
    s_cbranch_scc1 ok_38
    s_sub_u32 s63, s63, 1
    s_mov_b64 exec, vcc
    buffer_load_dwordx4 v[136:139], v13, s[36:39], s20 offen sc1
    buffer_load_dwordx4 v[140:143], v13, s[36:39], s21 offen sc1
    buffer_load_dwordx4 v[144:147], v13, s[36:39], s22 offen sc1
    buffer_load_dwordx4 v[148:151], v13, s[36:39], s24 offen sc1
    buffer_load_dwordx4 v[156:159], v13, s[36:39], s25 offen sc1
    s_mov_b64 exec, -1
    s_waitcnt vmcnt(0)
    v_max_u32_e32 v1, v136, v137
    v_max3_u32 v1, v1, v138, v139
    v_max3_u32 v1, v1, v140, v141
    v_max3_u32 v1, v1, v142, v143
    v_max3_u32 v1, v1, v144, v145
    v_max3_u32 v1, v1, v146, v147
    v_max3_u32 v1, v1, v148, v149
    v_max3_u32 v1, v1, v150, v151
    v_max3_u32 v1, v1, v156, v157
    v_max3_u32 v1, v1, v158, v159
    v_cmp_eq_u32_e32 vcc, -1, v1
    s_cbranch_vccnz retry_37
    s_branch ok_38
retry_39:
    s_cmp_eq_u32 s63, 0
    s_cbranch_scc1 ok_40
    s_sub_u32 s63, s63, 1
    s_mov_b64 exec, vcc
    buffer_load_dwordx4 v[120:123], v13, s[36:39], s15 offen sc1
    buffer_load_dwordx4 v[124:127], v13, s[36:39], s16 offen sc1
    buffer_load_dwordx4 v[128:131], v13, s[36:39], s17 offen sc1
    buffer_load_dwordx4 v[132:135], v13, s[36:39], s18 offen sc1
    buffer_load_dwordx4 v[152:155], v13, s[36:39], s19 offen sc1
    s_mov_b64 exec, -1
    s_waitcnt vmcnt(0)
    v_mfma_f32_16x16x32_bf16 v[160:163], v[112:115], v[120:123], 0
    v_max_u32_e32 v1, v120, v121
    v_max3_u32 v1, v1, v122, v123
    v_mfma_f32_16x16x32_bf16 v[160:163], v[112:115], v[124:127], v[160:163]
    v_max3_u32 v1, v1, v124, v125
    v_max3_u32 v1, v1, v126, v127
    v_mfma_f32_16x16x32_bf16 v[160:163], v[112:115], v[128:131], v[160:163]
    v_max3_u32 v1, v1, v128, v129
    v_max3_u32 v1, v1, v130, v131
    v_mfma_f32_16x16x32_bf16 v[160:163], v[112:115], v[132:135], v[160:163]
    v_max3_u32 v1, v1, v132, v133
    v_max3_u32 v1, v1, v134, v135
    v_max3_u32 v1, v1, v152, v153
    v_max3_u32 v1, v1, v154, v155
    v_cmp_eq_u32_e32 vcc, -1, v1
    s_cbranch_vccnz retry_39
    s_branch ok_40
retry_41:
    s_cmp_eq_u32 s63, 0
    s_cbranch_scc1 ok_42
    s_sub_u32 s63, s63, 1
    s_mov_b64 exec, vcc
    buffer_load_dwordx4 v[136:139], v13, s[36:39], s20 offen sc1
    buffer_load_dwordx4 v[140:143], v13, s[36:39], s21 offen sc1
    buffer_load_dwordx4 v[144:147], v13, s[36:39], s22 offen sc1
    buffer_load_dwordx4 v[148:151], v13, s[36:39], s24 offen sc1
    buffer_load_dwordx4 v[156:159], v13, s[36:39], s25 offen sc1
    s_mov_b64 exec, -1
    s_waitcnt vmcnt(0)
    v_max_u32_e32 v1, v136, v137
    v_max3_u32 v1, v1, v138, v139
    v_max3_u32 v1, v1, v140, v141
    v_max3_u32 v1, v1, v142, v143
    v_max3_u32 v1, v1, v144, v145
    v_max3_u32 v1, v1, v146, v147
    v_max3_u32 v1, v1, v148, v149
    v_max3_u32 v1, v1, v150, v151
    v_max3_u32 v1, v1, v156, v157
    v_max3_u32 v1, v1, v158, v159
    v_cmp_eq_u32_e32 vcc, -1, v1
    s_cbranch_vccnz retry_41
    s_branch ok_42
retry_43:
    s_cmp_eq_u32 s63, 0
    s_cbranch_scc1 ok_44
    s_sub_u32 s63, s63, 1
    s_mov_b64 exec, vcc
    s_add_u32 m0, s26, 0x0
    s_nop 0
    buffer_load_dwordx4 v29, s[36:39], s7 offen sc1 lds
    buffer_load_dwordx4 v29, s[36:39], s7 offen offset:1024 sc1 lds
    s_add_u32 m0, s26, 0x2000
    s_nop 0
    buffer_load_dwordx4 v29, s[36:39], s8 offen sc1 lds
    buffer_load_dwordx4 v29, s[36:39], s8 offen offset:1024 sc1 lds
    s_add_u32 m0, s26, 0x4000
    s_nop 0
    buffer_load_dwordx4 v29, s[36:39], s9 offen sc1 lds
    buffer_load_dwordx4 v29, s[36:39], s9 offen offset:1024 sc1 lds
    s_add_u32 m0, s26, 0x6000
    s_nop 0
    buffer_load_dwordx4 v29, s[36:39], s10 offen sc1 lds
    buffer_load_dwordx4 v29, s[36:39], s10 offen offset:1024 sc1 lds
    s_mov_b64 exec, -1
    s_waitcnt vmcnt(0)
    ds_read_b128 v[60:63], v30
    ds_read_b128 v[64:67], v30 offset:1024
    ds_read_b128 v[68:71], v30 offset:8192
    ds_read_b128 v[72:75], v30 offset:9216
    ds_read_b128 v[76:79], v30 offset:16384
    ds_read_b128 v[80:83], v30 offset:17408
    ds_read_b128 v[84:87], v30 offset:24576
    ds_read_b128 v[88:91], v30 offset:25600
    s_waitcnt lgkmcnt(7)
    v_max_u32_e32 v4, v60, v62
    s_waitcnt lgkmcnt(6)
    v_max3_u32 v4, v4, v64, v66
    s_waitcnt lgkmcnt(5)
    v_max3_u32 v4, v4, v68, v70
    s_waitcnt lgkmcnt(4)
    v_max3_u32 v4, v4, v72, v74
    s_waitcnt lgkmcnt(3)
    v_max3_u32 v4, v4, v76, v78
    s_waitcnt lgkmcnt(2)
    v_max3_u32 v4, v4, v80, v82
    s_waitcnt lgkmcnt(1)
    v_max3_u32 v4, v4, v84, v86
    s_waitcnt lgkmcnt(0)
    v_max3_u32 v4, v4, v88, v90
    v_cmp_eq_u32_e32 vcc, -1, v4
    s_cbranch_vccnz retry_43
    s_branch ok_44
redo_47:
    s_cmp_lg_u32 s81, 0
    s_cbranch_scc1 back_48
    s_mov_b32 s81, 1
    s_waitcnt vmcnt(0) lgkmcnt(0)
    s_nop 15
again_49:
    ds_read_b128 v[136:139], v30 offset:32768
    ds_read_b128 v[140:143], v30 offset:33792
    ds_read_b128 v[144:147], v30 offset:40960
    ds_read_b128 v[148:151], v30 offset:41984
    ds_read_b128 v[152:155], v30 offset:49152
    ds_read_b128 v[156:159], v30 offset:50176
    ds_read_b128 v[160:163], v30 offset:57344
    ds_read_b128 v[164:167], v30 offset:58368
    s_waitcnt lgkmcnt(7)
    v_max_u32_e32 v4, v136, v138
    s_waitcnt lgkmcnt(6)
    v_max3_u32 v4, v4, v140, v142
    s_waitcnt lgkmcnt(5)
    v_max3_u32 v4, v4, v144, v146
    s_waitcnt lgkmcnt(4)
    v_max3_u32 v4, v4, v148, v150
    s_waitcnt lgkmcnt(3)
    v_max3_u32 v4, v4, v152, v154
    s_waitcnt lgkmcnt(2)
    v_max3_u32 v4, v4, v156, v158
    s_waitcnt lgkmcnt(1)
    v_max3_u32 v4, v4, v160, v162
    s_waitcnt lgkmcnt(0)
    v_max3_u32 v4, v4, v164, v166
    v_cmp_eq_u32_e32 vcc, -1, v4
    s_cbranch_vccz good_50
    s_cmp_eq_u32 s63, 0
    s_cbranch_scc1 good_50
    s_sub_u32 s63, s63, 1
    s_mov_b64 exec, vcc
    s_add_u32 m0, s26, 0x8000
    s_nop 0
    buffer_load_dwordx4 v29, s[36:39], s11 offen sc1 lds
    buffer_load_dwordx4 v29, s[36:39], s11 offen offset:1024 sc1 lds
    s_add_u32 m0, s26, 0xa000
    s_nop 0
    buffer_load_dwordx4 v29, s[36:39], s12 offen sc1 lds
    buffer_load_dwordx4 v29, s[36:39], s12 offen offset:1024 sc1 lds
    s_add_u32 m0, s26, 0xc000
    s_nop 0
    buffer_load_dwordx4 v29, s[36:39], s13 offen sc1 lds
    buffer_load_dwordx4 v29, s[36:39], s13 offen offset:1024 sc1 lds
    s_add_u32 m0, s26, 0xe000
    s_nop 0
    buffer_load_dwordx4 v29, s[36:39], s14 offen sc1 lds
    buffer_load_dwordx4 v29, s[36:39], s14 offen offset:1024 sc1 lds
    s_mov_b64 exec, -1
    s_waitcnt vmcnt(0)
    s_branch again_49
good_50:
    s_barrier
    s_branch pass_46
retry_58:
    s_cmp_eq_u32 s63, 0
    s_cbranch_scc1 ok_59
    s_sub_u32 s63, s63, 1
    s_mov_b64 exec, vcc
    buffer_load_dwordx4 v[112:115], v36, s[36:39], s9 offen sc1
    buffer_load_dwordx4 v[116:119], v36, s[36:39], s9 offen offset:640 sc1
    buffer_load_dwordx4 v[120:123], v36, s[36:39], s9 offen offset:1280 sc1
    buffer_load_dwordx4 v[124:127], v36, s[36:39], s9 offen offset:1920 sc1
    buffer_load_dwordx4 v[128:131], v36, s[36:39], s10 offen sc1
    buffer_load_dwordx4 v[132:135], v36, s[36:39], s10 offen offset:640 sc1
    buffer_load_dwordx4 v[136:139], v36, s[36:39], s10 offen offset:1280 sc1
    buffer_load_dwordx4 v[140:143], v36, s[36:39], s10 offen offset:1920 sc1
    s_mov_b64 exec, -1
    s_waitcnt vmcnt(0)
    v_max_u32_e32 v1, v112, v114
    v_max3_u32 v1, v1, v116, v118
    v_max3_u32 v1, v1, v120, v122
    v_max3_u32 v1, v1, v128, v130
    v_max3_u32 v1, v1, v132, v134
    v_max3_u32 v1, v1, v136, v138
    v_max3_u32 v1, v1, v124, v126
    v_max3_u32 v1, v1, v140, v142
    v_cmp_eq_u32_e32 vcc, -1, v1
    s_cbranch_vccnz retry_58
    s_branch ok_59
retry_60:
    s_cmp_eq_u32 s63, 0
    s_cbranch_scc1 ok_61
    s_sub_u32 s63, s63, 1
    s_mov_b64 exec, vcc
    buffer_load_dwordx4 v[92:95], v35, s[36:39], s7 offen offset:3072 sc1
    buffer_load_dwordx4 v[108:111], v35, s[36:39], s8 offen offset:3072 sc1
    s_mov_b64 exec, -1
    s_waitcnt vmcnt(0)
    v_and_b32_e32 v1, v92, v94
    v_bitop3_b32 v1, v1, v108, v110 bitop3:0x80
    v_cmp_le_i32_e32 vcc, 0, v1
    s_waitcnt lgkmcnt(0)
    s_cbranch_vccnz retry_60
    s_branch ok_61
L_last:
.section .rodata,"a"
.p2align 6
.amdhsa_kernel interleave_layers__ssm_conv_s4__linear_attn_block__prompt_kernel
  .amdhsa_next_free_vgpr 512
  .amdhsa_next_free_sgpr 102
  .amdhsa_accum_offset 256
  .amdhsa_group_segment_fixed_size 0
  .amdhsa_kernarg_size 120
  .amdhsa_user_sgpr_count 2
  .amdhsa_user_sgpr_kernarg_segment_ptr 1
  .amdhsa_system_sgpr_workgroup_id_x 1
.end_amdhsa_kernel
```
